```python
import torch

def _softmax(x, axis=-1):
    return torch.softmax(x, dim=axis)
def _gelu(x):
    return torch.nn.functional.gelu(x, approximate="tanh")
def _silu(x):
    return torch.nn.functional.silu(x)
def _sigmoid(x):
    return torch.sigmoid(x)
def _layernorm(x, axis=-1, eps=1e-5):
    m = x.mean(dim=axis, keepdim=True)
    v = x.var(dim=axis, keepdim=True, unbiased=False)
    return (x - m) / torch.sqrt(v + eps)
def _scatter_add(tgt, idx, src, axis=0):
    return tgt.clone().index_add_(axis, idx, src)
def _segment_sum(src, seg, n):
    out = torch.zeros((n,) + src.shape[1:], dtype=src.dtype)
    return out.index_add_(0, seg, src)
def _pad(x, pw):
    flat = tuple(v for pair in reversed(pw) for v in pair)
    return torch.nn.functional.pad(x, flat)

kernel_name = 'interleave_layers__linear_kernel_hedgehog__dense_activation_squared_relu__prompt'

def setup_inputs():

    _w = (lambda a: (lambda t: t.to(torch.bfloat16) if t.is_floating_point() else t)(torch.as_tensor(a)))
    def _A_setup():
        B, S, D, H = 1, 2048, 640, 32
        Dh = D // H
        return {
            "x": _w((lambda *s: torch.randn(*s, dtype=torch.bfloat16) * 0.05)(B, S, D)),
            "wqkv": _w((lambda *s: torch.randn(*s, dtype=torch.bfloat16) * 0.2)(D, 3 * D)),
            "w_phi": _w((lambda *s: torch.randn(*s, dtype=torch.bfloat16) * 0.2)(H, Dh, Dh) * (Dh ** -0.5)),
            "wo": _w((lambda *s: torch.randn(*s, dtype=torch.bfloat16) * 0.05)(D, D)),
        }
    _A_in = _A_setup()

    def _B_setup():
        B, S, D, F = 1, 2048, 640, 1536
        return {
            "x": _w((lambda *s: torch.randn(*s, dtype=torch.bfloat16) * 0.05)(B, S, D)),
            "w1": _w((lambda *s: torch.randn(*s, dtype=torch.bfloat16) * 0.05)(D, F)),
            "b1": _w((lambda *s: torch.randn(*s, dtype=torch.bfloat16) * 0.2)(F)),
            "w2": _w((lambda *s: torch.randn(*s, dtype=torch.bfloat16) * 0.05)(F, D)),
            "b2": _w((lambda *s: torch.randn(*s, dtype=torch.bfloat16) * 0.8)(D)),
        }
    _B_in = _B_setup()

    return {
        "A_x": _A_in["x"],
        "A_wqkv": _A_in["wqkv"],
        "A_w_phi": _A_in["w_phi"],
        "A_wo": _A_in["wo"],
        "B_x": _B_in["x"],
        "B_w1": _B_in["w1"],
        "B_b1": _B_in["b1"],
        "B_w2": _B_in["w2"],
        "B_b2": _B_in["b2"],
    }

def reference(A_x, A_wqkv, A_w_phi, A_wo, B_x, B_w1, B_b1, B_w2, B_b2):
    def _A_ref(x, wqkv, w_phi, wo):
        B, S, D = x.shape
        H = 32; Dh = D // H
        qkv = (lambda x, *d: x.permute(*d))((x @ wqkv).reshape(B, S, 3, H, Dh), 2, 0, 3, 1, 4)
        q, k, v = qkv[0], qkv[1], qkv[2]
        pq = torch.einsum("bhsd,hdf->bhsf", q, w_phi)
        pk = torch.einsum("bhsd,hdf->bhsf", k, w_phi)
        phi_q = torch.concatenate([_softmax(pq, axis=-1), _softmax(-pq, axis=-1)], axis=-1)
        phi_k = torch.concatenate([_softmax(pk, axis=-1), _softmax(-pk, axis=-1)], axis=-1)
        kv = torch.einsum("bhsf,bhsd->bhfd", phi_k, v)
        z  = torch.einsum("bhsf->bhf", phi_k)
        num = torch.einsum("bhqf,bhfd->bhqd", phi_q, kv)
        den = torch.einsum("bhqf,bhf->bhq", phi_q, z)[..., None] + 1e-6
        o = num / den
        return (lambda x, *d: x.permute(*d))(o, 0, 2, 1, 3).reshape(B, S, D) @ wo

    def _B_ref(x, w1, b1, w2, b2):
        h = torch.einsum("bsd,df->bsf", x, w1) + b1
        zero = torch.zeros_like(h)
        r = torch.where(h > zero, h, zero)
        h = r * r
        out = torch.einsum("bsf,fd->bsd", h, w2) + b2
        return out

    x = A_x
    x = x + _A_ref(_layernorm(x, axis=-1), A_wqkv, A_w_phi, A_wo)
    x = x + _B_ref(_layernorm(x, axis=-1), B_w1, B_b1, B_w2, B_b2)
    x = x + _A_ref(_layernorm(x, axis=-1), A_wqkv, A_w_phi, A_wo)
    x = x + _B_ref(_layernorm(x, axis=-1), B_w1, B_b1, B_w2, B_b2)
    return x
```

```asm
; @launch grid=(256,1,1) block=(256,1,1) lds=163840
.amdgcn_target "amdgcn-amd-amdhsa--gfx950"
.text
.globl interleave_layers__linear_kernel_hedgehog__dense_activation_squared_relu__prompt_kernel
.p2align 8
.type interleave_layers__linear_kernel_hedgehog__dense_activation_squared_relu__prompt_kernel,@function
interleave_layers__linear_kernel_hedgehog__dense_activation_squared_relu__prompt_kernel:
    s_cmp_ge_u32 s2, 256
    s_cbranch_scc1 L_end
    s_load_dwordx16 s[36:51], s[0:1], 0
    s_load_dwordx8 s[52:59], s[0:1], 64
    v_lshrrev_b32 v4, 6, v0
    v_and_b32 v0, 63, v0
    v_readfirstlane_b32 s24, v4
    v_lshlrev_b32 v218, 4, v0
    v_mov_b32 v12, 0
    v_mov_b32 v13, 0
    v_mov_b32 v14, 0
    v_mov_b32 v15, 0
    s_mul_i32 s79, s24, 12800
    s_add_u32 s79, s79, 102400
    v_add_u32 v8, s79, v218
    ds_write_b128 v8, v[12:15] offset:0
    ds_write_b128 v8, v[12:15] offset:1024
    ds_write_b128 v8, v[12:15] offset:2048
    s_and_b32 s67, s2, 7
    s_lshr_b32 s26, s2, 3
    s_lshl_b32 s64, s26, 2
    s_add_u32 s64, s64, s24
    s_min_u32 s35, s64, 119
    s_and_b32 s80, s35, 7
    s_lshr_b32 s35, s35, 3
    s_mul_i32 s67, s67, 15
    s_add_u32 s67, s67, s35
    s_and_b32 s66, s67, 1
    s_lshl_b32 s66, s66, 3
    s_add_u32 s66, s66, s80
    s_lshr_b32 s68, s67, 1
    s_mul_i32 s69, s68, 21846
    s_lshr_b32 s69, s69, 16
    s_mul_i32 s35, s69, 3
    s_sub_u32 s70, s68, s35
    s_getreg_b32 s25, hwreg(HW_REG_XCC_ID, 0, 4)
    s_mul_i32 s62, s25, 327680
    s_mul_i32 s35, s64, 2560
    s_add_u32 s62, s62, s35
    v_lshlrev_b32 v11, 7, v0
    v_add_u32 v2, 0, v0
    v_mul_u32_u24 v3, 13108, v2
    v_lshrrev_b32 v3, 16, v3
    v_mul_u32_u24 v3, 3760, v3
    v_add_u32 v8, v3, v218
    v_add_u32 v2, 64, v0
    v_mul_u32_u24 v3, 13108, v2
    v_lshrrev_b32 v3, 16, v3
    v_mul_u32_u24 v3, 3760, v3
    v_add_u32 v9, v3, v218
    v_add_u32 v2, 128, v0
    v_mul_u32_u24 v3, 13108, v2
    v_lshrrev_b32 v3, 16, v3
    v_mul_u32_u24 v3, 3760, v3
    v_add_u32 v10, v3, v218
    s_mul_i32 s35, s69, 122880
    s_mul_i32 s60, s70, 1280
    s_mul_i32 s61, s66, 80
    s_add_u32 s35, s35, s60
    s_add_u32 s35, s35, s61
    s_mul_i32 s61, s66, 1600
    s_add_u32 s63, s61, 800
    s_mov_b32 s6, 27262976
    s_mov_b32 s7, 0x20000
    s_mov_b32 s10, 25600
    s_mov_b32 s11, 0x20000
    s_mov_b32 s14, 2457600
    s_mov_b32 s15, 0x20000
    s_mov_b32 s18, 1966080
    s_mov_b32 s19, 0x20000
    s_mov_b32 s22, 2621440
    s_mov_b32 s23, 0x20000
    s_add_u32 m0, s79, 10240
    s_waitcnt lgkmcnt(0)
    s_mov_b64 s[12:13], s[38:39]
    s_mov_b64 s[8:9], s[40:41]
    buffer_load_dwordx4 v8, s[12:15], s35 offen  lds
    buffer_load_dwordx4 v9, s[12:15], s35 offen offset:1024  lds
    s_mov_b32 exec_hi, 0
    buffer_load_dwordx4 v10, s[12:15], s35 offen offset:2048  lds
    s_mov_b32 m0, s79
    s_cmp_eq_u32 s70, 2
    s_cselect_b32 exec_lo, 0, -1
    s_cselect_b32 exec_hi, 0, 0x3ffff
    buffer_load_dwordx4 v218, s[8:11], s61 offen lds
    s_add_u32 m0, s79, 1920
    s_mov_b64 s[4:5], s[58:59]
    buffer_load_dwordx4 v218, s[8:11], s63 offen lds
    s_mov_b64 exec, -1
    s_mov_b64 s[20:21], s[36:37]
    s_mov_b32 s86, s62
    s_add_u32 s92, s58, 7766016
    s_addc_u32 s93, s59, 0
    s_load_dword s95, s[92:93], 0
    v_bfe_u32 v4, v218, 4, 4
    v_lshrrev_b32 v5, 8, v218
    v_lshrrev_b32 v6, 2, v4
    v_and_b32 v7, 3, v4
    s_mul_i32 s35, s66, 153600
    s_mul_i32 s60, s69, 5120
    s_mul_i32 s61, s69, 2560
    s_add_u32 s61, s61, 102400
    s_cmp_eq_u32 s70, 0
    s_cselect_b32 s60, s61, s60
    s_add_u32 s35, s35, s60
    s_cmp_eq_u32 s70, 2
    s_cselect_b32 s81, 3072, 0
    s_cselect_b32 s82, 512, 0
    s_cselect_b32 s76, -1, 0
    s_cselect_b32 s77, 0xff, 0
    s_add_u32 s81, s81, s35
    s_add_u32 s82, s82, s35
    s_mul_i32 s83, s66, 60
    s_add_u32 s83, s83, s68
    s_lshl_b32 s83, s83, 8
    s_add_u32 s83, s83, 7208960
    s_mul_i32 s69, s67, 10923
    s_lshr_b32 s69, s69, 16
    s_mul_i32 s35, s69, 6
    s_sub_u32 s35, s67, s35
    s_lshl_b32 s35, s35, 3
    s_add_u32 s35, s35, s80
    s_mul_i32 s84, s69, 98304
    s_lshl_b32 s60, s35, 6
    s_add_u32 s84, s84, s60
    v_lshrrev_b32 v2, 2, v0
    v_mul_u32_u24 v2, 3072, v2
    v_lshl_add_u32 v2, v7, 4, v2
    s_mov_b64 s[16:17], s[46:47]
    s_add_u32 m0, s79, 3072
    s_mul_i32 s66, s35, 21846
    buffer_load_dwordx4 v2, s[16:19], s84 offen  lds
    s_add_u32 s84, s84, 48128
    buffer_load_dwordx4 v2, s[16:19], s84 offen offset:1024  lds
    s_lshr_b32 s66, s66, 16
    s_mul_i32 s60, s66, 3
    s_sub_u32 s70, s35, s60
    s_mul_i32 s100, s66, 122880
    s_mul_i32 s35, s69, 6144
    s_lshl_b32 s60, s70, 11
    s_add_u32 s35, s35, s60
    s_add_u32 s100, s100, s35
    s_add_u32 s100, s100, 2457600
    s_mul_i32 s101, s66, 20
    s_add_u32 s101, s101, s69
    s_mul_i32 s101, s101, 3
    s_add_u32 s101, s101, s70
    s_lshl_b32 s101, s101, 8
    s_add_u32 s101, s101, 7454720
    s_lshl_b32 s35, s26, 1
    s_add_u32 s35, s35, s24
    s_add_u32 s60, s26, 64
    s_cmp_lt_u32 s24, 2
    s_cselect_b32 s35, s35, s60
    s_cmp_lt_u32 s24, 3
    s_cselect_b32 s35, s35, 72
    s_and_b32 s67, s35, 7
    s_lshr_b32 s60, s35, 3
    s_and_b32 s66, s2, 7
    s_mul_i32 s66, s66, 9
    s_add_u32 s66, s66, s60
    s_cmp_lt_u32 s35, 72
    s_cselect_b32 s66, s66, 68
    s_mul_i32 s35, s66, 13108
    s_lshr_b32 s35, s35, 16
    s_mul_i32 s60, s35, 5
    s_sub_u32 s60, s66, s60
    s_mul_i32 s35, s35, 160
    s_mul_i32 s61, s60, 40
    s_cmp_eq_u32 s60, 4
    s_cselect_b32 s61, 16, s61
    s_cselect_b32 s69, 80, 20
    s_cselect_b32 s70, 40, 8
    s_cselect_b32 s80, 20, 4
    s_add_u32 s68, s35, s61
    s_mul_i32 s85, s67, 102400
    s_add_u32 s85, s85, 4423680
    s_mul_i32 s62, s67, 245760
    s_add_u32 s62, s62, 5140480
    s_sub_u32 s35, s66, 20
    s_lshl_b32 s35, s35, 5
    s_cmp_lt_u32 s66, 20
    s_cselect_b32 s68, s68, s35
    s_cselect_b32 s69, s69, 16
    s_cselect_b32 s70, s70, 8
    s_cselect_b32 s80, s80, 4
    s_cselect_b32 s85, s85, s62
    s_cselect_b32 s12, s42, s50
    s_cselect_b32 s13, s43, s51
    s_mov_b32 s35, 819200
    s_cselect_b32 s14, s35, 1966080
    s_mul_i32 s35, s66, 5120
    s_add_u32 s85, s85, s35
    v_lshrrev_b32 v8, 5, v0
    v_mul_lo_u32 v9, v8, s70
    v_mul_lo_u32 v10, v8, s69
    v_bfe_u32 v8, v0, 4, 1
    v_mul_lo_u32 v2, v8, s80
    v_mul_lo_u32 v3, v8, s70
    v_add3_u32 v9, v9, v2, v6
    v_bfe_u32 v8, v0, 3, 1
    v_mul_lo_u32 v2, v8, s80
    v_add3_u32 v10, v10, v3, v2
    v_bfe_u32 v8, v0, 1, 2
    v_add_u32 v10, v10, v8
    v_mul_u32_u24 v9, 1280, v9
    v_lshl_add_u32 v9, v7, 4, v9
    v_mul_u32_u24 v10, 1280, v10
    v_and_b32 v8, 1, v0
    v_lshl_add_u32 v10, v8, 4, v10
    s_mul_i32 s68, s68, 1280
    s_mul_i32 s69, s69, 1280
    s_mul_i32 s35, s67, 160
    s_add_u32 s68, s68, s35
    s_bitcmp1_b32 s67, 0
    s_cselect_b32 s35, 32, 0
    s_cselect_b32 s60, 0, 128
    s_add_u32 s35, s35, s68
    s_add_u32 s60, s60, s68
    s_add_u32 s61, s35, s69
    s_add_u32 m0, s79, 5120
    s_cmp_lt_u32 s66, 68
    s_cselect_b64 s[74:75], -1, 0
    s_mov_b64 exec, s[74:75]
    buffer_load_dwordx4 v9, s[12:15], s35 offen  lds
    s_add_u32 m0, m0, 1024
    s_add_u32 s35, s35, 64
    buffer_load_dwordx4 v9, s[12:15], s61 offen  lds
    s_add_u32 m0, m0, 1024
    s_add_u32 s61, s61, 64
    buffer_load_dwordx4 v9, s[12:15], s35 offen  lds
    s_add_u32 m0, m0, 1024
    s_nop 0
    buffer_load_dwordx4 v9, s[12:15], s61 offen  lds
    s_add_u32 m0, m0, 1024
    s_nop 0
    buffer_load_dwordx4 v10, s[12:15], s60 offen  lds
    s_mov_b64 exec, -1
    s_mov_b32 s62, s86
    s_mov_b64 exec, 0xfffff
    buffer_load_dword v220, v11, s[20:23], s62 offen
    s_mov_b64 exec, -1
    v_mul_u32_u24 v9, 42, v0
    v_add_u32 v12, 1080, v9
    v_cmp_gt_u32 vcc, 20, v0
    v_mov_b32 v13, 0x3f80
    s_nop 0
    v_cndmask_b32 v9, v12, v9, vcc
    v_add_u32 v9, s79, v9
    s_mov_b64 exec, s[76:77]
    ds_write_b16 v9, v13
    s_mov_b64 exec, -1
    v_lshl_add_u32 v8, v5, 3, v6
    v_lshl_add_u32 v9, v5, 2, v6
    v_lshrrev_b32 v12, 1, v7
    v_mul_u32_u24 v12, 1120, v12
    v_add_u32 v12, s79, v12
    v_mad_u32_u24 v14, v8, 40, v12
    v_mad_u32_u24 v15, v9, 40, v12
    v_and_b32 v13, 1, v0
    v_lshl_add_u32 v12, v13, 3, v14
    v_lshl_add_u32 v13, v13, 3, v15
    v_lshl_add_u32 v2, v6, 3, v7
    v_mul_u32_u24 v2, 80, v2
    v_add_u32 v2, s79, v2
    v_min_u32 v3, 1, v5
    v_lshl_add_u32 v3, v3, 3, v2
    v_lshl_add_u32 v2, v5, 4, v2
    v_lshrrev_b32 v17, 2, v4
    v_lshl_add_u32 v17, v5, 2, v17
    v_and_b32 v16, 1, v4
    v_lshl_add_u32 v17, v17, 1, v16
    v_lshlrev_b32 v17, 4, v17
    s_waitcnt lgkmcnt(0)
    s_waitcnt vmcnt(8)
    ds_read_b128 v[20:23], v2 offset:10240
    ds_read_b128 v[24:27], v2 offset:10560
    ds_read_b64_tr_b16 v[100:101], v12 offset:0
    ds_read_b64_tr_b16 v[102:103], v12 offset:160
    ds_read_b64_tr_b16 v[106:107], v12 offset:16
    ds_read_b64_tr_b16 v[108:109], v12 offset:176
    ds_read_b64_tr_b16 v[112:113], v14 offset:32
    ds_read_b64_tr_b16 v[114:115], v14 offset:192
    ds_read_b64 v[28:29], v3 offset:10304
    ds_read_b64 v[30:31], v3 offset:10624
    ds_read_b64_tr_b16 v[104:105], v13 offset:1280
    ds_read_b64_tr_b16 v[110:111], v13 offset:1296
    ds_read_b64_tr_b16 v[116:117], v15 offset:1312
    v_lshlrev_b32 v18, 6, v8
    v_lshl_add_u32 v18, v7, 4, v18
    v_add_u32 v18, s79, v18
    v_lshlrev_b32 v19, 5, v8
    v_lshl_add_u32 v19, v7, 3, v19
    v_add_u32 v19, s79, v19
    v_mov_b32 v60, 0x3f803f80
    v_mov_b32 v61, 0x3f803f80
    v_mov_b32 v62, 0x3f803f80
    v_mov_b32 v63, 0x3f803f80
    s_waitcnt lgkmcnt(9)
    v_mfma_f32_16x16x32_bf16 v[120:123], v[20:23], v[100:103], 0
    v_mfma_f32_16x16x32_bf16 v[124:127], v[24:27], v[100:103], 0
    s_waitcnt lgkmcnt(7)
    v_mfma_f32_16x16x32_bf16 v[128:131], v[20:23], v[106:109], 0
    v_mfma_f32_16x16x32_bf16 v[132:135], v[24:27], v[106:109], 0
    s_waitcnt lgkmcnt(5)
    v_mfma_f32_16x16x32_bf16 v[136:139], v[20:23], v[112:115], 0
    v_mfma_f32_16x16x32_bf16 v[140:143], v[24:27], v[112:115], 0
    s_waitcnt lgkmcnt(2)
    v_mfma_f32_16x16x16_bf16 v[120:123], v[28:29], v[104:105], v[120:123]
    v_mfma_f32_16x16x16_bf16 v[124:127], v[30:31], v[104:105], v[124:127]
    s_waitcnt lgkmcnt(1)
    v_mfma_f32_16x16x16_bf16 v[128:131], v[28:29], v[110:111], v[128:131]
    v_mfma_f32_16x16x16_bf16 v[132:135], v[30:31], v[110:111], v[132:135]
    s_waitcnt lgkmcnt(0)
    v_mfma_f32_16x16x16_bf16 v[136:139], v[28:29], v[116:117], v[136:139]
    v_mfma_f32_16x16x16_bf16 v[140:143], v[30:31], v[116:117], v[140:143]
    s_mul_i32 s28, s95, 0x19660d
    s_add_u32 s28, s28, 0x3c6ef35f
    s_xor_b32 s29, s28, 0x5bd1e995
    s_mul_i32 s29, s29, 0x2c1b3c6d
    s_andn2_b32 s29, s29, 15
    v_cvt_pk_bf16_f32 v64, v120, v121
    v_cvt_pk_bf16_f32 v65, v122, v123
    v_cvt_pk_bf16_f32 v66, v124, v125
    v_cvt_pk_bf16_f32 v67, v126, v127
    buffer_store_dwordx4 v[64:67], v218, s[4:7], s81 offen offset:0 sc1
    v_cvt_pk_bf16_f32 v68, v128, v129
    v_cvt_pk_bf16_f32 v69, v130, v131
    v_cvt_pk_bf16_f32 v70, v132, v133
    v_cvt_pk_bf16_f32 v71, v134, v135
    buffer_store_dwordx4 v[68:71], v218, s[4:7], s81 offen offset:1024 sc1
    v_cvt_pk_bf16_f32 v72, v136, v137
    v_cvt_pk_bf16_f32 v73, v138, v139
    v_cvt_pk_bf16_f32 v74, v140, v141
    v_cvt_pk_bf16_f32 v75, v142, v143
    s_mov_b32 exec_lo, 0xc3c3c3c3
    s_mov_b32 exec_hi, 0xc3c3c3c3
    buffer_store_dwordx4 v[72:75], v17, s[4:7], s82 offen offset:2048 sc1
    s_mov_b64 exec, -1
    v_mfma_f32_16x16x32_bf16 v[76:79], v[60:63], v[64:67], 0
    v_mfma_f32_16x16x32_bf16 v[80:83], v[60:63], v[68:71], 0
    v_mfma_f32_16x16x32_bf16 v[84:87], v[60:63], v[72:75], 0
    s_lshl_b32 s99, s2, 2
    s_add_u32 s99, s99, s24
    s_lshl_b32 s99, s99, 10
    s_add_u32 s99, s99, 8388608
    s_cmp_lg_u64 s[74:75], 0
    s_cselect_b32 s95, s85, 1073741824
    s_nop 0
    v_mov_b32 v77, v80
    v_mov_b32 v78, v84
    s_mov_b64 exec, 0xffff
    buffer_store_dwordx4 v[76:79], v218, s[4:7], s83 offen offset:0 sc1
    s_mov_b64 exec, -1
    v_mov_b32 v252, v18
    v_mov_b32 v253, v19
    s_waitcnt vmcnt(5)
    ds_read_b64_tr_b16 a[24:25], v252 offset:3072
    ds_read_b64_tr_b16 a[26:27], v252 offset:3328
    ds_read_b64_tr_b16 a[28:29], v252 offset:3080
    ds_read_b64_tr_b16 a[30:31], v252 offset:3336
    ds_read_b64_tr_b16 a[32:33], v252 offset:5120
    ds_read_b64_tr_b16 a[34:35], v252 offset:5376
    ds_read_b64_tr_b16 a[36:37], v252 offset:5128
    ds_read_b64_tr_b16 a[38:39], v252 offset:5384
    ds_read_b64_tr_b16 a[40:41], v252 offset:7168
    ds_read_b64_tr_b16 a[42:43], v252 offset:7424
    ds_read_b64_tr_b16 a[44:45], v252 offset:7176
    ds_read_b64_tr_b16 a[46:47], v252 offset:7432
    ds_read_b64_tr_b16 a[48:49], v253 offset:9216
    ds_read_b64_tr_b16 a[50:51], v253 offset:9344
    v_mov_b32 v254, 0x3f803f80
    v_accvgpr_write_b32 a20, -1
    v_accvgpr_write_b32 a60, v254
    v_accvgpr_write_b32 a21, -1
    v_accvgpr_write_b32 a61, v254
    v_accvgpr_write_b32 a22, -1
    v_accvgpr_write_b32 a62, v254
    v_accvgpr_write_b32 a23, -1
    v_accvgpr_write_b32 a63, v254
    s_waitcnt lgkmcnt(12)
    s_nop 0
    v_mfma_f32_16x16x32_bf16 a[52:55], a[60:63], a[24:27], 0
    s_waitcnt lgkmcnt(10)
    v_mfma_f32_16x16x32_bf16 a[56:59], a[60:63], a[28:31], 0
    s_nop 7
    v_accvgpr_mov_b32 a53, a56
    buffer_store_dwordx4 a[24:27], v218, s[4:7], s100 offen offset:0 sc1
    buffer_store_dwordx4 a[28:31], v218, s[4:7], s100 offen offset:1024 sc1
    s_waitcnt lgkmcnt(8)
    buffer_store_dwordx4 a[32:35], v218, s[4:7], s95 offen offset:0 sc1
    s_waitcnt lgkmcnt(6)
    buffer_store_dwordx4 a[36:39], v218, s[4:7], s95 offen offset:1024 sc1
    s_waitcnt lgkmcnt(4)
    buffer_store_dwordx4 a[40:43], v218, s[4:7], s95 offen offset:2048 sc1
    s_waitcnt lgkmcnt(2)
    buffer_store_dwordx4 a[44:47], v218, s[4:7], s95 offen offset:3072 sc1
    s_add_u32 s95, s95, 4096
    s_waitcnt lgkmcnt(0)
    buffer_store_dwordx4 a[48:51], v218, s[4:7], s95 offen offset:0 sc1
    s_mov_b64 exec, 0xffff
    buffer_store_dwordx4 a[52:55], v218, s[4:7], s101 offen offset:0 sc1
    s_mov_b32 exec_lo, -1
    s_mov_b32 exec_hi, 0xffffff
    buffer_store_dwordx4 a[20:23], v218, s[4:7], s99 offen offset:0 sc1
    s_mov_b64 exec, -1
    s_mov_b32 exec_hi, 0xffffff
    s_add_u32 s99, s99, 0x100000
    buffer_store_dwordx4 a[20:23], v218, s[4:7], s99 offen offset:0 sc1
    s_mov_b64 exec, -1
    v_lshrrev_b32 v2, 3, v0
    v_mul_u32_u24 v2, 1280, v2
    v_and_b32 v3, 7, v0
    v_xor_b32 v3, v3, v5
    v_lshl_add_u32 v240, v3, 4, v2
    v_xor_b32 v241, 64, v240
    v_add_u32 v241, 9216, v241
    s_mul_i32 s90, s24, 24576
    s_lshl_b32 s91, s25, 1
    s_lshr_b32 s35, s26, 4
    s_add_u32 s91, s91, s35
    s_lshl_b32 s91, s91, 2
    s_add_u32 s91, s91, s24
    s_mul_i32 s91, s91, 40960
    s_getpc_b64 s[16:17]
L_pc:
    s_mov_b32 s18, L_end-L_pc
    s_lshl_b32 s35, s64, 9
    v_lshlrev_b32 v221, 7, v0
    v_min_u32 v221, 384, v221
    v_add_u32 v221, s35, v221
    buffer_load_dword v220, v221, s[16:19], 0 offen sc1
    v_lshrrev_b32 v2, 1, v4
    s_add_u32 m0, s90, 0
    s_add_u32 s98, s91, 0
    buffer_load_dwordx4 v240, s[20:23], s98 offen  lds
    buffer_load_dwordx4 v241, s[20:23], s98 offen offset:1024  lds
    v_xor_b32 v2, v2, v5
    v_lshlrev_b32 v3, 7, v4
    v_lshl_add_u32 v2, v2, 4, v3
    v_add_u32 v242, s90, v2
    v_xor_b32 v243, 64, v242
    v_and_b32 v36, 0xf0, v218
    v_lshrrev_b32 v37, 9, v218
    v_lshl_add_u32 v36, v37, 8, v36
    v_bfe_u32 v37, v218, 8, 1
    v_lshl_add_u32 v36, v37, 3, v36
    v_lshrrev_b32 v8, 5, v0
    v_and_b32 v9, 31, v0
    v_mul_u32_u24 v40, 304, v9
    v_mul_u32_u24 v41, 80, v8
    v_add_u32 v164, v40, v41
    v_mad_u32_u24 v165, v8, 48, v40
    v_lshl_add_u32 v40, v8, 3, v6
    v_mul_u32_u24 v40, 304, v40
    v_and_b32 v41, 1, v5
    v_lshl_add_u32 v42, v41, 2, v7
    v_min_u32 v43, 4, v42
    v_lshl_add_u32 v166, v43, 3, v40
    v_min_u32 v43, 5, v42
    v_lshl_add_u32 v167, v43, 3, v40
    v_mul_u32_u24 v40, 40, v9
    v_lshl_add_u32 v168, v8, 3, v40
    v_min_u32 v169, 864, v218
    v_add_u32 v170, 102400, v17
    v_lshrrev_b32 v40, 1, v7
    s_add_u32 m0, s90, 2048
    s_add_u32 s98, s91, 20480
    buffer_load_dwordx4 v240, s[20:23], s98 offen  lds
    buffer_load_dwordx4 v241, s[20:23], s98 offen offset:1024  lds
    v_lshl_add_u32 v171, v40, 9, v17
    v_bfe_u32 v40, v0, 3, 2
    v_lshl_add_u32 v40, v40, 2, v7
    v_add_u32 v42, 16, v40
    v_min_u32 v42, 21, v42
    v_bfe_u32 v43, v0, 2, 1
    v_cmp_eq_u32 vcc, v43, v8
    v_mul_u32_u24 v43, 1760, v8
    v_add_u32 v43, 155648, v43
    v_cndmask_b32 v40, 21, v40, vcc
    v_cndmask_b32 v42, 21, v42, vcc
    v_mad_u32_u24 v172, v40, 40, v43
    v_mad_u32_u24 v173, v42, 40, v43
    v_mul_u32_u24 v40, 49152, v41
    v_lshl_add_u32 v40, v4, 4, v40
    v_lshl_add_u32 v174, v8, 9, v40
    v_lshl_add_u32 v175, v8, 3, v40
    v_cmp_eq_u32 vcc, v6, v5
    v_and_b32 v40, 1, v0
    v_lshlrev_b32 v40, 4, v40
    v_mov_b32 v42, 0x3f80
    v_lshlrev_b32 v40, v40, v42
    v_cndmask_b32 v40, 0, v40, vcc
    v_cmp_gt_u32 vcc, 2, v7
    v_mov_b32 v178, v36
    v_mov_b32 v179, 0
    v_cndmask_b32 v176, 0, v40, vcc
    v_cndmask_b32 v177, v40, 0, vcc
    v_add_u32 v224, 159232, v218
    s_add_u32 m0, s90, 4096
    s_add_u32 s98, s91, 128
    buffer_load_dwordx4 v240, s[20:23], s98 offen  lds
    buffer_load_dwordx4 v241, s[20:23], s98 offen offset:1024  lds
    ds_write_b128 v224, v[164:167] offset:0
    ds_write_b128 v224, v[168:171] offset:1024
    ds_write_b128 v224, v[172:175] offset:2048
    ds_write_b128 v224, v[176:179] offset:3072
    v_lshlrev_b32 v225, 4, v5
    v_add_u32 v225, 153600, v225
    v_lshlrev_b32 v2, 3, v6
    v_bfe_u32 v3, v0, 4, 1
    v_lshl_add_u32 v2, v3, 2, v2
    v_lshrrev_b32 v3, 5, v0
    v_lshl_add_u32 v2, v3, 5, v2
    v_add_lshl_u32 v248, v2, v7, 1
    v_lshlrev_b32 v249, 1, v0
    v_mul_u32_u24 v250, 1280, v4
    v_lshl_add_u32 v251, v5, 3, v250
    v_lshl_add_u32 v250, v5, 4, v250
    s_or_b32 s35, s29, s25
    v_mov_b32 v190, s28
    v_mov_b32 v191, s35
    s_mul_i32 s35, s2, 32
    s_add_u32 s35, s35, 7700480
    s_add_u32 m0, s90, 6144
    s_add_u32 s98, s91, 20608
    buffer_load_dwordx4 v240, s[20:23], s98 offen  lds
    buffer_load_dwordx4 v241, s[20:23], s98 offen offset:1024  lds
    s_add_u32 m0, s90, 8192
    s_add_u32 s98, s91, 256
    buffer_load_dwordx4 v240, s[20:23], s98 offen  lds
    buffer_load_dwordx4 v241, s[20:23], s98 offen offset:1024  lds
    s_add_u32 m0, s90, 10240
    s_add_u32 s98, s91, 20736
    buffer_load_dwordx4 v240, s[20:23], s98 offen  lds
    buffer_load_dwordx4 v241, s[20:23], s98 offen offset:1024  lds
    s_cmp_eq_u32 s24, 0
    s_cselect_b64 exec, 1, 0
    s_waitcnt vmcnt(13)
    s_barrier
    buffer_store_dwordx2 v[190:191], off, s[4:7], s35 sc1
    s_mov_b64 exec, -1
    s_mov_b32 s27, 0
    s_mov_b32 s3, 0
L_reload_x:
    s_and_b32 s30, s26, 15
    s_add_u32 m0, s90, 12288
    s_add_u32 s98, s91, 384
    buffer_load_dwordx4 v240, s[20:23], s98 offen  lds
    buffer_load_dwordx4 v241, s[20:23], s98 offen offset:1024  lds
    s_mul_i32 s82, s30, 153600
    s_mov_b32 s60, 0x3f803f80
    v_mov_b32 v230, 0
    v_mov_b32 v231, 0
    v_mov_b32 v232, 0
    v_mov_b32 v233, 0
    v_mov_b32 v234, 0
    v_mov_b32 v235, 0
    v_mov_b32 v236, 0
    v_mov_b32 v237, 0
    s_waitcnt vmcnt(13)
    ds_read_b128 v[0:3], v242 offset:0
    ds_read_b128 v[8:11], v243 offset:0
    s_waitcnt vmcnt(11)
    ds_read_b128 v[4:7], v242 offset:2048
    ds_read_b128 v[12:15], v243 offset:2048
    s_waitcnt lgkmcnt(3)
    v_dot2c_f32_bf16 v230, s60, v0
    v_dot2c_f32_bf16 v231, v0, v0
    v_dot2c_f32_bf16 v232, s60, v1
    v_dot2c_f32_bf16 v233, v1, v1
    v_dot2c_f32_bf16 v230, s60, v2
    v_dot2c_f32_bf16 v231, v2, v2
    v_dot2c_f32_bf16 v232, s60, v3
    v_dot2c_f32_bf16 v233, v3, v3
    s_waitcnt lgkmcnt(2)
    v_dot2c_f32_bf16 v230, s60, v8
    v_dot2c_f32_bf16 v231, v8, v8
    v_dot2c_f32_bf16 v232, s60, v9
    s_add_u32 m0, s90, 14336
    s_add_u32 s98, s91, 20864
    buffer_load_dwordx4 v240, s[20:23], s98 offen  lds
    buffer_load_dwordx4 v241, s[20:23], s98 offen offset:1024  lds
    v_dot2c_f32_bf16 v233, v9, v9
    v_dot2c_f32_bf16 v230, s60, v10
    v_dot2c_f32_bf16 v231, v10, v10
    v_dot2c_f32_bf16 v232, s60, v11
    v_dot2c_f32_bf16 v233, v11, v11
    s_add_u32 m0, s90, 16384
    s_add_u32 s98, s91, 512
    buffer_load_dwordx4 v240, s[20:23], s98 offen  lds
    buffer_load_dwordx4 v241, s[20:23], s98 offen offset:1024  lds
    s_add_u32 m0, s90, 18432
    s_add_u32 s98, s91, 20992
    buffer_load_dwordx4 v240, s[20:23], s98 offen  lds
    buffer_load_dwordx4 v241, s[20:23], s98 offen offset:1024  lds
    s_add_u32 m0, s90, 20480
    s_add_u32 s98, s91, 640
    buffer_load_dwordx4 v240, s[20:23], s98 offen  lds
    buffer_load_dwordx4 v241, s[20:23], s98 offen offset:1024  lds
    s_add_u32 m0, s90, 22528
    s_add_u32 s98, s91, 21120
    buffer_load_dwordx4 v240, s[20:23], s98 offen  lds
    buffer_load_dwordx4 v241, s[20:23], s98 offen offset:1024  lds
    s_add_u32 m0, s90, 0
    s_add_u32 s98, s91, 768
    buffer_load_dwordx4 v240, s[20:23], s98 offen  lds
    buffer_load_dwordx4 v241, s[20:23], s98 offen offset:1024  lds
    s_waitcnt vmcnt(21)
    ds_read_b128 v[16:19], v242 offset:4096
    ds_read_b128 v[24:27], v243 offset:4096
    s_waitcnt lgkmcnt(3)
    v_dot2c_f32_bf16 v234, s60, v4
    v_dot2c_f32_bf16 v235, v4, v4
    v_dot2c_f32_bf16 v236, s60, v5
    v_dot2c_f32_bf16 v237, v5, v5
    v_dot2c_f32_bf16 v234, s60, v6
    v_dot2c_f32_bf16 v235, v6, v6
    v_dot2c_f32_bf16 v236, s60, v7
    v_dot2c_f32_bf16 v237, v7, v7
    s_waitcnt lgkmcnt(2)
    v_dot2c_f32_bf16 v234, s60, v12
    v_dot2c_f32_bf16 v235, v12, v12
    v_dot2c_f32_bf16 v236, s60, v13
    v_dot2c_f32_bf16 v237, v13, v13
    v_dot2c_f32_bf16 v234, s60, v14
    v_dot2c_f32_bf16 v235, v14, v14
    v_dot2c_f32_bf16 v236, s60, v15
    v_dot2c_f32_bf16 v237, v15, v15
    s_add_u32 m0, s90, 2048
    s_add_u32 s98, s91, 21248
    buffer_load_dwordx4 v240, s[20:23], s98 offen  lds
    buffer_load_dwordx4 v241, s[20:23], s98 offen offset:1024  lds
    s_waitcnt vmcnt(21)
    ds_read_b128 v[20:23], v242 offset:6144
    ds_read_b128 v[28:31], v243 offset:6144
    s_waitcnt lgkmcnt(3)
    v_dot2c_f32_bf16 v230, s60, v16
    v_dot2c_f32_bf16 v231, v16, v16
    v_dot2c_f32_bf16 v232, s60, v17
    v_dot2c_f32_bf16 v233, v17, v17
    v_dot2c_f32_bf16 v230, s60, v18
    v_dot2c_f32_bf16 v231, v18, v18
    v_dot2c_f32_bf16 v232, s60, v19
    v_dot2c_f32_bf16 v233, v19, v19
    s_waitcnt lgkmcnt(2)
    v_dot2c_f32_bf16 v230, s60, v24
    v_dot2c_f32_bf16 v231, v24, v24
    v_dot2c_f32_bf16 v232, s60, v25
    v_dot2c_f32_bf16 v233, v25, v25
    v_dot2c_f32_bf16 v230, s60, v26
    v_dot2c_f32_bf16 v231, v26, v26
    v_dot2c_f32_bf16 v232, s60, v27
    v_dot2c_f32_bf16 v233, v27, v27
    s_add_u32 m0, s90, 4096
    s_add_u32 s98, s91, 896
    buffer_load_dwordx4 v240, s[20:23], s98 offen  lds
    buffer_load_dwordx4 v241, s[20:23], s98 offen offset:1024  lds
    s_waitcnt vmcnt(21)
    ds_read_b128 v[32:35], v242 offset:8192
    ds_read_b128 v[40:43], v243 offset:8192
    s_waitcnt lgkmcnt(3)
    v_dot2c_f32_bf16 v234, s60, v20
    v_dot2c_f32_bf16 v235, v20, v20
    v_dot2c_f32_bf16 v236, s60, v21
    v_dot2c_f32_bf16 v237, v21, v21
    v_dot2c_f32_bf16 v234, s60, v22
    v_dot2c_f32_bf16 v235, v22, v22
    v_dot2c_f32_bf16 v236, s60, v23
    v_dot2c_f32_bf16 v237, v23, v23
    s_waitcnt lgkmcnt(2)
    v_dot2c_f32_bf16 v234, s60, v28
    v_dot2c_f32_bf16 v235, v28, v28
    v_dot2c_f32_bf16 v236, s60, v29
    v_dot2c_f32_bf16 v237, v29, v29
    v_dot2c_f32_bf16 v234, s60, v30
    v_dot2c_f32_bf16 v235, v30, v30
    v_dot2c_f32_bf16 v236, s60, v31
    v_dot2c_f32_bf16 v237, v31, v31
    s_add_u32 m0, s90, 6144
    s_add_u32 s98, s91, 21376
    buffer_load_dwordx4 v240, s[20:23], s98 offen  lds
    buffer_load_dwordx4 v241, s[20:23], s98 offen offset:1024  lds
    s_waitcnt vmcnt(21)
    ds_read_b128 v[36:39], v242 offset:10240
    ds_read_b128 v[44:47], v243 offset:10240
    s_waitcnt lgkmcnt(3)
    v_dot2c_f32_bf16 v230, s60, v32
    v_dot2c_f32_bf16 v231, v32, v32
    v_dot2c_f32_bf16 v232, s60, v33
    v_dot2c_f32_bf16 v233, v33, v33
    v_dot2c_f32_bf16 v230, s60, v34
    v_dot2c_f32_bf16 v231, v34, v34
    v_dot2c_f32_bf16 v232, s60, v35
    v_dot2c_f32_bf16 v233, v35, v35
    s_waitcnt lgkmcnt(2)
    v_dot2c_f32_bf16 v230, s60, v40
    v_dot2c_f32_bf16 v231, v40, v40
    v_dot2c_f32_bf16 v232, s60, v41
    v_dot2c_f32_bf16 v233, v41, v41
    v_dot2c_f32_bf16 v230, s60, v42
    v_dot2c_f32_bf16 v231, v42, v42
    v_dot2c_f32_bf16 v232, s60, v43
    v_dot2c_f32_bf16 v233, v43, v43
    s_add_u32 m0, s90, 8192
    s_add_u32 s98, s91, 1024
    buffer_load_dwordx4 v240, s[20:23], s98 offen  lds
    buffer_load_dwordx4 v241, s[20:23], s98 offen offset:1024  lds
    s_waitcnt vmcnt(20)
    ds_read_b128 v[48:51], v242 offset:12288
    ds_read_b128 v[56:59], v243 offset:12288
    s_waitcnt lgkmcnt(3)
    v_dot2c_f32_bf16 v234, s60, v36
    v_dot2c_f32_bf16 v235, v36, v36
    v_dot2c_f32_bf16 v236, s60, v37
    v_dot2c_f32_bf16 v237, v37, v37
    v_dot2c_f32_bf16 v234, s60, v38
    v_dot2c_f32_bf16 v235, v38, v38
    v_dot2c_f32_bf16 v236, s60, v39
    v_dot2c_f32_bf16 v237, v39, v39
    s_waitcnt lgkmcnt(2)
    v_dot2c_f32_bf16 v234, s60, v44
    v_dot2c_f32_bf16 v235, v44, v44
    v_dot2c_f32_bf16 v236, s60, v45
    v_dot2c_f32_bf16 v237, v45, v45
    v_dot2c_f32_bf16 v234, s60, v46
    v_dot2c_f32_bf16 v235, v46, v46
    v_dot2c_f32_bf16 v236, s60, v47
    v_dot2c_f32_bf16 v237, v47, v47
    s_add_u32 m0, s90, 10240
    s_add_u32 s98, s91, 21504
    buffer_load_dwordx4 v240, s[20:23], s98 offen  lds
    buffer_load_dwordx4 v241, s[20:23], s98 offen offset:1024  lds
    s_waitcnt vmcnt(20)
    ds_read_b128 v[52:55], v242 offset:14336
    ds_read_b128 v[60:63], v243 offset:14336
    s_waitcnt lgkmcnt(3)
    v_dot2c_f32_bf16 v230, s60, v48
    v_dot2c_f32_bf16 v231, v48, v48
    v_dot2c_f32_bf16 v232, s60, v49
    v_dot2c_f32_bf16 v233, v49, v49
    v_dot2c_f32_bf16 v230, s60, v50
    v_dot2c_f32_bf16 v231, v50, v50
    v_dot2c_f32_bf16 v232, s60, v51
    v_dot2c_f32_bf16 v233, v51, v51
    s_waitcnt lgkmcnt(2)
    v_dot2c_f32_bf16 v230, s60, v56
    v_dot2c_f32_bf16 v231, v56, v56
    v_dot2c_f32_bf16 v232, s60, v57
    v_dot2c_f32_bf16 v233, v57, v57
    v_dot2c_f32_bf16 v230, s60, v58
    v_dot2c_f32_bf16 v231, v58, v58
    v_dot2c_f32_bf16 v232, s60, v59
    v_dot2c_f32_bf16 v233, v59, v59
    s_add_u32 m0, s90, 12288
    s_add_u32 s98, s91, 1152
    buffer_load_dwordx4 v240, s[20:23], s98 offen  lds
    buffer_load_dwordx4 v241, s[20:23], s98 offen offset:1024  lds
    s_waitcnt vmcnt(20)
    ds_read_b128 v[64:67], v242 offset:16384
    ds_read_b128 v[72:75], v243 offset:16384
    s_waitcnt lgkmcnt(3)
    v_dot2c_f32_bf16 v234, s60, v52
    v_dot2c_f32_bf16 v235, v52, v52
    v_dot2c_f32_bf16 v236, s60, v53
    v_dot2c_f32_bf16 v237, v53, v53
    v_dot2c_f32_bf16 v234, s60, v54
    v_dot2c_f32_bf16 v235, v54, v54
    v_dot2c_f32_bf16 v236, s60, v55
    v_dot2c_f32_bf16 v237, v55, v55
    s_waitcnt lgkmcnt(2)
    v_dot2c_f32_bf16 v234, s60, v60
    v_dot2c_f32_bf16 v235, v60, v60
    v_dot2c_f32_bf16 v236, s60, v61
    v_dot2c_f32_bf16 v237, v61, v61
    v_dot2c_f32_bf16 v234, s60, v62
    v_dot2c_f32_bf16 v235, v62, v62
    v_dot2c_f32_bf16 v236, s60, v63
    v_dot2c_f32_bf16 v237, v63, v63
    s_add_u32 m0, s90, 14336
    s_add_u32 s98, s91, 21632
    buffer_load_dwordx4 v240, s[20:23], s98 offen  lds
    buffer_load_dwordx4 v241, s[20:23], s98 offen offset:1024  lds
    s_waitcnt vmcnt(20)
    ds_read_b128 v[68:71], v242 offset:18432
    ds_read_b128 v[76:79], v243 offset:18432
    s_waitcnt lgkmcnt(3)
    v_dot2c_f32_bf16 v230, s60, v64
    v_dot2c_f32_bf16 v231, v64, v64
    v_dot2c_f32_bf16 v232, s60, v65
    v_dot2c_f32_bf16 v233, v65, v65
    v_dot2c_f32_bf16 v230, s60, v66
    v_dot2c_f32_bf16 v231, v66, v66
    v_dot2c_f32_bf16 v232, s60, v67
    v_dot2c_f32_bf16 v233, v67, v67
    s_waitcnt lgkmcnt(2)
    v_dot2c_f32_bf16 v230, s60, v72
    v_dot2c_f32_bf16 v231, v72, v72
    v_dot2c_f32_bf16 v232, s60, v73
    v_dot2c_f32_bf16 v233, v73, v73
    v_dot2c_f32_bf16 v230, s60, v74
    v_dot2c_f32_bf16 v231, v74, v74
    v_dot2c_f32_bf16 v232, s60, v75
    v_dot2c_f32_bf16 v233, v75, v75
    s_waitcnt vmcnt(18)
    ds_read_b128 v[80:83], v242 offset:20480
    ds_read_b128 v[88:91], v243 offset:20480
    s_waitcnt lgkmcnt(3)
    v_dot2c_f32_bf16 v234, s60, v68
    v_dot2c_f32_bf16 v235, v68, v68
    v_dot2c_f32_bf16 v236, s60, v69
    v_dot2c_f32_bf16 v237, v69, v69
    v_dot2c_f32_bf16 v234, s60, v70
    v_dot2c_f32_bf16 v235, v70, v70
    v_dot2c_f32_bf16 v236, s60, v71
    v_dot2c_f32_bf16 v237, v71, v71
    s_waitcnt lgkmcnt(2)
    v_dot2c_f32_bf16 v234, s60, v76
    v_dot2c_f32_bf16 v235, v76, v76
    v_dot2c_f32_bf16 v236, s60, v77
    v_dot2c_f32_bf16 v237, v77, v77
    v_dot2c_f32_bf16 v234, s60, v78
    v_dot2c_f32_bf16 v235, v78, v78
    v_dot2c_f32_bf16 v236, s60, v79
    v_dot2c_f32_bf16 v237, v79, v79
    s_waitcnt vmcnt(16)
    ds_read_b128 v[84:87], v242 offset:22528
    ds_read_b128 v[92:95], v243 offset:22528
    s_waitcnt lgkmcnt(3)
    v_dot2c_f32_bf16 v230, s60, v80
    v_dot2c_f32_bf16 v231, v80, v80
    v_dot2c_f32_bf16 v232, s60, v81
    v_dot2c_f32_bf16 v233, v81, v81
    v_dot2c_f32_bf16 v230, s60, v82
    v_dot2c_f32_bf16 v231, v82, v82
    v_dot2c_f32_bf16 v232, s60, v83
    v_dot2c_f32_bf16 v233, v83, v83
    s_waitcnt lgkmcnt(2)
    v_dot2c_f32_bf16 v230, s60, v88
    v_dot2c_f32_bf16 v231, v88, v88
    v_dot2c_f32_bf16 v232, s60, v89
    v_dot2c_f32_bf16 v233, v89, v89
    v_dot2c_f32_bf16 v230, s60, v90
    v_dot2c_f32_bf16 v231, v90, v90
    v_dot2c_f32_bf16 v232, s60, v91
    v_dot2c_f32_bf16 v233, v91, v91
    s_waitcnt vmcnt(14)
    ds_read_b128 v[96:99], v242 offset:0
    ds_read_b128 v[104:107], v243 offset:0
    s_waitcnt lgkmcnt(3)
    v_dot2c_f32_bf16 v234, s60, v84
    v_dot2c_f32_bf16 v235, v84, v84
    v_dot2c_f32_bf16 v236, s60, v85
    v_dot2c_f32_bf16 v237, v85, v85
    v_dot2c_f32_bf16 v234, s60, v86
    v_dot2c_f32_bf16 v235, v86, v86
    v_dot2c_f32_bf16 v236, s60, v87
    v_dot2c_f32_bf16 v237, v87, v87
    s_waitcnt lgkmcnt(2)
    v_dot2c_f32_bf16 v234, s60, v92
    v_dot2c_f32_bf16 v235, v92, v92
    v_dot2c_f32_bf16 v236, s60, v93
    v_dot2c_f32_bf16 v237, v93, v93
    v_dot2c_f32_bf16 v234, s60, v94
    v_dot2c_f32_bf16 v235, v94, v94
    v_dot2c_f32_bf16 v236, s60, v95
    v_dot2c_f32_bf16 v237, v95, v95
    s_waitcnt vmcnt(12)
    ds_read_b128 v[100:103], v242 offset:2048
    ds_read_b128 v[108:111], v243 offset:2048
    s_waitcnt lgkmcnt(3)
    v_dot2c_f32_bf16 v230, s60, v96
    v_dot2c_f32_bf16 v231, v96, v96
    v_dot2c_f32_bf16 v232, s60, v97
    v_dot2c_f32_bf16 v233, v97, v97
    v_dot2c_f32_bf16 v230, s60, v98
    v_dot2c_f32_bf16 v231, v98, v98
    v_dot2c_f32_bf16 v232, s60, v99
    v_dot2c_f32_bf16 v233, v99, v99
    s_waitcnt lgkmcnt(2)
    v_dot2c_f32_bf16 v230, s60, v104
    v_dot2c_f32_bf16 v231, v104, v104
    v_dot2c_f32_bf16 v232, s60, v105
    v_dot2c_f32_bf16 v233, v105, v105
    v_dot2c_f32_bf16 v230, s60, v106
    v_dot2c_f32_bf16 v231, v106, v106
    v_dot2c_f32_bf16 v232, s60, v107
    v_dot2c_f32_bf16 v233, v107, v107
    s_waitcnt vmcnt(10)
    ds_read_b128 v[112:115], v242 offset:4096
    ds_read_b128 v[120:123], v243 offset:4096
    s_waitcnt lgkmcnt(3)
    v_dot2c_f32_bf16 v234, s60, v100
    v_dot2c_f32_bf16 v235, v100, v100
    v_dot2c_f32_bf16 v236, s60, v101
    v_dot2c_f32_bf16 v237, v101, v101
    v_dot2c_f32_bf16 v234, s60, v102
    v_dot2c_f32_bf16 v235, v102, v102
    v_dot2c_f32_bf16 v236, s60, v103
    v_dot2c_f32_bf16 v237, v103, v103
    s_waitcnt lgkmcnt(2)
    v_dot2c_f32_bf16 v234, s60, v108
    v_dot2c_f32_bf16 v235, v108, v108
    v_dot2c_f32_bf16 v236, s60, v109
    v_dot2c_f32_bf16 v237, v109, v109
    v_dot2c_f32_bf16 v234, s60, v110
    v_dot2c_f32_bf16 v235, v110, v110
    v_dot2c_f32_bf16 v236, s60, v111
    v_dot2c_f32_bf16 v237, v111, v111
    s_waitcnt vmcnt(8)
    ds_read_b128 v[116:119], v242 offset:6144
    ds_read_b128 v[124:127], v243 offset:6144
    s_waitcnt lgkmcnt(3)
    v_dot2c_f32_bf16 v230, s60, v112
    v_dot2c_f32_bf16 v231, v112, v112
    v_dot2c_f32_bf16 v232, s60, v113
    v_dot2c_f32_bf16 v233, v113, v113
    v_dot2c_f32_bf16 v230, s60, v114
    v_dot2c_f32_bf16 v231, v114, v114
    v_dot2c_f32_bf16 v232, s60, v115
    v_dot2c_f32_bf16 v233, v115, v115
    s_waitcnt lgkmcnt(2)
    v_dot2c_f32_bf16 v230, s60, v120
    v_dot2c_f32_bf16 v231, v120, v120
    v_dot2c_f32_bf16 v232, s60, v121
    v_dot2c_f32_bf16 v233, v121, v121
    v_dot2c_f32_bf16 v230, s60, v122
    v_dot2c_f32_bf16 v231, v122, v122
    v_dot2c_f32_bf16 v232, s60, v123
    v_dot2c_f32_bf16 v233, v123, v123
    s_waitcnt vmcnt(6)
    ds_read_b128 v[128:131], v242 offset:8192
    ds_read_b128 v[136:139], v243 offset:8192
    s_waitcnt lgkmcnt(3)
    v_dot2c_f32_bf16 v234, s60, v116
    v_dot2c_f32_bf16 v235, v116, v116
    v_dot2c_f32_bf16 v236, s60, v117
    v_dot2c_f32_bf16 v237, v117, v117
    v_dot2c_f32_bf16 v234, s60, v118
    v_dot2c_f32_bf16 v235, v118, v118
    v_dot2c_f32_bf16 v236, s60, v119
    v_dot2c_f32_bf16 v237, v119, v119
    s_waitcnt lgkmcnt(2)
    v_dot2c_f32_bf16 v234, s60, v124
    v_dot2c_f32_bf16 v235, v124, v124
    v_dot2c_f32_bf16 v236, s60, v125
    v_dot2c_f32_bf16 v237, v125, v125
    v_dot2c_f32_bf16 v234, s60, v126
    v_dot2c_f32_bf16 v235, v126, v126
    v_dot2c_f32_bf16 v236, s60, v127
    v_dot2c_f32_bf16 v237, v127, v127
    s_waitcnt vmcnt(4)
    ds_read_b128 v[132:135], v242 offset:10240
    ds_read_b128 v[140:143], v243 offset:10240
    s_waitcnt lgkmcnt(3)
    v_dot2c_f32_bf16 v230, s60, v128
    v_dot2c_f32_bf16 v231, v128, v128
    v_dot2c_f32_bf16 v232, s60, v129
    v_dot2c_f32_bf16 v233, v129, v129
    v_dot2c_f32_bf16 v230, s60, v130
    v_dot2c_f32_bf16 v231, v130, v130
    v_dot2c_f32_bf16 v232, s60, v131
    v_dot2c_f32_bf16 v233, v131, v131
    s_waitcnt lgkmcnt(2)
    v_dot2c_f32_bf16 v230, s60, v136
    v_dot2c_f32_bf16 v231, v136, v136
    v_dot2c_f32_bf16 v232, s60, v137
    v_dot2c_f32_bf16 v233, v137, v137
    v_dot2c_f32_bf16 v230, s60, v138
    v_dot2c_f32_bf16 v231, v138, v138
    v_dot2c_f32_bf16 v232, s60, v139
    v_dot2c_f32_bf16 v233, v139, v139
    s_waitcnt vmcnt(2)
    ds_read_b128 v[144:147], v242 offset:12288
    ds_read_b128 v[152:155], v243 offset:12288
    s_waitcnt lgkmcnt(3)
    v_dot2c_f32_bf16 v234, s60, v132
    v_dot2c_f32_bf16 v235, v132, v132
    v_dot2c_f32_bf16 v236, s60, v133
    v_dot2c_f32_bf16 v237, v133, v133
    v_dot2c_f32_bf16 v234, s60, v134
    v_dot2c_f32_bf16 v235, v134, v134
    v_dot2c_f32_bf16 v236, s60, v135
    v_dot2c_f32_bf16 v237, v135, v135
    s_waitcnt lgkmcnt(2)
    v_dot2c_f32_bf16 v234, s60, v140
    v_dot2c_f32_bf16 v235, v140, v140
    v_dot2c_f32_bf16 v236, s60, v141
    v_dot2c_f32_bf16 v237, v141, v141
    v_dot2c_f32_bf16 v234, s60, v142
    v_dot2c_f32_bf16 v235, v142, v142
    v_dot2c_f32_bf16 v236, s60, v143
    v_dot2c_f32_bf16 v237, v143, v143
    s_waitcnt vmcnt(0)
    ds_read_b128 v[148:151], v242 offset:14336
    ds_read_b128 v[156:159], v243 offset:14336
    s_waitcnt lgkmcnt(3)
    v_dot2c_f32_bf16 v230, s60, v144
    v_dot2c_f32_bf16 v231, v144, v144
    v_dot2c_f32_bf16 v232, s60, v145
    v_dot2c_f32_bf16 v233, v145, v145
    v_dot2c_f32_bf16 v230, s60, v146
    v_dot2c_f32_bf16 v231, v146, v146
    v_dot2c_f32_bf16 v232, s60, v147
    v_dot2c_f32_bf16 v233, v147, v147
    s_waitcnt lgkmcnt(2)
    v_dot2c_f32_bf16 v230, s60, v152
    v_dot2c_f32_bf16 v231, v152, v152
    v_dot2c_f32_bf16 v232, s60, v153
    v_dot2c_f32_bf16 v233, v153, v153
    v_dot2c_f32_bf16 v230, s60, v154
    v_dot2c_f32_bf16 v231, v154, v154
    v_dot2c_f32_bf16 v232, s60, v155
    v_dot2c_f32_bf16 v233, v155, v155
    s_waitcnt lgkmcnt(1)
    v_dot2c_f32_bf16 v234, s60, v148
    v_dot2c_f32_bf16 v235, v148, v148
    v_dot2c_f32_bf16 v236, s60, v149
    v_dot2c_f32_bf16 v237, v149, v149
    v_dot2c_f32_bf16 v234, s60, v150
    v_dot2c_f32_bf16 v235, v150, v150
    v_dot2c_f32_bf16 v236, s60, v151
    v_dot2c_f32_bf16 v237, v151, v151
    s_waitcnt lgkmcnt(0)
    v_dot2c_f32_bf16 v234, s60, v156
    v_dot2c_f32_bf16 v235, v156, v156
    v_dot2c_f32_bf16 v236, s60, v157
    v_dot2c_f32_bf16 v237, v157, v157
    v_dot2c_f32_bf16 v234, s60, v158
    v_dot2c_f32_bf16 v235, v158, v158
    v_dot2c_f32_bf16 v236, s60, v159
    v_dot2c_f32_bf16 v237, v159, v159
    v_add_f32 v226, v230, v232
    v_add_f32 v228, v231, v233
    v_add_f32 v227, v234, v236
    v_add_f32 v229, v235, v237
    v_mov_b32 v230, v226
    v_mov_b32 v231, v227
    v_mov_b32 v232, v228
    v_mov_b32 v233, v229
    v_permlane16_swap_b32 v226, v230
    v_permlane16_swap_b32 v227, v231
    v_permlane16_swap_b32 v228, v232
    v_permlane16_swap_b32 v229, v233
    v_add_f32 v226, v226, v230
    v_add_f32 v227, v227, v231
    v_add_f32 v228, v228, v232
    v_add_f32 v229, v229, v233
    v_mov_b32 v230, v226
    v_mov_b32 v231, v227
    v_mov_b32 v232, v228
    v_mov_b32 v233, v229
    v_permlane32_swap_b32 v226, v230
    v_permlane32_swap_b32 v227, v231
    v_permlane32_swap_b32 v228, v232
    v_permlane32_swap_b32 v229, v233
    v_add_f32 v226, v226, v230
    v_add_f32 v227, v227, v231
    v_add_f32 v228, v228, v232
    v_add_f32 v229, v229, v233
    v_mul_f32 v226, 0xbacccccd, v226
    v_mul_f32 v228, 0x3acccccd, v228
    v_mul_f32 v227, 0xbacccccd, v227
    v_mul_f32 v229, 0x3acccccd, v229
    v_fma_f32 v228, -v226, v226, v228
    v_fma_f32 v229, -v227, v227, v229
    v_max_f32 v228, 0, v228
    v_max_f32 v229, 0, v229
    v_add_f32 v228, 0x3727c5ac, v228
    v_add_f32 v229, 0x3727c5ac, v229
    v_rsq_f32 v228, v228
    v_rsq_f32 v229, v229
    v_lshrrev_b32 v246, 4, v218
    v_mul_u32_u24 v246, 32, v246
    s_mul_i32 s35, s24, 2048
    s_add_u32 s35, s35, 7700480
    s_mov_b32 s65, 262144
L_poll_1:
    buffer_load_dwordx2 v[244:245], v246, s[4:7], s35 offen sc1
    s_sub_u32 s65, s65, 1
    s_cbranch_scc1 L_polled_2
    s_waitcnt vmcnt(0)
    v_and_b32 v247, 15, v245
    v_and_b32 v245, -16, v245
    v_cmp_ne_u64 vcc, s[28:29], v[244:245]
    s_mov_b64 exec, vcc
    s_cbranch_vccnz L_poll_1
L_polled_2:
    s_mov_b64 exec, -1
    v_cmp_eq_u32 vcc, s25, v247
    s_lshl_b32 s61, s24, 2
    s_add_u32 s61, s61, 163328
    s_bcnt1_i32_b64 s35, vcc
    s_sub_u32 s92, vcc_lo, 0x01010101
    s_subb_u32 s93, vcc_hi, 0x01010101
    s_and_b64 s[92:93], s[92:93], vcc
    s_or_b32 s92, s92, s93
    s_xor_b32 s35, s35, 8
    s_or_b32 s35, s35, s92
    s_lshr_b32 s92, s25, 3
    s_or_b32 s35, s35, s92
    v_mov_b32 v244, s61
    v_mov_b32 v245, s35
    ds_write_b32 v244, v245
    v_mov_b32 v244, 163328
    s_waitcnt lgkmcnt(0)
    s_barrier
    ds_read_b128 v[244:247], v244
    s_mul_i32 s98, s24, 3072
    s_min_u32 s98, s98, 7168
    s_add_u32 m0, s98, 0
    s_add_u32 s98, m0, s82
    buffer_load_dwordx4 v218, s[4:7], s98 offen offset:0 sc1 lds
    buffer_load_dwordx4 v218, s[4:7], s98 offen offset:1024 sc1 lds
    buffer_load_dwordx4 v218, s[4:7], s98 offen offset:2048 sc1 lds
    s_waitcnt lgkmcnt(0)
    v_or3_b32 v244, v244, v245, v246
    v_or_b32 v244, v244, v247
    s_nop 0
    v_readfirstlane_b32 s35, v244
    s_andn2_b32 s35, s35, s3
    s_cbranch_scc1 L_role_fix
    s_barrier
    s_mul_i32 s98, s24, 5120
    s_add_u32 m0, s98, 10240
    s_add_u32 s98, m0, s82
    buffer_load_dwordx4 v218, s[4:7], s98 offen offset:0 sc1 lds
    buffer_load_dwordx4 v218, s[4:7], s98 offen offset:1024 sc1 lds
    buffer_load_dwordx4 v218, s[4:7], s98 offen offset:2048 sc1 lds
    buffer_load_dwordx4 v218, s[4:7], s98 offen offset:3072 sc1 lds
    s_add_u32 m0, m0, 4096
    s_add_u32 s98, s98, 4096
    buffer_load_dwordx4 v218, s[4:7], s98 offen offset:0 sc1 lds
    s_mul_i32 s98, s24, 5120
    s_add_u32 m0, s98, 30720
    s_add_u32 s98, m0, s82
    buffer_load_dwordx4 v218, s[4:7], s98 offen offset:0 sc1 lds
    buffer_load_dwordx4 v218, s[4:7], s98 offen offset:1024 sc1 lds
    buffer_load_dwordx4 v218, s[4:7], s98 offen offset:2048 sc1 lds
    s_and_b32 s31, s26, 7
    s_and_b32 s30, s26, 15
    s_lshr_b32 s32, s26, 4
    s_bfe_u32 s33, s26, 0x10003
    s_lshr_b32 s35, s26, 3
    s_lshl_b32 s35, s35, 2
    s_add_u32 s35, s35, s24
    s_lshl_b32 s60, s25, 4
    s_add_u32 s35, s35, s60
    s_mul_i32 s35, s35, 20480
    s_mul_i32 s60, s31, 160
    s_add_u32 s35, s35, s60
    s_bitcmp1_b32 s31, 0
    s_cselect_b32 s88, 32, 0
    s_cselect_b32 s89, 0, 128
    s_add_u32 s88, s88, s35
    s_add_u32 s89, s89, s35
    s_lshl_b32 s35, s25, 21
    s_add_u32 s35, s35, 10485760
    s_mul_i32 s34, s32, 180224
    s_add_u32 s34, s34, s35
    s_mul_i32 s94, s32, 393216
    s_add_u32 s94, s94, s35
    s_add_u32 s94, s94, 360448
    s_lshl_b32 s35, s33, 2
    s_add_u32 s60, s24, 1
    s_and_b32 s60, s60, 3
    s_add_u32 s71, s60, s35
    s_add_u32 s60, s24, 2
    s_and_b32 s60, s60, 3
    s_add_u32 s72, s60, s35
    s_add_u32 s60, s24, 3
    s_and_b32 s60, s60, 3
    s_add_u32 s73, s60, s35
    s_add_u32 s60, s24, 4
    s_and_b32 s60, s60, 3
    s_add_u32 s74, s60, s35
    s_add_u32 s64, s34, 172032
    s_and_b32 s63, s24, 1
    s_lshr_b32 s35, s74, 1
    s_lshl_b32 s35, s35, 7
    s_lshl_b32 s60, s31, 1
    s_add_u32 s60, s60, s63
    s_lshl_b32 s60, s60, 3
    s_add_u32 s78, s35, s60
    s_add_u32 s78, s78, s64
    s_mul_i32 s35, s74, 20480
    s_add_u32 s35, s35, s34
    s_mul_i32 s60, s31, 2560
    s_add_u32 s35, s35, s60
    s_bitcmp1_b32 s31, 0
    s_cselect_b32 s75, 512, 0
    s_cselect_b32 s76, 0, 2048
    s_cselect_b32 s61, 8, 0
    s_add_u32 s75, s75, s35
    s_add_u32 s76, s76, s35
    s_lshl_b32 s77, s74, 10
    s_lshr_b32 s60, s31, 1
    s_lshl_b32 s60, s60, 8
    s_add_u32 s77, s77, s60
    s_add_u32 s77, s77, s61
    s_add_u32 s77, s77, s34
    s_add_u32 s77, s77, 163840
    s_add_u32 s64, s34, 172032
    s_and_b32 s63, s24, 1
    s_lshl_b32 s81, s74, 7
    s_add_u32 s81, s81, s64
    s_lshl_b32 s79, s24, 7
    s_add_u32 s79, s79, s64
    s_lshl_b32 s35, s25, 1
    s_add_u32 s35, s35, s32
    s_lshl_b32 s60, s30, 2
    s_add_u32 s60, s60, s24
    s_lshl_b32 s87, s60, 14
    s_add_u32 s87, s87, 8388608
    s_lshl_b32 s35, s35, 10
    s_add_u32 s86, s87, s35
    s_mul_i32 s66, s24, 40960
    s_add_u32 s66, s66, s34
    s_lshl_b32 s67, s24, 11
    s_add_u32 s67, s67, s34
    s_add_u32 s67, s67, 163840
    s_mul_i32 s70, s24, 98304
    s_add_u32 s70, s70, s94
    s_lshr_b32 s35, s30, 2
    s_and_b32 s60, s30, 3
    s_mul_i32 s61, s35, 5120
    s_add_u32 s61, s61, s70
    s_lshl_b32 s62, s60, 10
    s_add_u32 s68, s61, s62
    s_lshl_b32 s62, s60, 8
    s_add_u32 s69, s61, s62
    s_add_u32 s69, s69, 4096
    s_lshr_b32 s61, s24, 1
    s_lshl_b32 s61, s61, 2
    s_add_u32 s61, s61, s35
    s_lshl_b32 s61, s61, 7
    s_lshl_b32 s62, s60, 1
    s_add_u32 s62, s62, s63
    s_lshl_b32 s62, s62, 3
    s_add_u32 s80, s61, s62
    s_add_u32 s80, s80, s64
    s_mul_i32 s35, s30, 3072
    s_add_u32 s70, s70, s35
    s_mul_i32 s82, s30, 153600
    s_mul_i32 s83, s30, 122880
    s_add_u32 s83, s83, 2457600
    s_mul_i32 s84, s31, 102400
    s_mul_i32 s35, s24, 25600
    s_add_u32 s84, s84, s35
    s_add_u32 s84, s84, 4423680
    s_mul_i32 s85, s31, 245760
    s_mul_i32 s35, s24, 61440
    s_add_u32 s85, s85, s35
    s_add_u32 s85, s85, 5242880
    ds_read_b32 v219, v224 offset:1036
    v_add_u32 v223, 0x10000, v218
    s_waitcnt vmcnt(8)
    s_barrier
    ds_read_b128 a[240:243], v218 offset:0
    ds_read_b128 a[244:247], v218 offset:1024
    s_waitcnt lgkmcnt(2)
    ds_read_b128 a[248:251], v219 offset:2048
    ds_read_b128 a[252:255], v218 offset:3072
    s_waitcnt lgkmcnt(3)
    buffer_load_dwordx4 v218, s[4:7], s98 offen offset:3072 sc1 lds
    v_mfma_f32_16x16x32_bf16 v[160:163], a[240:243], v[0:3], 0
    ds_read_b128 v[240:243], v218 offset:4096
    v_mfma_f32_16x16x32_bf16 v[164:167], a[240:243], v[4:7], 0
    s_waitcnt lgkmcnt(3)
    v_mfma_f32_16x16x32_bf16 v[168:171], a[244:247], v[0:3], 0
    ds_read_b128 v[244:247], v218 offset:5120
    v_mfma_f32_16x16x32_bf16 v[172:175], a[244:247], v[4:7], 0
    s_waitcnt lgkmcnt(3)
    v_mfma_f32_16x16x32_bf16 v[176:179], a[248:251], v[0:3], 0
    ds_read_b128 a[240:243], v218 offset:6144
    v_mfma_f32_16x16x32_bf16 v[180:183], a[248:251], v[4:7], 0
    s_waitcnt lgkmcnt(3)
    s_add_u32 m0, m0, 4096
    s_add_u32 s98, s98, 4096
    v_mfma_f32_16x16x32_bf16 v[184:187], a[252:255], v[0:3], 0
    ds_read_b128 a[244:247], v219 offset:7168
    v_mfma_f32_16x16x32_bf16 v[188:191], a[252:255], v[4:7], 0
    s_waitcnt lgkmcnt(3)
    buffer_load_dwordx4 v218, s[4:7], s98 offen offset:0 sc1 lds
    v_mfma_f32_16x16x32_bf16 v[192:195], v[240:243], v[0:3], 0
    ds_read_b128 a[248:251], v218 offset:8192
    v_mfma_f32_16x16x32_bf16 v[196:199], v[240:243], v[4:7], 0
    s_waitcnt lgkmcnt(3)
    v_mfma_f32_16x16x32_bf16 v[160:163], v[244:247], v[8:11], v[160:163]
    ds_read_b128 a[252:255], v218 offset:9216
    v_mfma_f32_16x16x32_bf16 v[164:167], v[244:247], v[12:15], v[164:167]
    s_waitcnt lgkmcnt(3)
    s_mul_i32 s98, s24, 7168
    s_min_u32 s98, s98, 18432
    v_mfma_f32_16x16x32_bf16 v[168:171], a[240:243], v[8:11], v[168:171]
    s_add_u32 m0, s98, 51200
    s_waitcnt vmcnt(5)
    s_add_u32 s98, m0, s82
    s_barrier
    ds_read_b128 v[240:243], v218 offset:10240
    v_mfma_f32_16x16x32_bf16 v[172:175], a[240:243], v[12:15], v[172:175]
    s_waitcnt lgkmcnt(3)
    buffer_load_dwordx4 v218, s[4:7], s98 offen offset:0 sc1 lds
    v_mfma_f32_16x16x32_bf16 v[176:179], a[244:247], v[8:11], v[176:179]
    ds_read_b128 v[244:247], v218 offset:11264
    v_mfma_f32_16x16x32_bf16 v[180:183], a[244:247], v[12:15], v[180:183]
    s_waitcnt lgkmcnt(3)
    v_mfma_f32_16x16x32_bf16 v[184:187], a[248:251], v[8:11], v[184:187]
    ds_read_b128 a[240:243], v219 offset:12288
    v_mfma_f32_16x16x32_bf16 v[188:191], a[248:251], v[12:15], v[188:191]
    s_waitcnt lgkmcnt(3)
    buffer_load_dwordx4 v218, s[4:7], s98 offen offset:1024 sc1 lds
    v_mfma_f32_16x16x32_bf16 v[192:195], a[252:255], v[8:11], v[192:195]
    ds_read_b128 a[244:247], v218 offset:13312
    v_mfma_f32_16x16x32_bf16 v[196:199], a[252:255], v[12:15], v[196:199]
    s_waitcnt lgkmcnt(3)
    v_mfma_f32_16x16x32_bf16 v[160:163], v[240:243], v[16:19], v[160:163]
    ds_read_b128 a[248:251], v218 offset:14336
    v_mfma_f32_16x16x32_bf16 v[164:167], v[240:243], v[20:23], v[164:167]
    s_waitcnt lgkmcnt(3)
    v_mfma_f32_16x16x32_bf16 v[168:171], v[244:247], v[16:19], v[168:171]
    ds_read_b128 a[252:255], v218 offset:15360
    v_mfma_f32_16x16x32_bf16 v[172:175], v[244:247], v[20:23], v[172:175]
    s_waitcnt lgkmcnt(3)
    buffer_load_dwordx4 v218, s[4:7], s98 offen offset:2048 sc1 lds
    v_mfma_f32_16x16x32_bf16 v[176:179], a[240:243], v[16:19], v[176:179]
    ds_read_b128 v[240:243], v218 offset:16384
    v_mfma_f32_16x16x32_bf16 v[180:183], a[240:243], v[20:23], v[180:183]
    s_waitcnt lgkmcnt(3)
    v_mfma_f32_16x16x32_bf16 v[184:187], a[244:247], v[16:19], v[184:187]
    ds_read_b128 v[244:247], v219 offset:17408
    v_mfma_f32_16x16x32_bf16 v[188:191], a[244:247], v[20:23], v[188:191]
    s_waitcnt lgkmcnt(3)
    v_mfma_f32_16x16x32_bf16 v[192:195], a[248:251], v[16:19], v[192:195]
    ds_read_b128 a[240:243], v218 offset:18432
    v_mfma_f32_16x16x32_bf16 v[196:199], a[248:251], v[20:23], v[196:199]
    s_waitcnt lgkmcnt(3)
    buffer_load_dwordx4 v218, s[4:7], s98 offen offset:3072 sc1 lds
    v_mfma_f32_16x16x32_bf16 v[160:163], a[252:255], v[24:27], v[160:163]
    ds_read_b128 a[244:247], v218 offset:19456
    v_mfma_f32_16x16x32_bf16 v[164:167], a[252:255], v[28:31], v[164:167]
    s_waitcnt lgkmcnt(3)
    v_mfma_f32_16x16x32_bf16 v[168:171], v[240:243], v[24:27], v[168:171]
    ds_read_b128 a[248:251], v218 offset:20480
    v_mfma_f32_16x16x32_bf16 v[172:175], v[240:243], v[28:31], v[172:175]
    s_waitcnt lgkmcnt(3)
    v_mfma_f32_16x16x32_bf16 v[176:179], v[244:247], v[24:27], v[176:179]
    ds_read_b128 a[252:255], v218 offset:21504
    v_mfma_f32_16x16x32_bf16 v[180:183], v[244:247], v[28:31], v[180:183]
    s_waitcnt lgkmcnt(3)
    s_add_u32 m0, m0, 4096
    s_add_u32 s98, s98, 4096
    v_mfma_f32_16x16x32_bf16 v[184:187], a[240:243], v[24:27], v[184:187]
    ds_read_b128 v[240:243], v219 offset:22528
    v_mfma_f32_16x16x32_bf16 v[188:191], a[240:243], v[28:31], v[188:191]
    s_waitcnt lgkmcnt(3)
    buffer_load_dwordx4 v218, s[4:7], s98 offen offset:0 sc1 lds
    v_mfma_f32_16x16x32_bf16 v[192:195], a[244:247], v[24:27], v[192:195]
    ds_read_b128 v[244:247], v218 offset:23552
    v_mfma_f32_16x16x32_bf16 v[196:199], a[244:247], v[28:31], v[196:199]
    s_waitcnt lgkmcnt(3)
    v_mfma_f32_16x16x32_bf16 v[160:163], a[248:251], v[32:35], v[160:163]
    ds_read_b128 a[240:243], v218 offset:24576
    v_mfma_f32_16x16x32_bf16 v[164:167], a[248:251], v[36:39], v[164:167]
    s_waitcnt lgkmcnt(3)
    buffer_load_dwordx4 v218, s[4:7], s98 offen offset:1024 sc1 lds
    v_mfma_f32_16x16x32_bf16 v[168:171], a[252:255], v[32:35], v[168:171]
    ds_read_b128 a[244:247], v218 offset:25600
    v_mfma_f32_16x16x32_bf16 v[172:175], a[252:255], v[36:39], v[172:175]
    s_waitcnt lgkmcnt(3)
    v_mfma_f32_16x16x32_bf16 v[176:179], v[240:243], v[32:35], v[176:179]
    ds_read_b128 a[248:251], v218 offset:26624
    v_mfma_f32_16x16x32_bf16 v[180:183], v[240:243], v[36:39], v[180:183]
    s_waitcnt lgkmcnt(3)
    v_mfma_f32_16x16x32_bf16 v[184:187], v[244:247], v[32:35], v[184:187]
    ds_read_b128 a[252:255], v219 offset:27648
    v_mfma_f32_16x16x32_bf16 v[188:191], v[244:247], v[36:39], v[188:191]
    s_waitcnt lgkmcnt(3)
    buffer_load_dwordx4 v218, s[4:7], s98 offen offset:2048 sc1 lds
    v_mfma_f32_16x16x32_bf16 v[192:195], a[240:243], v[32:35], v[192:195]
    ds_read_b128 v[240:243], v218 offset:28672
    v_mfma_f32_16x16x32_bf16 v[196:199], a[240:243], v[36:39], v[196:199]
    s_waitcnt lgkmcnt(3)
    v_mfma_f32_16x16x32_bf16 v[160:163], a[244:247], v[40:43], v[160:163]
    ds_read_b128 v[244:247], v218 offset:29696
    v_mfma_f32_16x16x32_bf16 v[164:167], a[244:247], v[44:47], v[164:167]
    s_waitcnt lgkmcnt(3)
    v_mfma_f32_16x16x32_bf16 v[168:171], a[248:251], v[40:43], v[168:171]
    s_waitcnt vmcnt(7)
    s_barrier
    ds_read_b128 a[240:243], v218 offset:30720
    v_mfma_f32_16x16x32_bf16 v[172:175], a[248:251], v[44:47], v[172:175]
    s_waitcnt lgkmcnt(3)
    s_mul_i32 s98, s24, 7168
    s_min_u32 s98, s98, 18432
    v_mfma_f32_16x16x32_bf16 v[176:179], a[252:255], v[40:43], v[176:179]
    s_add_u32 m0, s98, 76800
    ds_read_b128 a[244:247], v218 offset:31744
    s_add_u32 s98, m0, s82
    v_mfma_f32_16x16x32_bf16 v[180:183], a[252:255], v[44:47], v[180:183]
    s_waitcnt lgkmcnt(3)
    buffer_load_dwordx4 v218, s[4:7], s98 offen offset:0 sc1 lds
    v_mfma_f32_16x16x32_bf16 v[184:187], v[240:243], v[40:43], v[184:187]
    ds_read_b128 a[248:251], v219 offset:32768
    v_mfma_f32_16x16x32_bf16 v[188:191], v[240:243], v[44:47], v[188:191]
    s_waitcnt lgkmcnt(3)
    v_mfma_f32_16x16x32_bf16 v[192:195], v[244:247], v[40:43], v[192:195]
    ds_read_b128 a[252:255], v218 offset:33792
    v_mfma_f32_16x16x32_bf16 v[196:199], v[244:247], v[44:47], v[196:199]
    s_waitcnt lgkmcnt(3)
    buffer_load_dwordx4 v218, s[4:7], s98 offen offset:1024 sc1 lds
    v_mfma_f32_16x16x32_bf16 v[160:163], a[240:243], v[48:51], v[160:163]
    ds_read_b128 v[240:243], v218 offset:34816
    v_mfma_f32_16x16x32_bf16 v[164:167], a[240:243], v[52:55], v[164:167]
    s_waitcnt lgkmcnt(3)
    v_mfma_f32_16x16x32_bf16 v[168:171], a[244:247], v[48:51], v[168:171]
    ds_read_b128 v[244:247], v218 offset:35840
    v_mfma_f32_16x16x32_bf16 v[172:175], a[244:247], v[52:55], v[172:175]
    s_waitcnt lgkmcnt(3)
    v_mfma_f32_16x16x32_bf16 v[176:179], a[248:251], v[48:51], v[176:179]
    ds_read_b128 a[240:243], v218 offset:36864
    v_mfma_f32_16x16x32_bf16 v[180:183], a[248:251], v[52:55], v[180:183]
    s_waitcnt lgkmcnt(3)
    buffer_load_dwordx4 v218, s[4:7], s98 offen offset:2048 sc1 lds
    v_mfma_f32_16x16x32_bf16 v[184:187], a[252:255], v[48:51], v[184:187]
    ds_read_b128 a[244:247], v219 offset:37888
    v_mfma_f32_16x16x32_bf16 v[188:191], a[252:255], v[52:55], v[188:191]
    s_waitcnt lgkmcnt(3)
    v_mfma_f32_16x16x32_bf16 v[192:195], v[240:243], v[48:51], v[192:195]
    ds_read_b128 a[248:251], v218 offset:38912
    v_mfma_f32_16x16x32_bf16 v[196:199], v[240:243], v[52:55], v[196:199]
    s_waitcnt lgkmcnt(3)
    v_mfma_f32_16x16x32_bf16 v[160:163], v[244:247], v[56:59], v[160:163]
    ds_read_b128 a[252:255], v218 offset:39936
    v_mfma_f32_16x16x32_bf16 v[164:167], v[244:247], v[60:63], v[164:167]
    s_waitcnt lgkmcnt(3)
    buffer_load_dwordx4 v218, s[4:7], s98 offen offset:3072 sc1 lds
    v_mfma_f32_16x16x32_bf16 v[168:171], a[240:243], v[56:59], v[168:171]
    ds_read_b128 v[240:243], v218 offset:40960
    v_mfma_f32_16x16x32_bf16 v[172:175], a[240:243], v[60:63], v[172:175]
    s_waitcnt lgkmcnt(3)
    v_mfma_f32_16x16x32_bf16 v[176:179], a[244:247], v[56:59], v[176:179]
    ds_read_b128 v[244:247], v218 offset:41984
    v_mfma_f32_16x16x32_bf16 v[180:183], a[244:247], v[60:63], v[180:183]
    s_waitcnt lgkmcnt(3)
    v_mfma_f32_16x16x32_bf16 v[184:187], a[248:251], v[56:59], v[184:187]
    ds_read_b128 a[240:243], v219 offset:43008
    v_mfma_f32_16x16x32_bf16 v[188:191], a[248:251], v[60:63], v[188:191]
    s_waitcnt lgkmcnt(3)
    s_add_u32 m0, m0, 4096
    s_add_u32 s98, s98, 4096
    v_mfma_f32_16x16x32_bf16 v[192:195], a[252:255], v[56:59], v[192:195]
    ds_read_b128 a[244:247], v218 offset:44032
    v_mfma_f32_16x16x32_bf16 v[196:199], a[252:255], v[60:63], v[196:199]
    s_waitcnt lgkmcnt(3)
    buffer_load_dwordx4 v218, s[4:7], s98 offen offset:0 sc1 lds
    v_mfma_f32_16x16x32_bf16 v[160:163], v[240:243], v[64:67], v[160:163]
    ds_read_b128 a[248:251], v218 offset:45056
    v_mfma_f32_16x16x32_bf16 v[164:167], v[240:243], v[68:71], v[164:167]
    s_waitcnt lgkmcnt(3)
    v_mfma_f32_16x16x32_bf16 v[168:171], v[244:247], v[64:67], v[168:171]
    ds_read_b128 a[252:255], v218 offset:46080
    v_mfma_f32_16x16x32_bf16 v[172:175], v[244:247], v[68:71], v[172:175]
    s_waitcnt lgkmcnt(3)
    buffer_load_dwordx4 v218, s[4:7], s98 offen offset:1024 sc1 lds
    v_mfma_f32_16x16x32_bf16 v[176:179], a[240:243], v[64:67], v[176:179]
    ds_read_b128 v[240:243], v218 offset:47104
    v_mfma_f32_16x16x32_bf16 v[180:183], a[240:243], v[68:71], v[180:183]
    s_waitcnt lgkmcnt(3)
    v_mfma_f32_16x16x32_bf16 v[184:187], a[244:247], v[64:67], v[184:187]
    ds_read_b128 v[244:247], v219 offset:48128
    v_mfma_f32_16x16x32_bf16 v[188:191], a[244:247], v[68:71], v[188:191]
    s_waitcnt lgkmcnt(3)
    v_mfma_f32_16x16x32_bf16 v[192:195], a[248:251], v[64:67], v[192:195]
    ds_read_b128 a[240:243], v218 offset:49152
    v_mfma_f32_16x16x32_bf16 v[196:199], a[248:251], v[68:71], v[196:199]
    s_waitcnt lgkmcnt(3)
    buffer_load_dwordx4 v218, s[4:7], s98 offen offset:2048 sc1 lds
    v_mfma_f32_16x16x32_bf16 v[160:163], a[252:255], v[72:75], v[160:163]
    ds_read_b128 a[244:247], v218 offset:50176
    v_mfma_f32_16x16x32_bf16 v[164:167], a[252:255], v[76:79], v[164:167]
    s_waitcnt lgkmcnt(3)
    v_mfma_f32_16x16x32_bf16 v[168:171], v[240:243], v[72:75], v[168:171]
    s_waitcnt vmcnt(7)
    s_barrier
    ds_read_b128 a[248:251], v218 offset:51200
    v_mfma_f32_16x16x32_bf16 v[172:175], v[240:243], v[76:79], v[172:175]
    s_waitcnt lgkmcnt(3)
    v_mfma_f32_16x16x32_bf16 v[176:179], v[244:247], v[72:75], v[176:179]
    ds_read_b128 a[252:255], v218 offset:52224
    v_mfma_f32_16x16x32_bf16 v[180:183], v[244:247], v[76:79], v[180:183]
    s_waitcnt lgkmcnt(3)
    v_lshrrev_b32 v204, 8, v218
    v_mul_u32_u24 v204, 3584, v204
    v_mfma_f32_16x16x32_bf16 v[184:187], a[240:243], v[72:75], v[184:187]
    ds_read_b128 v[240:243], v219 offset:53248
    v_add_u32 v204, v204, v218
    v_mfma_f32_16x16x32_bf16 v[188:191], a[240:243], v[76:79], v[188:191]
    s_waitcnt lgkmcnt(3)
    s_mul_i32 s35, s30, 15360
    s_min_u32 s61, s24, 2
    v_mfma_f32_16x16x32_bf16 v[192:195], a[244:247], v[72:75], v[192:195]
    s_lshl_b32 s61, s61, 8
    ds_read_b128 v[244:247], v218 offset:54272
    s_add_u32 s35, s35, s61
    v_mfma_f32_16x16x32_bf16 v[196:199], a[244:247], v[76:79], v[196:199]
    s_waitcnt lgkmcnt(3)
    s_add_u32 s35, s35, 7208960
    v_mfma_f32_16x16x32_bf16 v[160:163], a[248:251], v[80:83], v[160:163]
    ds_read_b128 a[240:243], v218 offset:55296
    v_mfma_f32_16x16x32_bf16 v[164:167], a[248:251], v[84:87], v[164:167]
    s_waitcnt lgkmcnt(3)
    buffer_load_dwordx3 a[100:102], v204, s[4:7], s35 offen offset:0 sc1
    v_mfma_f32_16x16x32_bf16 v[168:171], a[252:255], v[80:83], v[168:171]
    ds_read_b128 a[244:247], v218 offset:56320
    v_mfma_f32_16x16x32_bf16 v[172:175], a[252:255], v[84:87], v[172:175]
    s_waitcnt lgkmcnt(3)
    buffer_load_dwordx3 a[104:106], v204, s[4:7], s35 offen offset:768 sc1
    buffer_load_dwordx3 a[108:110], v204, s[4:7], s35 offen offset:1536 sc1
    buffer_load_dwordx3 a[112:114], v204, s[4:7], s35 offen offset:2304 sc1
    buffer_load_dwordx3 a[116:118], v204, s[4:7], s35 offen offset:3072 sc1
    v_mfma_f32_16x16x32_bf16 v[176:179], v[240:243], v[80:83], v[176:179]
    s_add_u32 s35, s35, 245760
    ds_read_b128 a[248:251], v218 offset:57344
    v_mfma_f32_16x16x32_bf16 v[180:183], v[240:243], v[84:87], v[180:183]
    s_waitcnt lgkmcnt(3)
    buffer_load_dwordx2 a[120:121], v204, s[4:7], s35 offen offset:0 sc1
    v_mfma_f32_16x16x32_bf16 v[184:187], v[244:247], v[80:83], v[184:187]
    ds_read_b128 a[252:255], v219 offset:58368
    v_mfma_f32_16x16x32_bf16 v[188:191], v[244:247], v[84:87], v[188:191]
    s_waitcnt lgkmcnt(3)
    buffer_load_dwordx2 a[124:125], v204, s[4:7], s35 offen offset:768 sc1
    v_mfma_f32_16x16x32_bf16 v[192:195], a[240:243], v[80:83], v[192:195]
    ds_read_b128 v[240:243], v218 offset:59392
    v_mfma_f32_16x16x32_bf16 v[196:199], a[240:243], v[84:87], v[196:199]
    s_waitcnt lgkmcnt(3)
    buffer_load_dwordx2 a[128:129], v204, s[4:7], s35 offen offset:1536 sc1
    buffer_load_dwordx2 a[132:133], v204, s[4:7], s35 offen offset:2304 sc1
    buffer_load_dwordx2 a[136:137], v204, s[4:7], s35 offen offset:3072 sc1
    v_mfma_f32_16x16x32_bf16 v[160:163], a[244:247], v[88:91], v[160:163]
    ds_read_b128 v[244:247], v218 offset:60416
    v_mfma_f32_16x16x32_bf16 v[164:167], a[244:247], v[92:95], v[164:167]
    s_waitcnt lgkmcnt(3)
    s_mov_b64 s[8:9], s[48:49]
    s_mov_b32 s10, 3072
    v_mfma_f32_16x16x32_bf16 v[168:171], a[248:251], v[88:91], v[168:171]
    s_mul_i32 s35, s30, 192
    ds_read_b128 a[240:243], v218 offset:61440
    v_mfma_f32_16x16x32_bf16 v[172:175], a[248:251], v[92:95], v[172:175]
    s_waitcnt lgkmcnt(3)
    buffer_load_ushort v200, v248, s[8:11], s35 offen
    v_mfma_f32_16x16x32_bf16 v[176:179], a[252:255], v[88:91], v[176:179]
    ds_read_b128 a[244:247], v218 offset:62464
    v_mfma_f32_16x16x32_bf16 v[180:183], a[252:255], v[92:95], v[180:183]
    s_waitcnt lgkmcnt(3)
    buffer_load_ushort v201, v248, s[8:11], s35 offen offset:128
    v_mfma_f32_16x16x32_bf16 v[184:187], v[240:243], v[88:91], v[184:187]
    s_mov_b64 s[12:13], s[52:53]
    ds_read_b128 a[248:251], v219 offset:63488
    s_mov_b32 s14, 1280
    v_mfma_f32_16x16x32_bf16 v[188:191], v[240:243], v[92:95], v[188:191]
    s_waitcnt lgkmcnt(3)
    s_mul_i32 s35, s31, 160
    v_mfma_f32_16x16x32_bf16 v[192:195], v[244:247], v[88:91], v[192:195]
    s_bitcmp1_b32 s31, 0
    s_cselect_b32 s60, 32, 0
    s_cselect_b32 s61, 0, 128
    ds_read_b128 a[252:255], v218 offset:64512
    v_mfma_f32_16x16x32_bf16 v[196:199], v[244:247], v[92:95], v[196:199]
    s_waitcnt lgkmcnt(3)
    s_add_u32 s60, s60, s35
    s_add_u32 s61, s61, s35
    v_mfma_f32_16x16x32_bf16 v[160:163], a[240:243], v[96:99], v[160:163]
    ds_read_b128 v[240:243], v223 offset:0
    v_mfma_f32_16x16x32_bf16 v[164:167], a[240:243], v[100:103], v[164:167]
    s_waitcnt lgkmcnt(3)
    buffer_load_ushort v202, v248, s[12:15], s60 offen
    v_mfma_f32_16x16x32_bf16 v[168:171], a[244:247], v[96:99], v[168:171]
    ds_read_b128 v[244:247], v223 offset:1024
    v_mfma_f32_16x16x32_bf16 v[172:175], a[244:247], v[100:103], v[172:175]
    s_waitcnt lgkmcnt(3)
    buffer_load_ushort v203, v249, s[12:15], s61 offen
    v_mfma_f32_16x16x32_bf16 v[176:179], a[248:251], v[96:99], v[176:179]
    ds_read_b128 a[240:243], v223 offset:2048
    v_mfma_f32_16x16x32_bf16 v[180:183], a[248:251], v[100:103], v[180:183]
    s_waitcnt lgkmcnt(3)
    buffer_load_dwordx4 v[208:211], v250, s[20:23], s88 offen
    v_mfma_f32_16x16x32_bf16 v[184:187], a[252:255], v[96:99], v[184:187]
    v_add_u32 v219, 0x10000, v219
    ds_read_b128 a[244:247], v219 offset:3072
    v_mfma_f32_16x16x32_bf16 v[188:191], a[252:255], v[100:103], v[188:191]
    s_waitcnt lgkmcnt(3)
    buffer_load_dwordx4 v[212:215], v250, s[20:23], s88 offen offset:64
    v_mfma_f32_16x16x32_bf16 v[192:195], v[240:243], v[96:99], v[192:195]
    ds_read_b128 a[248:251], v223 offset:4096
    v_mfma_f32_16x16x32_bf16 v[196:199], v[240:243], v[100:103], v[196:199]
    s_waitcnt lgkmcnt(3)
    buffer_load_dwordx2 v[216:217], v251, s[20:23], s89 offen
    v_mfma_f32_16x16x32_bf16 v[160:163], v[244:247], v[104:107], v[160:163]
    s_mov_b64 s[20:21], s[54:55]
    ds_read_b128 a[252:255], v223 offset:5120
    v_mfma_f32_16x16x32_bf16 v[164:167], v[244:247], v[108:111], v[164:167]
    s_waitcnt lgkmcnt(3)
    buffer_load_dword v220, v221, s[16:19], 0 offen sc1
    v_mfma_f32_16x16x32_bf16 v[168:171], a[240:243], v[104:107], v[168:171]
    ds_read_b128 v[240:243], v223 offset:6144
    v_mfma_f32_16x16x32_bf16 v[172:175], a[240:243], v[108:111], v[172:175]
    s_waitcnt lgkmcnt(3)
    v_mfma_f32_16x16x32_bf16 v[176:179], a[244:247], v[104:107], v[176:179]
    s_mul_i32 s98, s24, 13312
    ds_read_b128 v[244:247], v223 offset:7168
    s_min_u32 s98, s98, 37888
    v_mfma_f32_16x16x32_bf16 v[180:183], a[244:247], v[108:111], v[180:183]
    s_waitcnt lgkmcnt(3)
    s_add_u32 m0, s98, 102400
    s_add_u32 s98, m0, s82
    v_mfma_f32_16x16x32_bf16 v[184:187], a[248:251], v[104:107], v[184:187]
    ds_read_b128 a[240:243], v219 offset:8192
    v_mfma_f32_16x16x32_bf16 v[188:191], a[248:251], v[108:111], v[188:191]
    s_waitcnt lgkmcnt(3)
    buffer_load_dwordx4 v218, s[4:7], s98 offen offset:0 sc1 lds
    v_mfma_f32_16x16x32_bf16 v[192:195], a[252:255], v[104:107], v[192:195]
    ds_read_b128 a[244:247], v223 offset:9216
    v_mfma_f32_16x16x32_bf16 v[196:199], a[252:255], v[108:111], v[196:199]
    s_waitcnt lgkmcnt(3)
    v_mfma_f32_16x16x32_bf16 v[160:163], v[240:243], v[112:115], v[160:163]
    ds_read_b128 a[248:251], v223 offset:10240
    v_mfma_f32_16x16x32_bf16 v[164:167], v[240:243], v[116:119], v[164:167]
    s_waitcnt lgkmcnt(3)
    buffer_load_dwordx4 v218, s[4:7], s98 offen offset:1024 sc1 lds
    v_mfma_f32_16x16x32_bf16 v[168:171], v[244:247], v[112:115], v[168:171]
    s_waitcnt vmcnt(20)
    s_barrier
    ds_read_b128 a[252:255], v223 offset:11264
    v_mfma_f32_16x16x32_bf16 v[172:175], v[244:247], v[116:119], v[172:175]
    s_waitcnt lgkmcnt(3)
    v_mfma_f32_16x16x32_bf16 v[176:179], a[240:243], v[112:115], v[176:179]
    ds_read_b128 v[240:243], v223 offset:12288
    v_mfma_f32_16x16x32_bf16 v[180:183], a[240:243], v[116:119], v[180:183]
    s_waitcnt lgkmcnt(3)
    s_mul_i32 s64, s24, 25600
    v_mfma_f32_16x16x32_bf16 v[184:187], a[244:247], v[112:115], v[184:187]
    ds_read_b128 v[244:247], v219 offset:13312
    v_add_u32 v205, s64, v218
    v_mfma_f32_16x16x32_bf16 v[188:191], a[244:247], v[116:119], v[188:191]
    s_waitcnt lgkmcnt(3)
    buffer_load_dwordx4 v218, s[4:7], s98 offen offset:2048 sc1 lds
    v_mfma_f32_16x16x32_bf16 v[192:195], a[248:251], v[112:115], v[192:195]
    ds_read_b128 a[240:243], v223 offset:14336
    ds_read_b128 a[140:143], v205 offset:0
    v_mfma_f32_16x16x32_bf16 v[196:199], a[248:251], v[116:119], v[196:199]
    s_waitcnt lgkmcnt(4)
    ds_read_b128 a[144:147], v205 offset:1024
    v_mfma_f32_16x16x32_bf16 v[160:163], a[252:255], v[120:123], v[160:163]
    ds_read_b128 a[244:247], v223 offset:15360
    v_mfma_f32_16x16x32_bf16 v[164:167], a[252:255], v[124:127], v[164:167]
    s_waitcnt lgkmcnt(5)
    ds_read_b128 a[148:151], v205 offset:2048
    v_mfma_f32_16x16x32_bf16 v[168:171], v[240:243], v[120:123], v[168:171]
    ds_read_b128 a[248:251], v223 offset:16384
    ds_read_b128 a[152:155], v205 offset:3072
    v_mfma_f32_16x16x32_bf16 v[172:175], v[240:243], v[124:127], v[172:175]
    s_waitcnt lgkmcnt(7)
    buffer_load_dwordx4 v218, s[4:7], s98 offen offset:3072 sc1 lds
    v_mfma_f32_16x16x32_bf16 v[176:179], v[244:247], v[120:123], v[176:179]
    ds_read_b128 a[252:255], v223 offset:17408
    ds_read_b128 a[156:159], v205 offset:4096
    v_mfma_f32_16x16x32_bf16 v[180:183], v[244:247], v[124:127], v[180:183]
    s_waitcnt lgkmcnt(8)
    ds_read_b128 a[160:163], v205 offset:5120
    v_mfma_f32_16x16x32_bf16 v[184:187], a[240:243], v[120:123], v[184:187]
    ds_read_b128 v[240:243], v219 offset:18432
    v_mfma_f32_16x16x32_bf16 v[188:191], a[240:243], v[124:127], v[188:191]
    s_waitcnt lgkmcnt(7)
    ds_read_b128 a[164:167], v205 offset:6144
    v_mfma_f32_16x16x32_bf16 v[192:195], a[244:247], v[120:123], v[192:195]
    ds_read_b128 v[244:247], v223 offset:19456
    ds_read_b128 a[168:171], v205 offset:7168
    v_mfma_f32_16x16x32_bf16 v[196:199], a[244:247], v[124:127], v[196:199]
    s_waitcnt lgkmcnt(8)
    v_mfma_f32_16x16x32_bf16 v[160:163], a[248:251], v[128:131], v[160:163]
    s_add_u32 m0, m0, 4096
    ds_read_b128 a[240:243], v223 offset:20480
    ds_read_b128 a[172:175], v205 offset:8192
    v_mfma_f32_16x16x32_bf16 v[164:167], a[248:251], v[132:135], v[164:167]
    s_waitcnt lgkmcnt(8)
    ds_read_b128 a[176:179], v205 offset:9216
    s_add_u32 s98, s98, 4096
    v_mfma_f32_16x16x32_bf16 v[168:171], a[252:255], v[128:131], v[168:171]
    ds_read_b128 a[244:247], v223 offset:21504
    v_mfma_f32_16x16x32_bf16 v[172:175], a[252:255], v[132:135], v[172:175]
    s_waitcnt lgkmcnt(7)
    ds_read_b128 a[180:183], v205 offset:10240
    buffer_load_dwordx4 v218, s[4:7], s98 offen offset:0 sc1 lds
    v_mfma_f32_16x16x32_bf16 v[176:179], v[240:243], v[128:131], v[176:179]
    ds_read_b128 a[248:251], v223 offset:22528
    ds_read_b128 a[184:187], v205 offset:11264
    v_mfma_f32_16x16x32_bf16 v[180:183], v[240:243], v[132:135], v[180:183]
    s_waitcnt lgkmcnt(8)
    v_mfma_f32_16x16x32_bf16 v[184:187], v[244:247], v[128:131], v[184:187]
    ds_read_b128 a[252:255], v219 offset:23552
    ds_read_b128 a[188:191], v205 offset:12288
    v_mfma_f32_16x16x32_bf16 v[188:191], v[244:247], v[132:135], v[188:191]
    s_waitcnt lgkmcnt(8)
    ds_read_b128 a[192:195], v205 offset:13312
    v_mfma_f32_16x16x32_bf16 v[192:195], a[240:243], v[128:131], v[192:195]
    ds_read_b128 v[240:243], v223 offset:24576
    v_mfma_f32_16x16x32_bf16 v[196:199], a[240:243], v[132:135], v[196:199]
    s_waitcnt lgkmcnt(7)
    ds_read_b128 a[196:199], v205 offset:14336
    buffer_load_dwordx4 v218, s[4:7], s98 offen offset:1024 sc1 lds
    v_mfma_f32_16x16x32_bf16 v[160:163], a[244:247], v[136:139], v[160:163]
    ds_read_b128 v[244:247], v223 offset:25600
    ds_read_b128 a[200:203], v205 offset:15360
    v_mfma_f32_16x16x32_bf16 v[164:167], a[244:247], v[140:143], v[164:167]
    s_waitcnt lgkmcnt(8)
    v_mfma_f32_16x16x32_bf16 v[168:171], a[248:251], v[136:139], v[168:171]
    ds_read_b128 a[240:243], v223 offset:26624
    ds_read_b128 a[204:207], v205 offset:16384
    v_mfma_f32_16x16x32_bf16 v[172:175], a[248:251], v[140:143], v[172:175]
    s_waitcnt lgkmcnt(8)
    ds_read_b128 a[208:211], v205 offset:17408
    v_mfma_f32_16x16x32_bf16 v[176:179], a[252:255], v[136:139], v[176:179]
    ds_read_b128 a[244:247], v223 offset:27648
    v_mfma_f32_16x16x32_bf16 v[180:183], a[252:255], v[140:143], v[180:183]
    s_waitcnt lgkmcnt(7)
    ds_read_b128 a[212:215], v205 offset:18432
    v_mfma_f32_16x16x32_bf16 v[184:187], v[240:243], v[136:139], v[184:187]
    ds_read_b128 a[248:251], v219 offset:28672
    ds_read_b128 a[216:219], v205 offset:19456
    buffer_load_dwordx4 v218, s[4:7], s98 offen offset:2048 sc1 lds
    v_mfma_f32_16x16x32_bf16 v[188:191], v[240:243], v[140:143], v[188:191]
    s_waitcnt lgkmcnt(8)
    v_mfma_f32_16x16x32_bf16 v[192:195], v[244:247], v[136:139], v[192:195]
    ds_read_b128 a[252:255], v223 offset:29696
    ds_read_b128 a[220:223], v205 offset:20480
    v_mfma_f32_16x16x32_bf16 v[196:199], v[244:247], v[140:143], v[196:199]
    s_waitcnt lgkmcnt(8)
    ds_read_b128 a[224:227], v205 offset:21504
    v_mfma_f32_16x16x32_bf16 v[160:163], a[240:243], v[144:147], v[160:163]
    ds_read_b128 v[240:243], v223 offset:30720
    v_mfma_f32_16x16x32_bf16 v[164:167], a[240:243], v[148:151], v[164:167]
    s_waitcnt lgkmcnt(7)
    ds_read_b128 a[228:231], v205 offset:22528
    v_mfma_f32_16x16x32_bf16 v[168:171], a[244:247], v[144:147], v[168:171]
    ds_read_b128 v[244:247], v223 offset:31744
    ds_read_b128 a[232:235], v205 offset:23552
    v_mfma_f32_16x16x32_bf16 v[172:175], a[244:247], v[148:151], v[172:175]
    s_waitcnt lgkmcnt(8)
    v_lshrrev_b32 v248, 2, v218
    buffer_load_dwordx4 v218, s[4:7], s98 offen offset:3072 sc1 lds
    v_mfma_f32_16x16x32_bf16 v[176:179], a[248:251], v[144:147], v[176:179]
    ds_read_b128 a[240:243], v223 offset:32768
    ds_read_b128 a[236:239], v205 offset:24576
    v_mfma_f32_16x16x32_bf16 v[180:183], a[248:251], v[148:151], v[180:183]
    s_waitcnt lgkmcnt(8)
    v_add_u32 v248, 154624, v248
    v_mfma_f32_16x16x32_bf16 v[184:187], a[252:255], v[144:147], v[184:187]
    ds_read_b128 a[244:247], v219 offset:33792
    v_mfma_f32_16x16x32_bf16 v[188:191], a[252:255], v[148:151], v[188:191]
    s_waitcnt lgkmcnt(6)
    s_waitcnt vmcnt(15)
    v_lshlrev_b32 v200, 16, v200
    v_mfma_f32_16x16x32_bf16 v[192:195], v[240:243], v[144:147], v[192:195]
    s_add_u32 m0, m0, 4096
    ds_read_b128 a[248:251], v223 offset:34816
    s_add_u32 s98, s98, 4096
    v_mfma_f32_16x16x32_bf16 v[196:199], v[240:243], v[148:151], v[196:199]
    s_waitcnt lgkmcnt(5)
    ds_write_b32 v248, v200 offset:0
    v_mfma_f32_16x16x32_bf16 v[160:163], v[244:247], v[152:155], v[160:163]
    s_waitcnt vmcnt(14)
    v_lshlrev_b32 v201, 16, v201
    ds_read_b128 a[252:255], v223 offset:35840
    buffer_load_dwordx4 v218, s[4:7], s98 offen offset:0 sc1 lds
    v_mfma_f32_16x16x32_bf16 v[164:167], v[244:247], v[156:159], v[164:167]
    s_waitcnt lgkmcnt(5)
    ds_write_b32 v248, v201 offset:256
    v_mfma_f32_16x16x32_bf16 v[168:171], a[240:243], v[152:155], v[168:171]
    s_waitcnt vmcnt(14)
    v_lshlrev_b32 v202, 16, v202
    v_mfma_f32_16x16x32_bf16 v[172:175], a[240:243], v[156:159], v[172:175]
    s_waitcnt lgkmcnt(4)
    ds_write_b32 v248, v202 offset:512
    v_mfma_f32_16x16x32_bf16 v[176:179], a[244:247], v[152:155], v[176:179]
    s_waitcnt vmcnt(13)
    v_lshlrev_b32 v203, 16, v203
    ds_read_b128 v[204:207], v224
    v_mfma_f32_16x16x32_bf16 v[180:183], a[244:247], v[156:159], v[180:183]
    s_waitcnt lgkmcnt(5)
    ds_write_b32 v248, v203 offset:768
    v_mfma_f32_16x16x32_bf16 v[184:187], a[248:251], v[152:155], v[184:187]
    buffer_load_dwordx4 v218, s[4:7], s98 offen offset:1024 sc1 lds
    v_mfma_f32_16x16x32_bf16 v[188:191], a[248:251], v[156:159], v[188:191]
    s_waitcnt lgkmcnt(4)
    v_mfma_f32_16x16x32_bf16 v[192:195], a[252:255], v[152:155], v[192:195]
    v_mfma_f32_16x16x32_bf16 v[196:199], a[252:255], v[156:159], v[196:199]
    v_accvgpr_read_b32 v230, a100
    v_accvgpr_read_b32 v231, a101
    v_accvgpr_read_b32 v232, a102
    v_accvgpr_read_b32 v234, a104
    buffer_load_dwordx4 v218, s[4:7], s98 offen offset:2048 sc1 lds
    v_accvgpr_read_b32 v235, a105
    v_accvgpr_read_b32 v236, a106
    v_add_f32 v230, v230, v234
    v_add_f32 v231, v231, v235
    v_add_f32 v232, v232, v236
    v_accvgpr_read_b32 v234, a108
    v_accvgpr_read_b32 v235, a109
    v_accvgpr_read_b32 v236, a110
    v_add_f32 v230, v230, v234
    v_add_f32 v231, v231, v235
    v_add_f32 v232, v232, v236
    v_accvgpr_read_b32 v234, a112
    v_accvgpr_read_b32 v235, a113
    v_accvgpr_read_b32 v236, a114
    v_add_f32 v230, v230, v234
    v_add_f32 v231, v231, v235
    v_add_f32 v232, v232, v236
    v_accvgpr_read_b32 v234, a116
    v_accvgpr_read_b32 v235, a117
    v_accvgpr_read_b32 v236, a118
    v_add_f32 v230, v230, v234
    v_add_f32 v231, v231, v235
    v_add_f32 v232, v232, v236
    v_mov_b32 v234, v230
    v_mov_b32 v235, v231
    v_mov_b32 v236, v232
    buffer_load_dwordx4 v218, s[4:7], s98 offen offset:3072 sc1 lds
    v_permlane16_swap_b32 v230, v234
    v_permlane16_swap_b32 v231, v235
    v_permlane16_swap_b32 v232, v236
    v_add_f32 v230, v230, v234
    v_add_f32 v231, v231, v235
    v_add_f32 v232, v232, v236
    v_mov_b32 v234, v230
    v_mov_b32 v235, v231
    v_mov_b32 v236, v232
    v_permlane32_swap_b32 v230, v234
    v_permlane32_swap_b32 v231, v235
    v_permlane32_swap_b32 v232, v236
    v_add_f32 v230, v230, v234
    v_add_f32 v231, v231, v235
    v_add_f32 v232, v232, v236
    s_min_u32 s61, s24, 2
    v_lshrrev_b32 v234, 2, v218
    s_mov_b32 s35, 153920
    s_mov_b32 s60, 154048
    s_cmp_eq_u32 s61, 1
    s_cselect_b32 s35, 153600, s35
    s_cselect_b32 s60, 153728, s60
    s_cmp_eq_u32 s61, 2
    s_cselect_b32 s35, 153792, s35
    s_cselect_b32 s60, 153736, s60
    v_and_b32 v235, 0x34, v234
    v_add_u32 v235, s60, v235
    v_add_u32 v234, s35, v234
    s_mov_b64 exec, 0xffff
    ds_write2_b32 v234, v230, v231 offset0:0 offset1:16
    s_mov_b64 exec, 0xc3c3
    ds_write_b32 v235, v232
    s_mov_b64 exec, -1
    s_waitcnt lgkmcnt(0)
    s_barrier
    ds_read_b128 v[230:233], v225 offset:0
    s_add_u32 m0, m0, 4096
    s_add_u32 s98, s98, 4096
    buffer_load_dwordx4 v218, s[4:7], s98 offen offset:0 sc1 lds
    ds_read_b128 v[234:237], v225 offset:64
    ds_read_b128 v[248:251], v225 offset:128
    ds_read_b128 v[252:255], v225 offset:192
    ds_read_b128 v[200:203], v225 offset:256
    s_mov_b32 s90, 0xffff0000
    s_mov_b32 s91, 0xffff0000
    s_waitcnt lgkmcnt(4)
    v_pk_fma_f32 v[160:161], v[226:227], v[230:231], v[160:161] op_sel:[0,0,0] op_sel_hi:[0,1,1]
    v_pk_fma_f32 v[164:165], v[226:227], v[230:231], v[164:165] op_sel:[1,0,0] op_sel_hi:[1,1,1]
    v_pk_fma_f32 v[162:163], v[226:227], v[232:233], v[162:163] op_sel:[0,0,0] op_sel_hi:[0,1,1]
    v_pk_fma_f32 v[166:167], v[226:227], v[232:233], v[166:167] op_sel:[1,0,0] op_sel_hi:[1,1,1]
    s_waitcnt lgkmcnt(3)
    v_pk_fma_f32 v[168:169], v[226:227], v[234:235], v[168:169] op_sel:[0,0,0] op_sel_hi:[0,1,1]
    v_pk_fma_f32 v[172:173], v[226:227], v[234:235], v[172:173] op_sel:[1,0,0] op_sel_hi:[1,1,1]
    v_pk_fma_f32 v[170:171], v[226:227], v[236:237], v[170:171] op_sel:[0,0,0] op_sel_hi:[0,1,1]
    v_pk_fma_f32 v[174:175], v[226:227], v[236:237], v[174:175] op_sel:[1,0,0] op_sel_hi:[1,1,1]
    s_waitcnt lgkmcnt(2)
    v_pk_fma_f32 v[176:177], v[226:227], v[248:249], v[176:177] op_sel:[0,0,0] op_sel_hi:[0,1,1]
    v_pk_fma_f32 v[180:181], v[226:227], v[248:249], v[180:181] op_sel:[1,0,0] op_sel_hi:[1,1,1]
    v_pk_fma_f32 v[178:179], v[226:227], v[250:251], v[178:179] op_sel:[0,0,0] op_sel_hi:[0,1,1]
    v_pk_fma_f32 v[182:183], v[226:227], v[250:251], v[182:183] op_sel:[1,0,0] op_sel_hi:[1,1,1]
    s_waitcnt lgkmcnt(1)
    v_pk_fma_f32 v[184:185], v[226:227], v[252:253], v[184:185] op_sel:[0,0,0] op_sel_hi:[0,1,1]
    v_pk_fma_f32 v[188:189], v[226:227], v[252:253], v[188:189] op_sel:[1,0,0] op_sel_hi:[1,1,1]
    s_add_u32 s64, s68, 49152
    buffer_load_dword v220, v218, s[4:7], s68 offen offset:0 sc1
    buffer_load_dword v220, v218, s[4:7], s64 offen offset:0 sc1
    v_pk_fma_f32 v[186:187], v[226:227], v[254:255], v[186:187] op_sel:[0,0,0] op_sel_hi:[0,1,1]
    v_pk_fma_f32 v[190:191], v[226:227], v[254:255], v[190:191] op_sel:[1,0,0] op_sel_hi:[1,1,1]
    s_waitcnt lgkmcnt(0)
    v_pk_fma_f32 v[192:193], v[226:227], v[200:201], v[192:193] op_sel:[0,0,0] op_sel_hi:[0,1,1]
    v_pk_fma_f32 v[196:197], v[226:227], v[200:201], v[196:197] op_sel:[1,0,0] op_sel_hi:[1,1,1]
    v_pk_fma_f32 v[194:195], v[226:227], v[202:203], v[194:195] op_sel:[0,0,0] op_sel_hi:[0,1,1]
    v_pk_fma_f32 v[198:199], v[226:227], v[202:203], v[198:199] op_sel:[1,0,0] op_sel_hi:[1,1,1]
    v_cndmask_b32 v228, v228, v229, s[90:91]
    s_mul_i32 s35, s24, 9728
    v_permlane16_swap_b32 v160, v164
    s_add_u32 s64, s69, 49152
    s_mov_b64 exec, 0xffff
    buffer_load_dword v220, v218, s[4:7], s69 offen offset:0 sc1
    buffer_load_dword v220, v218, s[4:7], s64 offen offset:0 sc1
    s_mov_b64 exec, -1
    v_permlane16_swap_b32 v161, v165
    v_permlane16_swap_b32 v162, v166
    v_permlane16_swap_b32 v163, v167
    v_permlane16_swap_b32 v168, v172
    v_permlane16_swap_b32 v169, v173
    v_permlane16_swap_b32 v170, v174
    v_permlane16_swap_b32 v171, v175
    v_permlane16_swap_b32 v176, v180
    s_add_u32 s64, s80, 0
    buffer_load_dword v220, off, s[4:7], s64 offset:1024 sc1
    buffer_load_dword v220, off, s[4:7], s64 offset:3072 sc1
    v_permlane16_swap_b32 v177, v181
    v_permlane16_swap_b32 v178, v182
    v_permlane16_swap_b32 v179, v183
    v_permlane16_swap_b32 v184, v188
    v_permlane16_swap_b32 v185, v189
    v_permlane16_swap_b32 v186, v190
    v_permlane16_swap_b32 v187, v191
    v_permlane16_swap_b32 v192, v196
    v_permlane16_swap_b32 v193, v197
    v_permlane16_swap_b32 v194, v198
    buffer_load_dword v220, v218, s[4:7], s75 offen offset:0 sc1
    v_permlane16_swap_b32 v195, v199
    v_add_u32 v204, s35, v204
    v_add_u32 v205, s35, v205
    v_pk_mul_f32 v[184:185], v[184:185], v[228:229] op_sel_hi:[1,0]
    v_pk_mul_f32 v[186:187], v[186:187], v[228:229] op_sel_hi:[1,0]
    v_pk_mul_f32 v[188:189], v[188:189], v[228:229] op_sel_hi:[1,0]
    v_pk_mul_f32 v[190:191], v[190:191], v[228:229] op_sel_hi:[1,0]
    v_pk_mul_f32 v[192:193], v[192:193], v[228:229] op_sel_hi:[1,0]
    v_pk_mul_f32 v[194:195], v[194:195], v[228:229] op_sel_hi:[1,0]
    v_pk_mul_f32 v[196:197], v[196:197], v[228:229] op_sel_hi:[1,0]
    v_pk_mul_f32 v[198:199], v[198:199], v[228:229] op_sel_hi:[1,0]
    v_pk_mul_f32 v[178:179], v[178:179], v[228:229] op_sel_hi:[1,0]
    v_pk_mul_f32 v[182:183], v[182:183], v[228:229] op_sel_hi:[1,0]
    buffer_load_dword v220, v218, s[4:7], s75 offen offset:1024 sc1
    v_cvt_pk_bf16_f32 v184, v184, v185
    v_cvt_pk_bf16_f32 v185, v186, v187
    v_cvt_pk_bf16_f32 v186, v188, v189
    v_cvt_pk_bf16_f32 v187, v190, v191
    v_cvt_pk_bf16_f32 v188, v192, v193
    v_cvt_pk_bf16_f32 v189, v194, v195
    v_cvt_pk_bf16_f32 v190, v196, v197
    v_cvt_pk_bf16_f32 v191, v198, v199
    v_cvt_pk_bf16_f32 v192, v178, v179
    v_cvt_pk_bf16_f32 v193, v182, v183
    v_mov_b32 v194, 0x3f80
    v_mov_b32 v195, 0
    ds_write_b128 v205, v[184:187] offset:63648
    buffer_load_dword v220, v218, s[4:7], s76 offen offset:0 sc1
    v_max3_f32 v200, v160, v161, v162
    v_min3_f32 v201, v160, v161, v162
    v_max3_f32 v200, v200, v163, v164
    v_min3_f32 v201, v201, v163, v164
    v_max3_f32 v200, v200, v165, v166
    v_min3_f32 v201, v201, v165, v166
    v_max3_f32 v200, v200, v167, v168
    v_min3_f32 v201, v201, v167, v168
    v_max3_f32 v200, v200, v169, v170
    v_min3_f32 v201, v201, v169, v170
    v_max3_f32 v200, v200, v171, v172
    v_min3_f32 v201, v201, v171, v172
    v_max3_f32 v200, v200, v173, v174
    buffer_load_dword v220, v218, s[4:7], s77 offen offset:0 sc1
    v_min3_f32 v201, v201, v173, v174
    ds_write_b128 v205, v[188:191] offset:63664
    v_max3_f32 v200, v200, v175, v176
    v_min3_f32 v201, v201, v175, v176
    v_max3_f32 v200, v200, v177, v180
    v_min3_f32 v201, v201, v177, v180
    v_mul_f32 v202, 0x3fb8aa3b, v228
    v_max_f32 v200, v200, v181
    v_min_f32 v201, v201, v181
    v_pk_mul_f32 v[200:201], v[200:201], v[202:203] op_sel_hi:[1,0]
    v_pk_fma_f32 v[230:231], v[160:161], v[202:203], v[200:201] op_sel:[0,0,1] op_sel_hi:[1,0,1] neg_lo:[1,0,0] neg_hi:[1,0,0]
    v_pk_fma_f32 v[160:161], v[160:161], v[202:203], v[200:201] op_sel:[0,0,0] op_sel_hi:[1,0,0] neg_lo:[0,0,1] neg_hi:[0,0,1]
    v_pk_fma_f32 v[232:233], v[162:163], v[202:203], v[200:201] op_sel:[0,0,1] op_sel_hi:[1,0,1] neg_lo:[1,0,0] neg_hi:[1,0,0]
    s_add_u32 s64, s78, 0
    buffer_load_dword v220, off, s[4:7], s64 offset:2048 sc1
    v_pk_fma_f32 v[162:163], v[162:163], v[202:203], v[200:201] op_sel:[0,0,0] op_sel_hi:[1,0,0] neg_lo:[0,0,1] neg_hi:[0,0,1]
    v_pk_fma_f32 v[234:235], v[164:165], v[202:203], v[200:201] op_sel:[0,0,1] op_sel_hi:[1,0,1] neg_lo:[1,0,0] neg_hi:[1,0,0]
    v_pk_fma_f32 v[164:165], v[164:165], v[202:203], v[200:201] op_sel:[0,0,0] op_sel_hi:[1,0,0] neg_lo:[0,0,1] neg_hi:[0,0,1]
    ds_write_b128 v205, v[192:195] offset:63680
    v_pk_fma_f32 v[236:237], v[166:167], v[202:203], v[200:201] op_sel:[0,0,1] op_sel_hi:[1,0,1] neg_lo:[1,0,0] neg_hi:[1,0,0]
    v_pk_fma_f32 v[166:167], v[166:167], v[202:203], v[200:201] op_sel:[0,0,0] op_sel_hi:[1,0,0] neg_lo:[0,0,1] neg_hi:[0,0,1]
    v_pk_fma_f32 v[238:239], v[168:169], v[202:203], v[200:201] op_sel:[0,0,1] op_sel_hi:[1,0,1] neg_lo:[1,0,0] neg_hi:[1,0,0]
    v_pk_fma_f32 v[168:169], v[168:169], v[202:203], v[200:201] op_sel:[0,0,0] op_sel_hi:[1,0,0] neg_lo:[0,0,1] neg_hi:[0,0,1]
    v_pk_fma_f32 v[240:241], v[170:171], v[202:203], v[200:201] op_sel:[0,0,1] op_sel_hi:[1,0,1] neg_lo:[1,0,0] neg_hi:[1,0,0]
    v_pk_fma_f32 v[170:171], v[170:171], v[202:203], v[200:201] op_sel:[0,0,0] op_sel_hi:[1,0,0] neg_lo:[0,0,1] neg_hi:[0,0,1]
    v_pk_fma_f32 v[242:243], v[172:173], v[202:203], v[200:201] op_sel:[0,0,1] op_sel_hi:[1,0,1] neg_lo:[1,0,0] neg_hi:[1,0,0]
    v_pk_fma_f32 v[172:173], v[172:173], v[202:203], v[200:201] op_sel:[0,0,0] op_sel_hi:[1,0,0] neg_lo:[0,0,1] neg_hi:[0,0,1]
    s_add_u32 s100, s84, 0
    buffer_load_dwordx4 a[0:3], v218, s[4:7], s100 offen offset:0 sc1
    v_pk_fma_f32 v[244:245], v[174:175], v[202:203], v[200:201] op_sel:[0,0,1] op_sel_hi:[1,0,1] neg_lo:[1,0,0] neg_hi:[1,0,0]
    v_pk_fma_f32 v[174:175], v[174:175], v[202:203], v[200:201] op_sel:[0,0,0] op_sel_hi:[1,0,0] neg_lo:[0,0,1] neg_hi:[0,0,1]
    v_pk_fma_f32 v[246:247], v[176:177], v[202:203], v[200:201] op_sel:[0,0,1] op_sel_hi:[1,0,1] neg_lo:[1,0,0] neg_hi:[1,0,0]
    v_pk_fma_f32 v[176:177], v[176:177], v[202:203], v[200:201] op_sel:[0,0,0] op_sel_hi:[1,0,0] neg_lo:[0,0,1] neg_hi:[0,0,1]
    v_pk_fma_f32 v[248:249], v[180:181], v[202:203], v[200:201] op_sel:[0,0,1] op_sel_hi:[1,0,1] neg_lo:[1,0,0] neg_hi:[1,0,0]
    v_pk_fma_f32 v[180:181], v[180:181], v[202:203], v[200:201] op_sel:[0,0,0] op_sel_hi:[1,0,0] neg_lo:[0,0,1] neg_hi:[0,0,1]
    v_exp_f32 v160, v160
    v_exp_f32 v230, v230
    v_exp_f32 v161, v161
    v_exp_f32 v231, v231
    v_exp_f32 v162, v162
    buffer_load_dwordx4 a[4:7], v218, s[4:7], s100 offen offset:1024 sc1
    v_exp_f32 v232, v232
    v_exp_f32 v163, v163
    v_exp_f32 v233, v233
    v_exp_f32 v164, v164
    v_exp_f32 v234, v234
    v_exp_f32 v165, v165
    v_exp_f32 v235, v235
    v_exp_f32 v166, v166
    v_exp_f32 v236, v236
    buffer_load_dwordx4 a[8:11], v218, s[4:7], s100 offen offset:2048 sc1
    v_exp_f32 v167, v167
    v_exp_f32 v237, v237
    v_exp_f32 v168, v168
    v_exp_f32 v238, v238
    v_exp_f32 v169, v169
    v_exp_f32 v239, v239
    v_exp_f32 v170, v170
    v_exp_f32 v240, v240
    v_exp_f32 v171, v171
    buffer_load_dwordx4 a[12:15], v218, s[4:7], s100 offen offset:3072 sc1
    v_exp_f32 v241, v241
    v_exp_f32 v172, v172
    v_exp_f32 v242, v242
    v_exp_f32 v173, v173
    v_exp_f32 v243, v243
    v_exp_f32 v174, v174
    v_exp_f32 v244, v244
    v_exp_f32 v175, v175
    v_exp_f32 v245, v245
    s_add_u32 s100, s84, 4096
    buffer_load_dwordx4 a[16:19], v218, s[4:7], s100 offen offset:0 sc1
    v_exp_f32 v176, v176
    v_exp_f32 v246, v246
    v_exp_f32 v177, v177
    v_exp_f32 v247, v247
    v_exp_f32 v180, v180
    v_exp_f32 v248, v248
    v_exp_f32 v181, v181
    v_exp_f32 v249, v249
    buffer_load_dwordx4 a[20:23], v218, s[4:7], s100 offen offset:1024 sc1
    v_pk_add_f32 v[200:201], v[160:161], v[162:163]
    v_pk_add_f32 v[202:203], v[230:231], v[232:233]
    v_pk_add_f32 v[200:201], v[200:201], v[164:165]
    v_pk_add_f32 v[202:203], v[202:203], v[234:235]
    v_pk_add_f32 v[200:201], v[200:201], v[166:167]
    v_pk_add_f32 v[202:203], v[202:203], v[236:237]
    v_pk_add_f32 v[200:201], v[200:201], v[168:169]
    v_pk_add_f32 v[202:203], v[202:203], v[238:239]
    v_pk_add_f32 v[200:201], v[200:201], v[170:171]
    v_pk_add_f32 v[202:203], v[202:203], v[240:241]
    v_pk_add_f32 v[200:201], v[200:201], v[172:173]
    v_pk_add_f32 v[202:203], v[202:203], v[242:243]
    v_pk_add_f32 v[200:201], v[200:201], v[174:175]
    v_pk_add_f32 v[202:203], v[202:203], v[244:245]
    v_pk_add_f32 v[200:201], v[200:201], v[176:177]
    v_pk_add_f32 v[202:203], v[202:203], v[246:247]
    v_pk_add_f32 v[200:201], v[200:201], v[180:181]
    buffer_load_dwordx4 a[24:27], v218, s[4:7], s100 offen offset:2048 sc1
    v_pk_add_f32 v[202:203], v[202:203], v[248:249]
    v_add_f32 v200, v200, v201
    v_add_f32 v202, v202, v203
    v_rcp_f32 v200, v200
    v_rcp_f32 v202, v202
    s_nop 0
    v_pk_mul_f32 v[230:231], v[230:231], v[202:203] op_sel_hi:[1,0]
    v_pk_mul_f32 v[232:233], v[232:233], v[202:203] op_sel_hi:[1,0]
    v_pk_mul_f32 v[234:235], v[234:235], v[202:203] op_sel_hi:[1,0]
    v_pk_mul_f32 v[236:237], v[236:237], v[202:203] op_sel_hi:[1,0]
    v_pk_mul_f32 v[238:239], v[238:239], v[202:203] op_sel_hi:[1,0]
    v_pk_mul_f32 v[240:241], v[240:241], v[202:203] op_sel_hi:[1,0]
    v_pk_mul_f32 v[242:243], v[242:243], v[202:203] op_sel_hi:[1,0]
    v_pk_mul_f32 v[244:245], v[244:245], v[202:203] op_sel_hi:[1,0]
    v_pk_mul_f32 v[246:247], v[246:247], v[202:203] op_sel_hi:[1,0]
    buffer_load_dwordx4 a[28:31], v218, s[4:7], s100 offen offset:3072 sc1
    v_pk_mul_f32 v[248:249], v[248:249], v[202:203] op_sel_hi:[1,0]
    v_cvt_pk_bf16_f32 v249, v248, v249
    v_cvt_pk_bf16_f32 v248, v246, v247
    v_cvt_pk_bf16_f32 v247, v244, v245
    v_cvt_pk_bf16_f32 v246, v242, v243
    ds_write_b128 v204, v[246:249] offset:63552
    v_cvt_pk_bf16_f32 v245, v240, v241
    v_cvt_pk_bf16_f32 v244, v238, v239
    v_cvt_pk_bf16_f32 v243, v236, v237
    v_cvt_pk_bf16_f32 v242, v234, v235
    v_cvt_pk_bf16_f32 v241, v232, v233
    v_cvt_pk_bf16_f32 v240, v230, v231
    v_pk_mul_f32 v[160:161], v[160:161], v[200:201] op_sel_hi:[1,0]
    v_pk_mul_f32 v[162:163], v[162:163], v[200:201] op_sel_hi:[1,0]
    v_pk_mul_f32 v[164:165], v[164:165], v[200:201] op_sel_hi:[1,0]
    v_pk_mul_f32 v[166:167], v[166:167], v[200:201] op_sel_hi:[1,0]
    v_pk_mul_f32 v[168:169], v[168:169], v[200:201] op_sel_hi:[1,0]
    s_add_u32 s100, s84, 8192
    buffer_load_dwordx4 a[32:35], v218, s[4:7], s100 offen offset:0 sc1
    v_pk_mul_f32 v[170:171], v[170:171], v[200:201] op_sel_hi:[1,0]
    ds_write_b128 v204, v[242:245] offset:63536
    v_pk_mul_f32 v[172:173], v[172:173], v[200:201] op_sel_hi:[1,0]
    v_pk_mul_f32 v[174:175], v[174:175], v[200:201] op_sel_hi:[1,0]
    v_pk_mul_f32 v[176:177], v[176:177], v[200:201] op_sel_hi:[1,0]
    v_pk_mul_f32 v[180:181], v[180:181], v[200:201] op_sel_hi:[1,0]
    v_cvt_pk_bf16_f32 v238, v176, v177
    v_cvt_pk_bf16_f32 v239, v180, v181
    ds_write_b128 v204, v[238:241] offset:63520
    v_cvt_pk_bf16_f32 v230, v160, v161
    v_cvt_pk_bf16_f32 v231, v162, v163
    v_cvt_pk_bf16_f32 v232, v164, v165
    v_cvt_pk_bf16_f32 v233, v166, v167
    ds_write_b128 v204, v[230:233] offset:63488
    v_cvt_pk_bf16_f32 v234, v168, v169
    v_cvt_pk_bf16_f32 v235, v170, v171
    buffer_load_dwordx4 a[36:39], v218, s[4:7], s100 offen offset:1024 sc1
    v_cvt_pk_bf16_f32 v236, v172, v173
    v_cvt_pk_bf16_f32 v237, v174, v175
    ds_write_b128 v204, v[234:237] offset:63504
    s_mul_i32 s35, s24, 40
    s_add_u32 s35, s35, 63488
    s_lshr_b32 s60, s24, 1
    s_mul_i32 s60, s60, 48
    s_add_u32 s60, s60, 63648
    v_add_u32 v223, s35, v206
    v_add_u32 v219, s60, v207
    s_waitcnt lgkmcnt(0)
    s_barrier
    ds_read_b64_tr_b16 v[176:177], v223 offset:0
    buffer_load_dwordx4 a[40:43], v218, s[4:7], s100 offen offset:2048 sc1
    ds_read_b64_tr_b16 v[178:179], v223 offset:1216
    ds_read_b64_tr_b16 v[180:181], v219 offset:0
    ds_read_b64_tr_b16 v[182:183], v219 offset:1216
    ds_read_b64_tr_b16 v[184:185], v223 offset:4864
    ds_read_b64_tr_b16 v[186:187], v223 offset:6080
    ds_read_b64_tr_b16 v[188:189], v219 offset:4864
    ds_read_b64_tr_b16 v[190:191], v219 offset:6080
    ds_read_b64_tr_b16 v[192:193], v223 offset:9728
    ds_read_b64_tr_b16 v[194:195], v223 offset:10944
    ds_read_b64_tr_b16 v[196:197], v219 offset:9728
    ds_read_b64_tr_b16 v[198:199], v219 offset:10944
    s_waitcnt lgkmcnt(8)
    v_mfma_f32_32x32x16_bf16 v[160:175], v[176:179], v[180:183], 0
    ds_read_b64_tr_b16 v[200:201], v223 offset:14592
    ds_read_b64_tr_b16 v[202:203], v223 offset:15808
    ds_read_b64_tr_b16 v[204:205], v219 offset:14592
    buffer_load_dwordx4 a[44:47], v218, s[4:7], s100 offen offset:3072 sc1
    ds_read_b64_tr_b16 v[206:207], v219 offset:15808
    s_waitcnt lgkmcnt(8)
    v_mfma_f32_32x32x16_bf16 v[160:175], v[184:187], v[188:191], v[160:175]
    ds_read_b64_tr_b16 v[176:177], v223 offset:19456
    ds_read_b64_tr_b16 v[178:179], v223 offset:20672
    ds_read_b64_tr_b16 v[180:181], v219 offset:19456
    ds_read_b64_tr_b16 v[182:183], v219 offset:20672
    s_waitcnt lgkmcnt(8)
    v_mfma_f32_32x32x16_bf16 v[160:175], v[192:195], v[196:199], v[160:175]
    ds_read_b64_tr_b16 v[184:185], v223 offset:24320
    ds_read_b64_tr_b16 v[186:187], v223 offset:25536
    ds_read_b64_tr_b16 v[188:189], v219 offset:24320
    ds_read_b64_tr_b16 v[190:191], v219 offset:25536
    s_waitcnt lgkmcnt(8)
    v_mfma_f32_32x32x16_bf16 v[160:175], v[200:203], v[204:207], v[160:175]
    s_add_u32 s100, s84, 12288
    buffer_load_dwordx4 a[48:51], v218, s[4:7], s100 offen offset:0 sc1
    ds_read_b64_tr_b16 v[192:193], v223 offset:29184
    ds_read_b64_tr_b16 v[194:195], v223 offset:30400
    ds_read_b64_tr_b16 v[196:197], v219 offset:29184
    ds_read_b64_tr_b16 v[198:199], v219 offset:30400
    s_waitcnt lgkmcnt(8)
    v_mfma_f32_32x32x16_bf16 v[160:175], v[176:179], v[180:183], v[160:175]
    ds_read_b64_tr_b16 v[200:201], v223 offset:34048
    ds_read_b64_tr_b16 v[202:203], v223 offset:35264
    ds_read_b64_tr_b16 v[204:205], v219 offset:34048
    ds_read_b64_tr_b16 v[206:207], v219 offset:35264
    s_waitcnt lgkmcnt(8)
    v_mfma_f32_32x32x16_bf16 v[160:175], v[184:187], v[188:191], v[160:175]
    ds_read_b128 v[236:239], v224 offset:1024
    buffer_load_dwordx4 a[52:55], v218, s[4:7], s100 offen offset:1024 sc1
    s_waitcnt lgkmcnt(5)
    v_mfma_f32_32x32x16_bf16 v[160:175], v[192:195], v[196:199], v[160:175]
    s_waitcnt lgkmcnt(1)
    v_mfma_f32_32x32x16_bf16 v[160:175], v[200:203], v[204:207], v[160:175]
    s_mul_i32 s60, s24, 880
    s_add_u32 s60, s60, 155648
    s_add_u32 s35, s86, 0
    v_add_u32 v223, 102400, v218
    buffer_load_dwordx4 a[56:59], v218, s[4:7], s100 offen offset:2048 sc1
    s_waitcnt lgkmcnt(0)
    v_mov_b32 v219, v237
    v_add_u32 v236, s60, v236
    v_add_u32 v237, s60, v237
    s_mov_b32 exec_lo, 0x3fffff
    s_mov_b32 exec_hi, 0x3fffff
    s_nop 0
    v_cvt_pk_bf16_f32 v230, v160, v161
    v_cvt_pk_bf16_f32 v231, v162, v163
    v_cvt_pk_bf16_f32 v232, v164, v165
    v_cvt_pk_bf16_f32 v233, v166, v167
    ds_write2_b64 v236, v[230:231], v[232:233] offset0:0 offset1:2
    v_cvt_pk_bf16_f32 v234, v168, v169
    v_cvt_pk_bf16_f32 v235, v170, v171
    s_mov_b32 exec_hi, 0
    ds_write_b64 v236, v[234:235] offset:32
    s_mov_b32 exec_lo, 0xffffffff
    s_mov_b32 exec_hi, 0xffffff
    ds_read_b128 v[230:233], v237
    s_waitcnt lgkmcnt(0)
    v_min_u32 v230, -2, v230
    v_min_u32 v231, -2, v231
    v_min_u32 v232, -2, v232
    v_min_u32 v233, -2, v233
    buffer_store_dwordx4 v[230:233], v218, s[4:7], s35 offen sc1
    s_mov_b64 exec, -1
    s_waitcnt vmcnt(27)
    s_barrier
    ds_read_b128 a[240:243], v223 offset:0
    buffer_load_dwordx4 a[60:63], v218, s[4:7], s100 offen offset:3072 sc1
    ds_read_b128 a[244:247], v223 offset:1024
    ds_read_b128 a[248:251], v238 offset:2048
    ds_read_b128 a[252:255], v223 offset:2560
    s_waitcnt lgkmcnt(3)
    v_mfma_f32_16x16x32_bf16 v[164:167], a[240:243], v[0:3], 0
    ds_read_b128 v[240:243], v223 offset:3584
    v_mfma_f32_16x16x32_bf16 v[168:171], a[240:243], v[4:7], 0
    s_waitcnt lgkmcnt(3)
    v_mfma_f32_16x16x32_bf16 v[172:175], a[244:247], v[0:3], 0
    ds_read_b128 v[244:247], v238 offset:4608
    v_mfma_f32_16x16x32_bf16 v[176:179], a[244:247], v[4:7], 0
    s_waitcnt lgkmcnt(3)
    s_add_u32 s100, s84, 16384
    v_mfma_f32_16x16x32_bf16 v[180:183], a[248:251], v[0:3], 0
    ds_read_b128 a[240:243], v223 offset:5120
    v_mfma_f32_16x16x32_bf16 v[184:187], a[248:251], v[4:7], 0
    s_waitcnt lgkmcnt(3)
    buffer_load_dwordx4 a[64:67], v218, s[4:7], s100 offen offset:0 sc1
    v_mfma_f32_16x16x32_bf16 v[164:167], a[252:255], v[8:11], v[164:167]
    ds_read_b128 a[244:247], v223 offset:6144
    v_mfma_f32_16x16x32_bf16 v[168:171], a[252:255], v[12:15], v[168:171]
    s_waitcnt lgkmcnt(3)
    v_mfma_f32_16x16x32_bf16 v[172:175], v[240:243], v[8:11], v[172:175]
    ds_read_b128 a[248:251], v238 offset:7168
    v_mfma_f32_16x16x32_bf16 v[176:179], v[240:243], v[12:15], v[176:179]
    s_waitcnt lgkmcnt(3)
    buffer_load_dwordx4 a[68:71], v218, s[4:7], s100 offen offset:1024 sc1
    v_mfma_f32_16x16x32_bf16 v[180:183], v[244:247], v[8:11], v[180:183]
    ds_read_b128 a[252:255], v223 offset:7680
    v_mfma_f32_16x16x32_bf16 v[184:187], v[244:247], v[12:15], v[184:187]
    s_waitcnt lgkmcnt(3)
    v_mfma_f32_16x16x32_bf16 v[164:167], a[240:243], v[16:19], v[164:167]
    ds_read_b128 v[240:243], v223 offset:8704
    v_mfma_f32_16x16x32_bf16 v[168:171], a[240:243], v[20:23], v[168:171]
    s_waitcnt lgkmcnt(3)
    buffer_load_dwordx4 a[72:75], v218, s[4:7], s100 offen offset:2048 sc1
    v_mfma_f32_16x16x32_bf16 v[172:175], a[244:247], v[16:19], v[172:175]
    ds_read_b128 v[244:247], v238 offset:9728
    v_mfma_f32_16x16x32_bf16 v[176:179], a[244:247], v[20:23], v[176:179]
    s_waitcnt lgkmcnt(3)
    v_mfma_f32_16x16x32_bf16 v[180:183], a[248:251], v[16:19], v[180:183]
    ds_read_b128 a[240:243], v223 offset:10240
    v_mfma_f32_16x16x32_bf16 v[184:187], a[248:251], v[20:23], v[184:187]
    s_waitcnt lgkmcnt(3)
    v_mfma_f32_16x16x32_bf16 v[164:167], a[252:255], v[24:27], v[164:167]
    ds_read_b128 a[244:247], v223 offset:11264
    v_mfma_f32_16x16x32_bf16 v[168:171], a[252:255], v[28:31], v[168:171]
    s_waitcnt lgkmcnt(3)
    buffer_load_dwordx4 a[76:79], v218, s[4:7], s100 offen offset:3072 sc1
    v_mfma_f32_16x16x32_bf16 v[172:175], v[240:243], v[24:27], v[172:175]
    ds_read_b128 a[248:251], v238 offset:12288
    v_mfma_f32_16x16x32_bf16 v[176:179], v[240:243], v[28:31], v[176:179]
    s_waitcnt lgkmcnt(3)
    v_mfma_f32_16x16x32_bf16 v[180:183], v[244:247], v[24:27], v[180:183]
    ds_read_b128 a[252:255], v223 offset:12800
    v_mfma_f32_16x16x32_bf16 v[184:187], v[244:247], v[28:31], v[184:187]
    s_waitcnt lgkmcnt(3)
    s_add_u32 s100, s84, 20480
    v_mfma_f32_16x16x32_bf16 v[164:167], a[240:243], v[32:35], v[164:167]
    ds_read_b128 v[240:243], v223 offset:13824
    v_mfma_f32_16x16x32_bf16 v[168:171], a[240:243], v[36:39], v[168:171]
    s_waitcnt lgkmcnt(3)
    buffer_load_dwordx4 a[80:83], v218, s[4:7], s100 offen offset:0 sc1
    v_mfma_f32_16x16x32_bf16 v[172:175], a[244:247], v[32:35], v[172:175]
    ds_read_b128 v[244:247], v238 offset:14848
    v_mfma_f32_16x16x32_bf16 v[176:179], a[244:247], v[36:39], v[176:179]
    s_waitcnt lgkmcnt(3)
    v_mfma_f32_16x16x32_bf16 v[180:183], a[248:251], v[32:35], v[180:183]
    ds_read_b128 a[240:243], v223 offset:15360
    v_mfma_f32_16x16x32_bf16 v[184:187], a[248:251], v[36:39], v[184:187]
    s_waitcnt lgkmcnt(3)
    buffer_load_dwordx4 a[84:87], v218, s[4:7], s100 offen offset:1024 sc1
    v_mfma_f32_16x16x32_bf16 v[164:167], a[252:255], v[40:43], v[164:167]
    ds_read_b128 a[244:247], v223 offset:16384
    v_mfma_f32_16x16x32_bf16 v[168:171], a[252:255], v[44:47], v[168:171]
    s_waitcnt lgkmcnt(3)
    v_mfma_f32_16x16x32_bf16 v[172:175], v[240:243], v[40:43], v[172:175]
    ds_read_b128 a[248:251], v238 offset:17408
    v_mfma_f32_16x16x32_bf16 v[176:179], v[240:243], v[44:47], v[176:179]
    s_waitcnt lgkmcnt(3)
    buffer_load_dwordx4 a[88:91], v218, s[4:7], s100 offen offset:2048 sc1
    v_mfma_f32_16x16x32_bf16 v[180:183], v[244:247], v[40:43], v[180:183]
    ds_read_b128 a[252:255], v223 offset:17920
    v_mfma_f32_16x16x32_bf16 v[184:187], v[244:247], v[44:47], v[184:187]
    s_waitcnt lgkmcnt(3)
    v_mfma_f32_16x16x32_bf16 v[164:167], a[240:243], v[48:51], v[164:167]
    ds_read_b128 v[240:243], v223 offset:18944
    v_mfma_f32_16x16x32_bf16 v[168:171], a[240:243], v[52:55], v[168:171]
    s_waitcnt lgkmcnt(3)
    v_mfma_f32_16x16x32_bf16 v[172:175], a[244:247], v[48:51], v[172:175]
    ds_read_b128 v[244:247], v238 offset:19968
    v_mfma_f32_16x16x32_bf16 v[176:179], a[244:247], v[52:55], v[176:179]
    s_waitcnt lgkmcnt(3)
    buffer_load_dwordx4 a[92:95], v218, s[4:7], s100 offen offset:3072 sc1
    v_mfma_f32_16x16x32_bf16 v[180:183], a[248:251], v[48:51], v[180:183]
    ds_read_b128 a[240:243], v223 offset:20480
    v_mfma_f32_16x16x32_bf16 v[184:187], a[248:251], v[52:55], v[184:187]
    s_waitcnt lgkmcnt(3)
    v_mfma_f32_16x16x32_bf16 v[164:167], a[252:255], v[56:59], v[164:167]
    ds_read_b128 a[244:247], v223 offset:21504
    v_mfma_f32_16x16x32_bf16 v[168:171], a[252:255], v[60:63], v[168:171]
    s_waitcnt lgkmcnt(3)
    s_add_u32 s100, s84, 24576
    v_mfma_f32_16x16x32_bf16 v[172:175], v[240:243], v[56:59], v[172:175]
    ds_read_b128 a[248:251], v238 offset:22528
    v_mfma_f32_16x16x32_bf16 v[176:179], v[240:243], v[60:63], v[176:179]
    s_waitcnt lgkmcnt(3)
    buffer_load_dwordx4 a[96:99], v218, s[4:7], s100 offen offset:0 sc1
    v_mfma_f32_16x16x32_bf16 v[180:183], v[244:247], v[56:59], v[180:183]
    ds_read_b128 a[252:255], v223 offset:23040
    v_mfma_f32_16x16x32_bf16 v[184:187], v[244:247], v[60:63], v[184:187]
    s_waitcnt lgkmcnt(3)
    v_mfma_f32_16x16x32_bf16 v[164:167], a[240:243], v[64:67], v[164:167]
    s_mul_i32 s98, s24, 15360
    ds_read_b128 v[240:243], v223 offset:24064
    s_add_u32 m0, s98, 0
    v_mfma_f32_16x16x32_bf16 v[168:171], a[240:243], v[68:71], v[168:171]
    s_waitcnt lgkmcnt(3)
    s_add_u32 s98, m0, s83
    v_mfma_f32_16x16x32_bf16 v[172:175], a[244:247], v[64:67], v[172:175]
    ds_read_b128 v[244:247], v238 offset:25088
    v_mfma_f32_16x16x32_bf16 v[176:179], a[244:247], v[68:71], v[176:179]
    s_waitcnt lgkmcnt(3)
    buffer_load_dwordx4 v218, s[4:7], s98 offen offset:0 sc1 lds
    v_mfma_f32_16x16x32_bf16 v[180:183], a[248:251], v[64:67], v[180:183]
    ds_read_b128 a[240:243], v223 offset:25600
    v_mfma_f32_16x16x32_bf16 v[184:187], a[248:251], v[68:71], v[184:187]
    s_waitcnt lgkmcnt(3)
    v_mfma_f32_16x16x32_bf16 v[164:167], a[252:255], v[72:75], v[164:167]
    ds_read_b128 a[244:247], v223 offset:26624
    v_mfma_f32_16x16x32_bf16 v[168:171], a[252:255], v[76:79], v[168:171]
    s_waitcnt lgkmcnt(3)
    buffer_load_dwordx4 v218, s[4:7], s98 offen offset:1024 sc1 lds
    v_mfma_f32_16x16x32_bf16 v[172:175], v[240:243], v[72:75], v[172:175]
    ds_read_b128 a[248:251], v238 offset:27648
    v_mfma_f32_16x16x32_bf16 v[176:179], v[240:243], v[76:79], v[176:179]
    s_waitcnt lgkmcnt(3)
    v_mfma_f32_16x16x32_bf16 v[180:183], v[244:247], v[72:75], v[180:183]
    ds_read_b128 a[252:255], v223 offset:28160
    v_mfma_f32_16x16x32_bf16 v[184:187], v[244:247], v[76:79], v[184:187]
    s_waitcnt lgkmcnt(3)
    v_mfma_f32_16x16x32_bf16 v[164:167], a[240:243], v[80:83], v[164:167]
    ds_read_b128 v[240:243], v223 offset:29184
    v_mfma_f32_16x16x32_bf16 v[168:171], a[240:243], v[84:87], v[168:171]
    s_waitcnt lgkmcnt(3)
    v_mfma_f32_16x16x32_bf16 v[172:175], a[244:247], v[80:83], v[172:175]
    buffer_load_dwordx4 v218, s[4:7], s98 offen offset:2048 sc1 lds
    ds_read_b128 v[244:247], v238 offset:30208
    v_mfma_f32_16x16x32_bf16 v[176:179], a[244:247], v[84:87], v[176:179]
    s_waitcnt lgkmcnt(3)
    v_mfma_f32_16x16x32_bf16 v[180:183], a[248:251], v[80:83], v[180:183]
    s_add_u32 s99, s87, 0
    ds_read_b128 a[240:243], v223 offset:30720
    v_mfma_f32_16x16x32_bf16 v[184:187], a[248:251], v[84:87], v[184:187]
    s_waitcnt lgkmcnt(3)
    buffer_load_dwordx4 v[0:3], v219, s[4:7], s99 offen offset:0 sc1
    v_mfma_f32_16x16x32_bf16 v[164:167], a[252:255], v[88:91], v[164:167]
    ds_read_b128 a[244:247], v223 offset:31744
    v_mfma_f32_16x16x32_bf16 v[168:171], a[252:255], v[92:95], v[168:171]
    s_waitcnt lgkmcnt(3)
    v_mfma_f32_16x16x32_bf16 v[172:175], v[240:243], v[88:91], v[172:175]
    ds_read_b128 a[248:251], v238 offset:32768
    v_mfma_f32_16x16x32_bf16 v[176:179], v[240:243], v[92:95], v[176:179]
    s_waitcnt lgkmcnt(3)
    buffer_load_dwordx4 v[4:7], v219, s[4:7], s99 offen offset:1024 sc1
    v_mfma_f32_16x16x32_bf16 v[180:183], v[244:247], v[88:91], v[180:183]
    ds_read_b128 a[252:255], v223 offset:33280
    v_mfma_f32_16x16x32_bf16 v[184:187], v[244:247], v[92:95], v[184:187]
    s_waitcnt lgkmcnt(3)
    v_mfma_f32_16x16x32_bf16 v[164:167], a[240:243], v[96:99], v[164:167]
    ds_read_b128 v[240:243], v223 offset:34304
    v_mfma_f32_16x16x32_bf16 v[168:171], a[240:243], v[100:103], v[168:171]
    s_waitcnt lgkmcnt(3)
    v_mfma_f32_16x16x32_bf16 v[172:175], a[244:247], v[96:99], v[172:175]
    ds_read_b128 v[244:247], v238 offset:35328
    v_mfma_f32_16x16x32_bf16 v[176:179], a[244:247], v[100:103], v[176:179]
    s_waitcnt lgkmcnt(3)
    buffer_load_dwordx4 v[8:11], v219, s[4:7], s99 offen offset:2048 sc1
    v_mfma_f32_16x16x32_bf16 v[180:183], a[248:251], v[96:99], v[180:183]
    ds_read_b128 a[240:243], v223 offset:35840
    v_mfma_f32_16x16x32_bf16 v[184:187], a[248:251], v[100:103], v[184:187]
    s_waitcnt lgkmcnt(3)
    v_mfma_f32_16x16x32_bf16 v[164:167], a[252:255], v[104:107], v[164:167]
    ds_read_b128 a[244:247], v223 offset:36864
    v_mfma_f32_16x16x32_bf16 v[168:171], a[252:255], v[108:111], v[168:171]
    s_waitcnt lgkmcnt(3)
    buffer_load_dwordx4 v[12:15], v219, s[4:7], s99 offen offset:3072 sc1
    v_mfma_f32_16x16x32_bf16 v[172:175], v[240:243], v[104:107], v[172:175]
    ds_read_b128 a[248:251], v238 offset:37888
    v_mfma_f32_16x16x32_bf16 v[176:179], v[240:243], v[108:111], v[176:179]
    s_waitcnt lgkmcnt(3)
    v_mfma_f32_16x16x32_bf16 v[180:183], v[244:247], v[104:107], v[180:183]
    ds_read_b128 a[252:255], v223 offset:38400
    v_mfma_f32_16x16x32_bf16 v[184:187], v[244:247], v[108:111], v[184:187]
    s_waitcnt lgkmcnt(3)
    v_mfma_f32_16x16x32_bf16 v[164:167], a[240:243], v[112:115], v[164:167]
    s_add_u32 s99, s87, 4096
    ds_read_b128 v[240:243], v223 offset:39424
    v_mfma_f32_16x16x32_bf16 v[168:171], a[240:243], v[116:119], v[168:171]
    s_waitcnt lgkmcnt(3)
    buffer_load_dwordx4 v[16:19], v219, s[4:7], s99 offen offset:0 sc1
    v_mfma_f32_16x16x32_bf16 v[172:175], a[244:247], v[112:115], v[172:175]
    ds_read_b128 v[244:247], v238 offset:40448
    v_mfma_f32_16x16x32_bf16 v[176:179], a[244:247], v[116:119], v[176:179]
    s_waitcnt lgkmcnt(3)
    v_mfma_f32_16x16x32_bf16 v[180:183], a[248:251], v[112:115], v[180:183]
    ds_read_b128 a[240:243], v223 offset:40960
    v_mfma_f32_16x16x32_bf16 v[184:187], a[248:251], v[116:119], v[184:187]
    s_waitcnt lgkmcnt(3)
    buffer_load_dwordx4 v[20:23], v219, s[4:7], s99 offen offset:1024 sc1
    v_mfma_f32_16x16x32_bf16 v[164:167], a[252:255], v[120:123], v[164:167]
    ds_read_b128 a[244:247], v223 offset:41984
    v_mfma_f32_16x16x32_bf16 v[168:171], a[252:255], v[124:127], v[168:171]
    s_waitcnt lgkmcnt(3)
    v_mfma_f32_16x16x32_bf16 v[172:175], v[240:243], v[120:123], v[172:175]
    ds_read_b128 a[248:251], v238 offset:43008
    v_mfma_f32_16x16x32_bf16 v[176:179], v[240:243], v[124:127], v[176:179]
    s_waitcnt lgkmcnt(3)
    v_mfma_f32_16x16x32_bf16 v[180:183], v[244:247], v[120:123], v[180:183]
    ds_read_b128 a[252:255], v223 offset:43520
    v_mfma_f32_16x16x32_bf16 v[184:187], v[244:247], v[124:127], v[184:187]
    s_waitcnt lgkmcnt(3)
    buffer_load_dwordx4 v[24:27], v219, s[4:7], s99 offen offset:2048 sc1
    v_mfma_f32_16x16x32_bf16 v[164:167], a[240:243], v[128:131], v[164:167]
    ds_read_b128 v[240:243], v223 offset:44544
    v_mfma_f32_16x16x32_bf16 v[168:171], a[240:243], v[132:135], v[168:171]
    s_waitcnt lgkmcnt(3)
    v_mfma_f32_16x16x32_bf16 v[172:175], a[244:247], v[128:131], v[172:175]
    ds_read_b128 v[244:247], v238 offset:45568
    v_mfma_f32_16x16x32_bf16 v[176:179], a[244:247], v[132:135], v[176:179]
    s_waitcnt lgkmcnt(3)
    buffer_load_dwordx4 v[28:31], v219, s[4:7], s99 offen offset:3072 sc1
    v_mfma_f32_16x16x32_bf16 v[180:183], a[248:251], v[128:131], v[180:183]
    ds_read_b128 a[240:243], v223 offset:46080
    v_mfma_f32_16x16x32_bf16 v[184:187], a[248:251], v[132:135], v[184:187]
    s_waitcnt lgkmcnt(3)
    v_mfma_f32_16x16x32_bf16 v[164:167], a[252:255], v[136:139], v[164:167]
    ds_read_b128 a[244:247], v223 offset:47104
    v_mfma_f32_16x16x32_bf16 v[168:171], a[252:255], v[140:143], v[168:171]
    s_waitcnt lgkmcnt(3)
    ds_read_b128 v[188:191], v225 offset:320
    v_mfma_f32_16x16x32_bf16 v[172:175], v[240:243], v[136:139], v[172:175]
    s_add_u32 s99, s87, 8192
    ds_read_b128 a[248:251], v238 offset:48128
    v_mfma_f32_16x16x32_bf16 v[176:179], v[240:243], v[140:143], v[176:179]
    s_waitcnt lgkmcnt(4)
    ds_read_b128 v[192:195], v225 offset:384
    v_mfma_f32_16x16x32_bf16 v[180:183], v[244:247], v[136:139], v[180:183]
    ds_read_b128 a[252:255], v223 offset:48640
    v_mfma_f32_16x16x32_bf16 v[184:187], v[244:247], v[140:143], v[184:187]
    s_waitcnt lgkmcnt(5)
    ds_read_b128 v[196:199], v225 offset:448
    buffer_load_dwordx4 v[32:35], v219, s[4:7], s99 offen offset:0 sc1
    v_mfma_f32_16x16x32_bf16 v[164:167], a[240:243], v[144:147], v[164:167]
    ds_read_b128 v[240:243], v223 offset:49664
    v_mfma_f32_16x16x32_bf16 v[168:171], a[240:243], v[148:151], v[168:171]
    s_waitcnt lgkmcnt(6)
    buffer_load_dwordx4 v[36:39], v219, s[4:7], s99 offen offset:1024 sc1
    v_mfma_f32_16x16x32_bf16 v[172:175], a[244:247], v[144:147], v[172:175]
    ds_read_b128 v[244:247], v238 offset:50688
    v_mfma_f32_16x16x32_bf16 v[176:179], a[244:247], v[148:151], v[176:179]
    s_waitcnt lgkmcnt(5)
    ds_read_b64 v[250:251], v224 offset:3072
    v_mfma_f32_16x16x32_bf16 v[180:183], a[248:251], v[144:147], v[180:183]
    v_mfma_f32_16x16x32_bf16 v[184:187], a[248:251], v[148:151], v[184:187]
    s_waitcnt lgkmcnt(4)
    ds_read_b64 v[254:255], v224 offset:3072
    v_mfma_f32_16x16x32_bf16 v[164:167], a[252:255], v[152:155], v[164:167]
    buffer_load_dwordx4 v[40:43], v219, s[4:7], s99 offen offset:2048 sc1
    v_mfma_f32_16x16x32_bf16 v[168:171], a[252:255], v[156:159], v[168:171]
    s_waitcnt lgkmcnt(3)
    v_mov_b32 v252, 0
    v_mfma_f32_16x16x32_bf16 v[172:175], v[240:243], v[152:155], v[172:175]
    v_mfma_f32_16x16x32_bf16 v[176:179], v[240:243], v[156:159], v[176:179]
    s_waitcnt lgkmcnt(2)
    v_mov_b32 v253, 0
    v_mfma_f32_16x16x32_bf16 v[180:183], v[244:247], v[152:155], v[180:183]
    buffer_load_dwordx4 v[44:47], v219, s[4:7], s99 offen offset:3072 sc1
    v_mfma_f32_16x16x32_bf16 v[184:187], v[244:247], v[156:159], v[184:187]
    v_pk_fma_f32 v[164:165], v[226:227], v[188:189], v[164:165] op_sel:[0,0,0] op_sel_hi:[0,1,1]
    v_pk_fma_f32 v[168:169], v[226:227], v[188:189], v[168:169] op_sel:[1,0,0] op_sel_hi:[1,1,1]
    v_pk_fma_f32 v[166:167], v[226:227], v[190:191], v[166:167] op_sel:[0,0,0] op_sel_hi:[0,1,1]
    v_pk_fma_f32 v[170:171], v[226:227], v[190:191], v[170:171] op_sel:[1,0,0] op_sel_hi:[1,1,1]
    v_pk_fma_f32 v[172:173], v[226:227], v[192:193], v[172:173] op_sel:[0,0,0] op_sel_hi:[0,1,1]
    v_pk_fma_f32 v[176:177], v[226:227], v[192:193], v[176:177] op_sel:[1,0,0] op_sel_hi:[1,1,1]
    v_pk_fma_f32 v[174:175], v[226:227], v[194:195], v[174:175] op_sel:[0,0,0] op_sel_hi:[0,1,1]
    v_pk_fma_f32 v[178:179], v[226:227], v[194:195], v[178:179] op_sel:[1,0,0] op_sel_hi:[1,1,1]
    v_pk_fma_f32 v[180:181], v[226:227], v[196:197], v[180:181] op_sel:[0,0,0] op_sel_hi:[0,1,1]
    v_pk_fma_f32 v[184:185], v[226:227], v[196:197], v[184:185] op_sel:[1,0,0] op_sel_hi:[1,1,1]
    v_permlane16_swap_b32 v164, v168
    v_permlane16_swap_b32 v165, v169
    v_permlane16_swap_b32 v166, v170
    v_permlane16_swap_b32 v167, v171
    s_add_u32 s99, s87, 12288
    buffer_load_dwordx4 v[48:51], v219, s[4:7], s99 offen offset:0 sc1
    v_permlane16_swap_b32 v172, v176
    v_permlane16_swap_b32 v173, v177
    v_permlane16_swap_b32 v174, v178
    v_permlane16_swap_b32 v175, v179
    v_permlane16_swap_b32 v180, v184
    v_permlane16_swap_b32 v181, v185
    ds_read_b128 v[188:191], v224 offset:2048
    v_max3_f32 v182, v164, v165, v166
    v_min3_f32 v183, v164, v165, v166
    v_max3_f32 v182, v182, v167, v168
    v_min3_f32 v183, v183, v167, v168
    v_max3_f32 v182, v182, v169, v170
    v_min3_f32 v183, v183, v169, v170
    v_max3_f32 v182, v182, v171, v172
    v_min3_f32 v183, v183, v171, v172
    buffer_load_dwordx4 v[52:55], v219, s[4:7], s99 offen offset:1024 sc1
    v_max3_f32 v182, v182, v173, v174
    v_min3_f32 v183, v183, v173, v174
    v_max3_f32 v182, v182, v175, v176
    v_min3_f32 v183, v183, v175, v176
    v_max3_f32 v182, v182, v177, v178
    v_min3_f32 v183, v183, v177, v178
    v_max3_f32 v182, v182, v179, v180
    v_min3_f32 v183, v183, v179, v180
    v_max3_f32 v182, v182, v181, v184
    v_min3_f32 v183, v183, v181, v184
    v_mul_f32 v186, 0x3fb8aa3b, v228
    v_max_f32 v182, v182, v185
    v_min_f32 v183, v183, v185
    v_pk_mul_f32 v[182:183], v[182:183], v[186:187] op_sel_hi:[1,0]
    v_pk_fma_f32 v[230:231], v[164:165], v[186:187], v[182:183] op_sel:[0,0,1] op_sel_hi:[1,0,1] neg_lo:[1,0,0] neg_hi:[1,0,0]
    v_pk_fma_f32 v[164:165], v[164:165], v[186:187], v[182:183] op_sel:[0,0,0] op_sel_hi:[1,0,0] neg_lo:[0,0,1] neg_hi:[0,0,1]
    buffer_load_dwordx4 v[56:59], v219, s[4:7], s99 offen offset:2048 sc1
    v_pk_fma_f32 v[232:233], v[166:167], v[186:187], v[182:183] op_sel:[0,0,1] op_sel_hi:[1,0,1] neg_lo:[1,0,0] neg_hi:[1,0,0]
    v_pk_fma_f32 v[166:167], v[166:167], v[186:187], v[182:183] op_sel:[0,0,0] op_sel_hi:[1,0,0] neg_lo:[0,0,1] neg_hi:[0,0,1]
    v_pk_fma_f32 v[234:235], v[168:169], v[186:187], v[182:183] op_sel:[0,0,1] op_sel_hi:[1,0,1] neg_lo:[1,0,0] neg_hi:[1,0,0]
    v_pk_fma_f32 v[168:169], v[168:169], v[186:187], v[182:183] op_sel:[0,0,0] op_sel_hi:[1,0,0] neg_lo:[0,0,1] neg_hi:[0,0,1]
    v_pk_fma_f32 v[236:237], v[170:171], v[186:187], v[182:183] op_sel:[0,0,1] op_sel_hi:[1,0,1] neg_lo:[1,0,0] neg_hi:[1,0,0]
    v_pk_fma_f32 v[170:171], v[170:171], v[186:187], v[182:183] op_sel:[0,0,0] op_sel_hi:[1,0,0] neg_lo:[0,0,1] neg_hi:[0,0,1]
    v_pk_fma_f32 v[238:239], v[172:173], v[186:187], v[182:183] op_sel:[0,0,1] op_sel_hi:[1,0,1] neg_lo:[1,0,0] neg_hi:[1,0,0]
    v_pk_fma_f32 v[172:173], v[172:173], v[186:187], v[182:183] op_sel:[0,0,0] op_sel_hi:[1,0,0] neg_lo:[0,0,1] neg_hi:[0,0,1]
    v_pk_fma_f32 v[240:241], v[174:175], v[186:187], v[182:183] op_sel:[0,0,1] op_sel_hi:[1,0,1] neg_lo:[1,0,0] neg_hi:[1,0,0]
    v_pk_fma_f32 v[174:175], v[174:175], v[186:187], v[182:183] op_sel:[0,0,0] op_sel_hi:[1,0,0] neg_lo:[0,0,1] neg_hi:[0,0,1]
    v_pk_fma_f32 v[242:243], v[176:177], v[186:187], v[182:183] op_sel:[0,0,1] op_sel_hi:[1,0,1] neg_lo:[1,0,0] neg_hi:[1,0,0]
    v_pk_fma_f32 v[176:177], v[176:177], v[186:187], v[182:183] op_sel:[0,0,0] op_sel_hi:[1,0,0] neg_lo:[0,0,1] neg_hi:[0,0,1]
    v_pk_fma_f32 v[244:245], v[178:179], v[186:187], v[182:183] op_sel:[0,0,1] op_sel_hi:[1,0,1] neg_lo:[1,0,0] neg_hi:[1,0,0]
    v_pk_fma_f32 v[178:179], v[178:179], v[186:187], v[182:183] op_sel:[0,0,0] op_sel_hi:[1,0,0] neg_lo:[0,0,1] neg_hi:[0,0,1]
    v_pk_fma_f32 v[246:247], v[180:181], v[186:187], v[182:183] op_sel:[0,0,1] op_sel_hi:[1,0,1] neg_lo:[1,0,0] neg_hi:[1,0,0]
    v_pk_fma_f32 v[180:181], v[180:181], v[186:187], v[182:183] op_sel:[0,0,0] op_sel_hi:[1,0,0] neg_lo:[0,0,1] neg_hi:[0,0,1]
    buffer_load_dwordx4 v[60:63], v219, s[4:7], s99 offen offset:3072 sc1
    v_pk_fma_f32 v[248:249], v[184:185], v[186:187], v[182:183] op_sel:[0,0,1] op_sel_hi:[1,0,1] neg_lo:[1,0,0] neg_hi:[1,0,0]
    v_pk_fma_f32 v[184:185], v[184:185], v[186:187], v[182:183] op_sel:[0,0,0] op_sel_hi:[1,0,0] neg_lo:[0,0,1] neg_hi:[0,0,1]
    v_exp_f32 v164, v164
    v_exp_f32 v230, v230
    v_exp_f32 v165, v165
    v_exp_f32 v231, v231
    v_exp_f32 v166, v166
    v_exp_f32 v232, v232
    v_exp_f32 v167, v167
    buffer_load_dwordx4 v218, s[4:7], s98 offen offset:3072 sc1 lds
    v_exp_f32 v233, v233
    v_exp_f32 v168, v168
    v_exp_f32 v234, v234
    v_exp_f32 v169, v169
    v_exp_f32 v235, v235
    v_exp_f32 v170, v170
    v_exp_f32 v236, v236
    v_exp_f32 v171, v171
    v_exp_f32 v237, v237
    v_exp_f32 v172, v172
    v_exp_f32 v238, v238
    v_exp_f32 v173, v173
    v_exp_f32 v239, v239
    s_add_u32 m0, m0, 4096
    s_add_u32 s98, s98, 4096
    buffer_load_dwordx4 v218, s[4:7], s98 offen offset:0 sc1 lds
    v_exp_f32 v174, v174
    v_exp_f32 v240, v240
    v_exp_f32 v175, v175
    v_exp_f32 v241, v241
    v_exp_f32 v176, v176
    v_exp_f32 v242, v242
    v_exp_f32 v177, v177
    v_exp_f32 v243, v243
    s_mov_b32 s65, 262144
    s_waitcnt vmcnt(12)
L_kvagain_3:
    v_max_u32 v192, v0, v20
    v_max3_u32 v192, v192, v4, v8
    v_max3_u32 v192, v192, v12, v16
    v_cmp_eq_u32 vcc, -1, v192
    s_cbranch_vccz L_kvhave_4
    s_add_u32 s61, s87, 0
    v_cmp_eq_u32 vcc, -1, v0
    s_mov_b64 exec, vcc
    buffer_load_dwordx4 v[0:3], v219, s[4:7], s61 offen offset:0 sc1
    s_mov_b64 exec, -1
    v_cmp_eq_u32 vcc, -1, v4
    s_mov_b64 exec, vcc
    buffer_load_dwordx4 v[4:7], v219, s[4:7], s61 offen offset:1024 sc1
    s_mov_b64 exec, -1
    v_cmp_eq_u32 vcc, -1, v8
    s_mov_b64 exec, vcc
    buffer_load_dwordx4 v[8:11], v219, s[4:7], s61 offen offset:2048 sc1
    s_mov_b64 exec, -1
    v_cmp_eq_u32 vcc, -1, v12
    s_mov_b64 exec, vcc
    buffer_load_dwordx4 v[12:15], v219, s[4:7], s61 offen offset:3072 sc1
    s_mov_b64 exec, -1
    s_add_u32 s61, s87, 4096
    v_cmp_eq_u32 vcc, -1, v16
    s_mov_b64 exec, vcc
    buffer_load_dwordx4 v[16:19], v219, s[4:7], s61 offen offset:0 sc1
    s_mov_b64 exec, -1
    v_cmp_eq_u32 vcc, -1, v20
    s_mov_b64 exec, vcc
    buffer_load_dwordx4 v[20:23], v219, s[4:7], s61 offen offset:1024 sc1
    s_mov_b64 exec, -1
    s_sub_u32 s65, s65, 1
    s_waitcnt vmcnt(0)
    s_cbranch_scc0 L_kvagain_3
L_kvhave_4:
    s_waitcnt lgkmcnt(2)
    v_mfma_f32_16x16x32_bf16 v[200:203], v[250:253], v[0:3], 0
    buffer_load_dwordx4 v218, s[4:7], s98 offen offset:1024 sc1 lds
    v_exp_f32 v178, v178
    s_waitcnt lgkmcnt(1)
    v_mfma_f32_16x16x32_bf16 v[204:207], v[252:255], v[0:3], 0
    v_exp_f32 v244, v244
    v_mfma_f32_16x16x32_bf16 v[200:203], v[250:253], v[4:7], v[200:203]
    v_exp_f32 v179, v179
    v_mfma_f32_16x16x32_bf16 v[204:207], v[252:255], v[4:7], v[204:207]
    v_exp_f32 v245, v245
    v_mfma_f32_16x16x32_bf16 v[200:203], v[250:253], v[8:11], v[200:203]
    v_exp_f32 v180, v180
    v_mfma_f32_16x16x32_bf16 v[204:207], v[252:255], v[8:11], v[204:207]
    v_exp_f32 v246, v246
    v_mfma_f32_16x16x32_bf16 v[200:203], v[250:253], v[12:15], v[200:203]
    v_exp_f32 v181, v181
    buffer_load_dwordx4 v218, s[4:7], s98 offen offset:2048 sc1 lds
    v_mfma_f32_16x16x32_bf16 v[204:207], v[252:255], v[12:15], v[204:207]
    v_exp_f32 v247, v247
    v_mfma_f32_16x16x32_bf16 v[200:203], v[250:253], v[16:19], v[200:203]
    v_exp_f32 v184, v184
    v_mfma_f32_16x16x32_bf16 v[204:207], v[252:255], v[16:19], v[204:207]
    v_exp_f32 v248, v248
    v_mfma_f32_16x16x32_bf16 v[200:203], v[250:253], v[20:23], v[200:203]
    v_exp_f32 v185, v185
    v_mfma_f32_16x16x32_bf16 v[204:207], v[252:255], v[20:23], v[204:207]
    v_exp_f32 v249, v249
    v_pk_add_f32 v[182:183], v[164:165], v[166:167]
    v_pk_add_f32 v[186:187], v[230:231], v[232:233]
    v_pk_add_f32 v[182:183], v[182:183], v[168:169]
    v_pk_add_f32 v[186:187], v[186:187], v[234:235]
    v_pk_add_f32 v[182:183], v[182:183], v[170:171]
    v_pk_add_f32 v[186:187], v[186:187], v[236:237]
    buffer_load_dwordx4 v218, s[4:7], s98 offen offset:3072 sc1 lds
    v_pk_add_f32 v[182:183], v[182:183], v[172:173]
    v_pk_add_f32 v[186:187], v[186:187], v[238:239]
    v_pk_add_f32 v[182:183], v[182:183], v[174:175]
    v_pk_add_f32 v[186:187], v[186:187], v[240:241]
    v_pk_add_f32 v[182:183], v[182:183], v[176:177]
    v_pk_add_f32 v[186:187], v[186:187], v[242:243]
    v_pk_add_f32 v[182:183], v[182:183], v[178:179]
    v_pk_add_f32 v[186:187], v[186:187], v[244:245]
    v_pk_add_f32 v[182:183], v[182:183], v[180:181]
    v_pk_add_f32 v[186:187], v[186:187], v[246:247]
    v_pk_add_f32 v[182:183], v[182:183], v[184:185]
    v_pk_add_f32 v[186:187], v[186:187], v[248:249]
    v_add_f32 v182, v182, v183
    v_add_f32 v186, v186, v187
    v_rcp_f32 v182, v182
    v_rcp_f32 v186, v186
    v_pk_mul_f32 v[164:165], v[164:165], v[182:183] op_sel_hi:[1,0]
    v_pk_mul_f32 v[230:231], v[230:231], v[186:187] op_sel_hi:[1,0]
    v_pk_mul_f32 v[166:167], v[166:167], v[182:183] op_sel_hi:[1,0]
    v_pk_mul_f32 v[232:233], v[232:233], v[186:187] op_sel_hi:[1,0]
    v_pk_mul_f32 v[168:169], v[168:169], v[182:183] op_sel_hi:[1,0]
    v_pk_mul_f32 v[234:235], v[234:235], v[186:187] op_sel_hi:[1,0]
    v_pk_mul_f32 v[170:171], v[170:171], v[182:183] op_sel_hi:[1,0]
    v_pk_mul_f32 v[236:237], v[236:237], v[186:187] op_sel_hi:[1,0]
    s_add_u32 m0, m0, 4096
    s_add_u32 s98, s98, 4096
    buffer_load_dwordx4 v218, s[4:7], s98 offen offset:0 sc1 lds
    v_pk_mul_f32 v[172:173], v[172:173], v[182:183] op_sel_hi:[1,0]
    v_pk_mul_f32 v[238:239], v[238:239], v[186:187] op_sel_hi:[1,0]
    v_pk_mul_f32 v[174:175], v[174:175], v[182:183] op_sel_hi:[1,0]
    v_pk_mul_f32 v[240:241], v[240:241], v[186:187] op_sel_hi:[1,0]
    v_pk_mul_f32 v[176:177], v[176:177], v[182:183] op_sel_hi:[1,0]
    v_pk_mul_f32 v[242:243], v[242:243], v[186:187] op_sel_hi:[1,0]
    v_pk_mul_f32 v[178:179], v[178:179], v[182:183] op_sel_hi:[1,0]
    v_pk_mul_f32 v[244:245], v[244:245], v[186:187] op_sel_hi:[1,0]
    v_pk_mul_f32 v[180:181], v[180:181], v[182:183] op_sel_hi:[1,0]
    v_pk_mul_f32 v[246:247], v[246:247], v[186:187] op_sel_hi:[1,0]
    v_pk_mul_f32 v[184:185], v[184:185], v[182:183] op_sel_hi:[1,0]
    v_pk_mul_f32 v[248:249], v[248:249], v[186:187] op_sel_hi:[1,0]
    v_cvt_pk_bf16_f32 v164, v164, v165
    v_cvt_pk_bf16_f32 v165, v166, v167
    v_cvt_pk_bf16_f32 v166, v168, v169
    v_cvt_pk_bf16_f32 v167, v170, v171
    v_cvt_pk_bf16_f32 v168, v172, v173
    v_cvt_pk_bf16_f32 v169, v174, v175
    v_cvt_pk_bf16_f32 v170, v176, v177
    v_cvt_pk_bf16_f32 v171, v178, v179
    v_cvt_pk_bf16_f32 v172, v180, v181
    v_cvt_pk_bf16_f32 v173, v184, v185
    v_cvt_pk_bf16_f32 v174, v230, v231
    v_cvt_pk_bf16_f32 v175, v232, v233
    buffer_load_dwordx4 v218, s[4:7], s98 offen offset:1024 sc1 lds
    v_cvt_pk_bf16_f32 v176, v234, v235
    v_cvt_pk_bf16_f32 v177, v236, v237
    v_cvt_pk_bf16_f32 v178, v238, v239
    v_cvt_pk_bf16_f32 v179, v240, v241
    v_cvt_pk_bf16_f32 v180, v242, v243
    v_cvt_pk_bf16_f32 v181, v244, v245
    v_cvt_pk_bf16_f32 v182, v246, v247
    v_cvt_pk_bf16_f32 v183, v248, v249
    s_mov_b32 s65, 262144
    s_waitcnt vmcnt(11)
L_kvagain_5:
    v_max_u32 v192, v24, v44
    v_max3_u32 v192, v192, v28, v32
    v_max3_u32 v192, v192, v36, v40
    v_cmp_eq_u32 vcc, -1, v192
    s_cbranch_vccz L_kvhave_6
    s_add_u32 s61, s87, 4096
    v_cmp_eq_u32 vcc, -1, v24
    s_mov_b64 exec, vcc
    buffer_load_dwordx4 v[24:27], v219, s[4:7], s61 offen offset:2048 sc1
    s_mov_b64 exec, -1
    v_cmp_eq_u32 vcc, -1, v28
    s_mov_b64 exec, vcc
    buffer_load_dwordx4 v[28:31], v219, s[4:7], s61 offen offset:3072 sc1
    s_mov_b64 exec, -1
    s_add_u32 s61, s87, 8192
    v_cmp_eq_u32 vcc, -1, v32
    s_mov_b64 exec, vcc
    buffer_load_dwordx4 v[32:35], v219, s[4:7], s61 offen offset:0 sc1
    s_mov_b64 exec, -1
    v_cmp_eq_u32 vcc, -1, v36
    s_mov_b64 exec, vcc
    buffer_load_dwordx4 v[36:39], v219, s[4:7], s61 offen offset:1024 sc1
    s_mov_b64 exec, -1
    v_cmp_eq_u32 vcc, -1, v40
    s_mov_b64 exec, vcc
    buffer_load_dwordx4 v[40:43], v219, s[4:7], s61 offen offset:2048 sc1
    s_mov_b64 exec, -1
    v_cmp_eq_u32 vcc, -1, v44
    s_mov_b64 exec, vcc
    buffer_load_dwordx4 v[44:47], v219, s[4:7], s61 offen offset:3072 sc1
    s_mov_b64 exec, -1
    s_sub_u32 s65, s65, 1
    s_waitcnt vmcnt(0)
    s_cbranch_scc0 L_kvagain_5
L_kvhave_6:
    v_mfma_f32_16x16x32_bf16 v[200:203], v[250:253], v[24:27], v[200:203]
    buffer_load_dwordx4 v218, s[4:7], s98 offen offset:2048 sc1 lds
    v_mfma_f32_16x16x32_bf16 v[204:207], v[252:255], v[24:27], v[204:207]
    v_mfma_f32_16x16x32_bf16 v[200:203], v[250:253], v[28:31], v[200:203]
    v_mfma_f32_16x16x32_bf16 v[204:207], v[252:255], v[28:31], v[204:207]
    v_mfma_f32_16x16x32_bf16 v[200:203], v[250:253], v[32:35], v[200:203]
    v_mfma_f32_16x16x32_bf16 v[204:207], v[252:255], v[32:35], v[204:207]
    v_mfma_f32_16x16x32_bf16 v[200:203], v[250:253], v[36:39], v[200:203]
    v_mfma_f32_16x16x32_bf16 v[204:207], v[252:255], v[36:39], v[204:207]
    buffer_load_dwordx4 v218, s[4:7], s98 offen offset:3072 sc1 lds
    v_mfma_f32_16x16x32_bf16 v[200:203], v[250:253], v[40:43], v[200:203]
    v_mfma_f32_16x16x32_bf16 v[204:207], v[252:255], v[40:43], v[204:207]
    v_mfma_f32_16x16x32_bf16 v[200:203], v[250:253], v[44:47], v[200:203]
    v_mfma_f32_16x16x32_bf16 v[204:207], v[252:255], v[44:47], v[204:207]
    s_mov_b32 s65, 262144
    s_waitcnt vmcnt(9)
L_kvagain_7:
    v_max_u32 v192, v48, v60
    v_max3_u32 v192, v192, v52, v56
    v_cmp_eq_u32 vcc, -1, v192
    s_cbranch_vccz L_kvhave_8
    s_add_u32 s61, s87, 12288
    v_cmp_eq_u32 vcc, -1, v48
    s_mov_b64 exec, vcc
    buffer_load_dwordx4 v[48:51], v219, s[4:7], s61 offen offset:0 sc1
    s_mov_b64 exec, -1
    v_cmp_eq_u32 vcc, -1, v52
    s_mov_b64 exec, vcc
    buffer_load_dwordx4 v[52:55], v219, s[4:7], s61 offen offset:1024 sc1
    s_mov_b64 exec, -1
    v_cmp_eq_u32 vcc, -1, v56
    s_mov_b64 exec, vcc
    buffer_load_dwordx4 v[56:59], v219, s[4:7], s61 offen offset:2048 sc1
    s_mov_b64 exec, -1
    v_cmp_eq_u32 vcc, -1, v60
    s_mov_b64 exec, vcc
    buffer_load_dwordx4 v[60:63], v219, s[4:7], s61 offen offset:3072 sc1
    s_mov_b64 exec, -1
    s_sub_u32 s65, s65, 1
    s_waitcnt vmcnt(0)
    s_cbranch_scc0 L_kvagain_7
L_kvhave_8:
    v_mfma_f32_16x16x32_bf16 v[200:203], v[250:253], v[48:51], v[200:203]
    s_add_u32 m0, m0, 4096
    s_add_u32 s98, s98, 4096
    buffer_load_dwordx4 v218, s[4:7], s98 offen offset:0 sc1 lds
    v_mfma_f32_16x16x32_bf16 v[204:207], v[252:255], v[48:51], v[204:207]
    v_mfma_f32_16x16x32_bf16 v[200:203], v[250:253], v[52:55], v[200:203]
    v_mfma_f32_16x16x32_bf16 v[204:207], v[252:255], v[52:55], v[204:207]
    v_mfma_f32_16x16x32_bf16 v[200:203], v[250:253], v[56:59], v[200:203]
    v_mfma_f32_16x16x32_bf16 v[204:207], v[252:255], v[56:59], v[204:207]
    v_mfma_f32_16x16x32_bf16 v[200:203], v[250:253], v[60:63], v[200:203]
    v_mfma_f32_16x16x32_bf16 v[204:207], v[252:255], v[60:63], v[204:207]
    buffer_load_dwordx4 v218, s[4:7], s98 offen offset:1024 sc1 lds
    s_mul_i32 s35, s24, 880
    s_add_u32 s35, s35, 155648
    v_add_u32 v223, s35, v219
    s_nop 3
    v_cmp_u_f32 vcc, v204, v204
    s_cbranch_vccnz L_kvretry_9
L_kvok_10:
    v_cvt_pk_bf16_f32 v192, v200, v201
    v_cvt_pk_bf16_f32 v193, v202, v203
    v_cvt_pk_bf16_f32 v194, v204, v205
    v_cvt_pk_bf16_f32 v195, v206, v207
    ds_write_b128 v223, v[192:195]
    s_waitcnt lgkmcnt(0)
    s_barrier
    ds_read2_b64 v[4:7], v189 offset0:0 offset1:1
    buffer_load_dwordx4 v218, s[4:7], s98 offen offset:2048 sc1 lds
    ds_read2_b64 v[0:3], v188 offset0:0 offset1:1
    ds_read2_b64 v[12:15], v189 offset0:2 offset1:3
    ds_read2_b64 v[8:11], v188 offset0:2 offset1:3
    ds_read2_b64 v[20:23], v189 offset0:4 offset1:110
    ds_read2_b64 v[16:19], v188 offset0:4 offset1:110
    ds_read2_b64 v[28:31], v189 offset0:111 offset1:112
    ds_read2_b64 v[24:27], v188 offset0:111 offset1:112
    ds_read2_b64 v[36:39], v189 offset0:113 offset1:114
    ds_read2_b64 v[32:35], v188 offset0:113 offset1:114
    s_waitcnt lgkmcnt(9)
    v_mfma_f32_32x32x16_bf16 v[230:245], v[4:7], v[164:167], 0
    s_waitcnt lgkmcnt(8)
    v_mfma_f32_32x32x16_bf16 v[40:55], v[0:3], v[164:167], 0
    s_waitcnt lgkmcnt(7)
    v_mfma_f32_32x32x16_bf16 v[230:245], v[12:15], v[168:171], v[230:245]
    s_waitcnt lgkmcnt(6)
    v_mfma_f32_32x32x16_bf16 v[40:55], v[8:11], v[168:171], v[40:55]
    s_waitcnt lgkmcnt(5)
    v_mfma_f32_32x32x16_bf16 v[230:245], v[20:23], v[172:175], v[230:245]
    s_waitcnt lgkmcnt(4)
    v_mfma_f32_32x32x16_bf16 v[40:55], v[16:19], v[172:175], v[40:55]
    s_waitcnt lgkmcnt(3)
    v_mfma_f32_32x32x16_bf16 v[230:245], v[28:31], v[176:179], v[230:245]
    s_waitcnt lgkmcnt(2)
    v_mfma_f32_32x32x16_bf16 v[40:55], v[24:27], v[176:179], v[40:55]
    s_waitcnt lgkmcnt(1)
    v_mfma_f32_32x32x16_bf16 v[230:245], v[36:39], v[180:183], v[230:245]
    s_waitcnt lgkmcnt(0)
    v_mfma_f32_32x32x16_bf16 v[40:55], v[32:35], v[180:183], v[40:55]
    s_add_u32 s35, s80, 0
    s_nop 8
    v_add_f32 v234, 0x358637bd, v234
    v_rcp_f32 v234, v234
    s_nop 0
    v_pk_mul_f32 v[230:231], v[230:231], v[234:235] op_sel_hi:[1,0]
    v_cvt_pk_bf16_f32 v200, v230, v231
    v_pk_mul_f32 v[232:233], v[232:233], v[234:235] op_sel_hi:[1,0]
    v_cvt_pk_bf16_f32 v201, v232, v233
    buffer_store_dwordx2 v[200:201], v191, s[4:7], s69 offen
    v_pk_mul_f32 v[40:41], v[40:41], v[234:235] op_sel_hi:[1,0]
    v_cvt_pk_bf16_f32 v192, v40, v41
    v_pk_mul_f32 v[42:43], v[42:43], v[234:235] op_sel_hi:[1,0]
    v_cvt_pk_bf16_f32 v193, v42, v43
    v_pk_mul_f32 v[44:45], v[44:45], v[234:235] op_sel_hi:[1,0]
    v_cvt_pk_bf16_f32 v194, v44, v45
    v_pk_mul_f32 v[46:47], v[46:47], v[234:235] op_sel_hi:[1,0]
    v_cvt_pk_bf16_f32 v195, v46, v47
    buffer_store_dwordx4 v[192:195], v190, s[4:7], s68 offen
    v_pk_mul_f32 v[48:49], v[48:49], v[234:235] op_sel_hi:[1,0]
    v_cvt_pk_bf16_f32 v196, v48, v49
    v_pk_mul_f32 v[50:51], v[50:51], v[234:235] op_sel_hi:[1,0]
    v_cvt_pk_bf16_f32 v197, v50, v51
    v_pk_mul_f32 v[52:53], v[52:53], v[234:235] op_sel_hi:[1,0]
    v_cvt_pk_bf16_f32 v198, v52, v53
    v_pk_mul_f32 v[54:55], v[54:55], v[234:235] op_sel_hi:[1,0]
    v_cvt_pk_bf16_f32 v199, v54, v55
    buffer_store_dwordx4 v[196:199], v190, s[4:7], s68 offen offset:256
    s_mov_b64 exec, 1
    v_mov_b32 v202, s28
    v_mov_b32 v203, s29
    s_cmp_lg_u32 s27, 0
    s_cbranch_scc1 L_slowpub_11
    s_waitcnt vmcnt(0)
    buffer_store_dwordx2 v[202:203], off, s[4:7], s35 offset:1024
L_pubdone_12:
    s_mov_b64 exec, -1
    s_mul_i32 s35, s24, 5120
    s_add_u32 s35, s35, s94
    s_mul_i32 s90, s71, 49152
    s_add_u32 s90, s90, s35
    s_mul_i32 s91, s72, 49152
    s_add_u32 s91, s91, s35
    s_mul_i32 s92, s73, 49152
    s_add_u32 s92, s92, s35
    s_mul_i32 s93, s74, 49152
    s_add_u32 s93, s93, s35
    v_lshrrev_b32 v206, 1, v218
    s_mov_b32 exec_lo, 0xff
    s_mov_b32 exec_hi, 0x0
    s_mov_b32 s65, 262144
L_poll_13:
    buffer_load_dwordx2 v[204:205], v206, s[4:7], s81 offen offset:1024 sc1
    s_sub_u32 s65, s65, 1
    s_cbranch_scc1 L_polled_14
    s_waitcnt vmcnt(0)
    v_cmp_ne_u64 vcc, s[28:29], v[204:205]
    s_cbranch_vccnz L_poll_13
L_polled_14:
    s_mov_b64 exec, -1
    s_cmp_lg_u32 s27, 0
    s_cbranch_scc1 L_slowacq_15
L_acqdone_16:
    s_add_u32 s62, s90, 0
    buffer_load_dwordx4 v[0:3], v218, s[4:7], s62 offen offset:0 sc1
    buffer_load_dwordx4 v[4:7], v218, s[4:7], s62 offen offset:1024 sc1
    buffer_load_dwordx4 v[8:11], v218, s[4:7], s62 offen offset:2048 sc1
    buffer_load_dwordx4 v[12:15], v218, s[4:7], s62 offen offset:3072 sc1
    s_add_u32 s62, s90, 4096
    buffer_load_dwordx4 v[16:19], v218, s[4:7], s62 offen offset:0 sc1
    s_add_u32 s62, s91, 0
    buffer_load_dwordx4 v[20:23], v218, s[4:7], s62 offen offset:0 sc1
    s_waitcnt vmcnt(5)
    v_mfma_f32_16x16x32_bf16 v[164:167], a[0:3], v[0:3], 0
    buffer_load_dwordx4 v[24:27], v218, s[4:7], s62 offen offset:1024 sc1
    v_mfma_f32_16x16x32_bf16 v[168:171], a[4:7], v[0:3], 0
    v_mfma_f32_16x16x32_bf16 v[172:175], a[8:11], v[0:3], 0
    v_mfma_f32_16x16x32_bf16 v[176:179], a[12:15], v[0:3], 0
    v_mfma_f32_16x16x32_bf16 v[180:183], a[16:19], v[0:3], 0
    s_waitcnt vmcnt(5)
    buffer_load_dwordx4 v[28:31], v218, s[4:7], s62 offen offset:2048 sc1
    v_mfma_f32_16x16x32_bf16 v[164:167], a[20:23], v[4:7], v[164:167]
    s_mul_i32 s35, s24, 10240
    s_add_u32 s35, s35, 112640
    v_mfma_f32_16x16x32_bf16 v[168:171], a[24:27], v[4:7], v[168:171]
    v_add_u32 v219, s35, v218
    v_mfma_f32_16x16x32_bf16 v[172:175], a[28:31], v[4:7], v[172:175]
    v_lshlrev_b32 v230, 16, v208
    v_and_b32 v231, 0xffff0000, v208
    v_mfma_f32_16x16x32_bf16 v[176:179], a[32:35], v[4:7], v[176:179]
    buffer_load_dwordx4 v[32:35], v218, s[4:7], s62 offen offset:3072 sc1
    v_mfma_f32_16x16x32_bf16 v[180:183], a[36:39], v[4:7], v[180:183]
    s_waitcnt vmcnt(6)
    v_lshlrev_b32 v232, 16, v209
    v_and_b32 v233, 0xffff0000, v209
    v_mfma_f32_16x16x32_bf16 v[164:167], a[40:43], v[8:11], v[164:167]
    v_lshlrev_b32 v234, 16, v210
    v_mfma_f32_16x16x32_bf16 v[168:171], a[44:47], v[8:11], v[168:171]
    v_and_b32 v235, 0xffff0000, v210
    v_lshlrev_b32 v236, 16, v211
    v_mfma_f32_16x16x32_bf16 v[172:175], a[48:51], v[8:11], v[172:175]
    v_and_b32 v237, 0xffff0000, v211
    v_mfma_f32_16x16x32_bf16 v[176:179], a[52:55], v[8:11], v[176:179]
    s_add_u32 s62, s91, 4096
    buffer_load_dwordx4 v[36:39], v218, s[4:7], s62 offen offset:0 sc1
    v_mfma_f32_16x16x32_bf16 v[180:183], a[56:59], v[8:11], v[180:183]
    s_waitcnt vmcnt(6)
    v_lshlrev_b32 v238, 16, v212
    v_and_b32 v239, 0xffff0000, v212
    v_mfma_f32_16x16x32_bf16 v[164:167], a[60:63], v[12:15], v[164:167]
    v_lshlrev_b32 v240, 16, v213
    v_and_b32 v241, 0xffff0000, v213
    v_mfma_f32_16x16x32_bf16 v[168:171], a[64:67], v[12:15], v[168:171]
    v_lshlrev_b32 v242, 16, v214
    v_mfma_f32_16x16x32_bf16 v[172:175], a[68:71], v[12:15], v[172:175]
    s_add_u32 s62, s92, 0
    buffer_load_dwordx4 v[40:43], v218, s[4:7], s62 offen offset:0 sc1
    v_mfma_f32_16x16x32_bf16 v[176:179], a[72:75], v[12:15], v[176:179]
    v_and_b32 v243, 0xffff0000, v214
    v_lshlrev_b32 v244, 16, v215
    v_mfma_f32_16x16x32_bf16 v[180:183], a[76:79], v[12:15], v[180:183]
    s_waitcnt vmcnt(6)
    s_and_b32 s35, s71, 3
    v_and_b32 v245, 0xffff0000, v215
    v_mfma_f32_16x16x32_bf16 v[164:167], a[80:83], v[16:19], v[164:167]
    v_lshlrev_b32 v246, 16, v216
    s_mul_i32 s35, s35, 10240
    v_mfma_f32_16x16x32_bf16 v[168:171], a[84:87], v[16:19], v[168:171]
    v_and_b32 v247, 0xffff0000, v216
    s_add_u32 s35, s35, 112640
    v_mfma_f32_16x16x32_bf16 v[172:175], a[88:91], v[16:19], v[172:175]
    buffer_load_dwordx4 v[44:47], v218, s[4:7], s62 offen offset:1024 sc1
    v_mfma_f32_16x16x32_bf16 v[176:179], a[92:95], v[16:19], v[176:179]
    v_lshlrev_b32 v248, 16, v217
    v_add_u32 v223, s35, v218
    v_mfma_f32_16x16x32_bf16 v[180:183], a[96:99], v[16:19], v[180:183]
    s_waitcnt vmcnt(6)
    v_and_b32 v249, 0xffff0000, v217
    v_mfma_f32_16x16x32_bf16 v[184:187], a[0:3], v[20:23], 0
    v_mfma_f32_16x16x32_bf16 v[188:191], a[4:7], v[20:23], 0
    buffer_load_dwordx4 v[48:51], v218, s[4:7], s62 offen offset:2048 sc1
    v_mfma_f32_16x16x32_bf16 v[192:195], a[8:11], v[20:23], 0
    ds_write_b128 v223, v[164:167] offset:0
    v_mfma_f32_16x16x32_bf16 v[196:199], a[12:15], v[20:23], 0
    v_mfma_f32_16x16x32_bf16 v[200:203], a[16:19], v[20:23], 0
    s_waitcnt vmcnt(6)
    ds_write_b128 v223, v[168:171] offset:1024
    v_mfma_f32_16x16x32_bf16 v[184:187], a[20:23], v[24:27], v[184:187]
    buffer_load_dwordx4 v[52:55], v218, s[4:7], s62 offen offset:3072 sc1
    v_mfma_f32_16x16x32_bf16 v[188:191], a[24:27], v[24:27], v[188:191]
    v_mfma_f32_16x16x32_bf16 v[192:195], a[28:31], v[24:27], v[192:195]
    ds_write_b128 v223, v[172:175] offset:2048
    v_mfma_f32_16x16x32_bf16 v[196:199], a[32:35], v[24:27], v[196:199]
    v_mfma_f32_16x16x32_bf16 v[200:203], a[36:39], v[24:27], v[200:203]
    s_waitcnt vmcnt(6)
    v_mfma_f32_16x16x32_bf16 v[184:187], a[40:43], v[28:31], v[184:187]
    s_add_u32 s62, s92, 4096
    buffer_load_dwordx4 v[56:59], v218, s[4:7], s62 offen offset:0 sc1
    v_mfma_f32_16x16x32_bf16 v[188:191], a[44:47], v[28:31], v[188:191]
    ds_write_b128 v223, v[176:179] offset:3072
    v_mfma_f32_16x16x32_bf16 v[192:195], a[48:51], v[28:31], v[192:195]
    v_mfma_f32_16x16x32_bf16 v[196:199], a[52:55], v[28:31], v[196:199]
    ds_write_b128 v223, v[180:183] offset:4096
    v_mfma_f32_16x16x32_bf16 v[200:203], a[56:59], v[28:31], v[200:203]
    s_waitcnt vmcnt(6)
    s_add_u32 s62, s93, 0
    v_mfma_f32_16x16x32_bf16 v[184:187], a[60:63], v[32:35], v[184:187]
    buffer_load_dwordx4 v[60:63], v218, s[4:7], s62 offen offset:0 sc1
    v_mfma_f32_16x16x32_bf16 v[188:191], a[64:67], v[32:35], v[188:191]
    v_mfma_f32_16x16x32_bf16 v[192:195], a[68:71], v[32:35], v[192:195]
    v_mfma_f32_16x16x32_bf16 v[196:199], a[72:75], v[32:35], v[196:199]
    buffer_load_dwordx4 v[64:67], v218, s[4:7], s62 offen offset:1024 sc1
    v_mfma_f32_16x16x32_bf16 v[200:203], a[76:79], v[32:35], v[200:203]
    s_waitcnt vmcnt(7)
    s_and_b32 s35, s72, 3
    v_mfma_f32_16x16x32_bf16 v[184:187], a[80:83], v[36:39], v[184:187]
    s_mul_i32 s35, s35, 10240
    v_mfma_f32_16x16x32_bf16 v[188:191], a[84:87], v[36:39], v[188:191]
    s_add_u32 s35, s35, 117760
    v_mfma_f32_16x16x32_bf16 v[192:195], a[88:91], v[36:39], v[192:195]
    v_add_u32 v223, s35, v218
    v_mfma_f32_16x16x32_bf16 v[196:199], a[92:95], v[36:39], v[196:199]
    buffer_load_dwordx4 v[68:71], v218, s[4:7], s62 offen offset:2048 sc1
    v_mfma_f32_16x16x32_bf16 v[200:203], a[96:99], v[36:39], v[200:203]
    s_waitcnt vmcnt(7)
    s_waitcnt lgkmcnt(0)
    s_barrier
    ds_read_b128 v[80:83], v219 offset:0
    v_mfma_f32_16x16x32_bf16 v[164:167], a[0:3], v[40:43], 0
    ds_read_b128 v[84:87], v219 offset:1024
    ds_read_b128 v[88:91], v219 offset:2048
    v_mfma_f32_16x16x32_bf16 v[168:171], a[4:7], v[40:43], 0
    ds_read_b128 v[92:95], v219 offset:3072
    v_mfma_f32_16x16x32_bf16 v[172:175], a[8:11], v[40:43], 0
    buffer_load_dwordx4 v[72:75], v218, s[4:7], s62 offen offset:3072 sc1
    v_mfma_f32_16x16x32_bf16 v[176:179], a[12:15], v[40:43], 0
    ds_write_b128 v223, v[184:187] offset:0
    ds_read_b128 v[96:99], v219 offset:4096
    v_mfma_f32_16x16x32_bf16 v[180:183], a[16:19], v[40:43], 0
    s_waitcnt vmcnt(7)
    ds_write_b128 v223, v[188:191] offset:1024
    v_mfma_f32_16x16x32_bf16 v[164:167], a[20:23], v[44:47], v[164:167]
    v_mfma_f32_16x16x32_bf16 v[168:171], a[24:27], v[44:47], v[168:171]
    v_mfma_f32_16x16x32_bf16 v[172:175], a[28:31], v[44:47], v[172:175]
    s_add_u32 s62, s93, 4096
    buffer_load_dwordx4 v[76:79], v218, s[4:7], s62 offen offset:0 sc1
    v_mfma_f32_16x16x32_bf16 v[176:179], a[32:35], v[44:47], v[176:179]
    ds_write_b128 v223, v[192:195] offset:2048
    v_mfma_f32_16x16x32_bf16 v[180:183], a[36:39], v[44:47], v[180:183]
    s_waitcnt vmcnt(7)
    s_waitcnt lgkmcnt(7)
    v_add_f32 v230, v230, v80
    v_add_f32 v231, v231, v81
    v_mfma_f32_16x16x32_bf16 v[164:167], a[40:43], v[48:51], v[164:167]
    v_add_f32 v232, v232, v82
    v_add_f32 v233, v233, v83
    v_mfma_f32_16x16x32_bf16 v[168:171], a[44:47], v[48:51], v[168:171]
    s_waitcnt lgkmcnt(6)
    v_add_f32 v234, v234, v84
    v_mfma_f32_16x16x32_bf16 v[172:175], a[48:51], v[48:51], v[172:175]
    s_mul_i32 s98, s24, 10240
    ds_write_b128 v223, v[196:199] offset:3072
    v_add_f32 v235, v235, v85
    v_add_f32 v236, v236, v86
    v_mfma_f32_16x16x32_bf16 v[176:179], a[52:55], v[48:51], v[176:179]
    s_add_u32 m0, s98, 61440
    v_add_f32 v237, v237, v87
    s_add_u32 s98, m0, s83
    v_mfma_f32_16x16x32_bf16 v[180:183], a[56:59], v[48:51], v[180:183]
    s_waitcnt vmcnt(6)
    s_waitcnt lgkmcnt(6)
    v_add_f32 v238, v238, v88
    buffer_load_dword v220, v221, s[16:19], 0 offen sc1
    v_add_f32 v239, v239, v89
    v_mfma_f32_16x16x32_bf16 v[164:167], a[60:63], v[52:55], v[164:167]
    ds_write_b128 v223, v[200:203] offset:4096
    buffer_load_dwordx4 v218, s[4:7], s98 offen offset:0 sc1 lds
    v_add_f32 v240, v240, v90
    v_mfma_f32_16x16x32_bf16 v[168:171], a[64:67], v[52:55], v[168:171]
    v_add_f32 v241, v241, v91
    s_waitcnt lgkmcnt(6)
    v_add_f32 v242, v242, v92
    v_mfma_f32_16x16x32_bf16 v[172:175], a[68:71], v[52:55], v[172:175]
    v_add_f32 v243, v243, v93
    v_add_f32 v244, v244, v94
    v_mfma_f32_16x16x32_bf16 v[176:179], a[72:75], v[52:55], v[176:179]
    v_add_f32 v245, v245, v95
    v_mfma_f32_16x16x32_bf16 v[180:183], a[76:79], v[52:55], v[180:183]
    s_waitcnt vmcnt(7)
    s_waitcnt lgkmcnt(4)
    v_add_f32 v246, v246, v96
    v_mfma_f32_16x16x32_bf16 v[164:167], a[80:83], v[56:59], v[164:167]
    v_add_f32 v247, v247, v97
    buffer_load_dwordx4 v218, s[4:7], s98 offen offset:1024 sc1 lds
    v_add_f32 v248, v248, v98
    v_mfma_f32_16x16x32_bf16 v[168:171], a[84:87], v[56:59], v[168:171]
    s_and_b32 s35, s73, 3
    v_add_f32 v249, v249, v99
    s_mul_i32 s35, s35, 10240
    v_mfma_f32_16x16x32_bf16 v[172:175], a[88:91], v[56:59], v[172:175]
    s_add_u32 s35, s35, 112640
    v_add_u32 v223, s35, v218
    v_mfma_f32_16x16x32_bf16 v[176:179], a[92:95], v[56:59], v[176:179]
    buffer_load_dwordx4 v218, s[4:7], s98 offen offset:2048 sc1 lds
    v_mfma_f32_16x16x32_bf16 v[180:183], a[96:99], v[56:59], v[180:183]
    s_waitcnt vmcnt(8)
    s_waitcnt lgkmcnt(0)
    s_barrier
    ds_read_b128 v[100:103], v219 offset:5120
    v_mfma_f32_16x16x32_bf16 v[230:233], a[0:3], v[60:63], v[230:233]
    ds_read_b128 v[104:107], v219 offset:6144
    ds_read_b128 v[108:111], v219 offset:7168
    v_mfma_f32_16x16x32_bf16 v[234:237], a[4:7], v[60:63], v[234:237]
    ds_read_b128 v[112:115], v219 offset:8192
    v_mfma_f32_16x16x32_bf16 v[238:241], a[8:11], v[60:63], v[238:241]
    ds_write_b128 v223, v[164:167] offset:0
    v_mfma_f32_16x16x32_bf16 v[242:245], a[12:15], v[60:63], v[242:245]
    ds_read_b128 v[116:119], v219 offset:9216
    v_mfma_f32_16x16x32_bf16 v[246:249], a[16:19], v[60:63], v[246:249]
    s_waitcnt vmcnt(7)
    ds_write_b128 v223, v[168:171] offset:1024
    v_mfma_f32_16x16x32_bf16 v[230:233], a[20:23], v[64:67], v[230:233]
    buffer_load_dwordx4 v218, s[4:7], s98 offen offset:3072 sc1 lds
    v_mfma_f32_16x16x32_bf16 v[234:237], a[24:27], v[64:67], v[234:237]
    v_mfma_f32_16x16x32_bf16 v[238:241], a[28:31], v[64:67], v[238:241]
    ds_write_b128 v223, v[172:175] offset:2048
    v_mfma_f32_16x16x32_bf16 v[242:245], a[32:35], v[64:67], v[242:245]
    v_mfma_f32_16x16x32_bf16 v[246:249], a[36:39], v[64:67], v[246:249]
    s_waitcnt vmcnt(7)
    v_mfma_f32_16x16x32_bf16 v[230:233], a[40:43], v[68:71], v[230:233]
    s_add_u32 m0, m0, 4096
    ds_write_b128 v223, v[176:179] offset:3072
    v_mfma_f32_16x16x32_bf16 v[234:237], a[44:47], v[68:71], v[234:237]
    s_add_u32 s98, s98, 4096
    buffer_load_dwordx4 v218, s[4:7], s98 offen offset:0 sc1 lds
    v_mfma_f32_16x16x32_bf16 v[238:241], a[48:51], v[68:71], v[238:241]
    v_mfma_f32_16x16x32_bf16 v[242:245], a[52:55], v[68:71], v[242:245]
    ds_write_b128 v223, v[180:183] offset:4096
    v_mfma_f32_16x16x32_bf16 v[246:249], a[56:59], v[68:71], v[246:249]
    s_waitcnt vmcnt(7)
    v_mfma_f32_16x16x32_bf16 v[230:233], a[60:63], v[72:75], v[230:233]
    v_mfma_f32_16x16x32_bf16 v[234:237], a[64:67], v[72:75], v[234:237]
    s_waitcnt lgkmcnt(0)
    s_barrier
    ds_read_b128 v[120:123], v219 offset:0
    v_mfma_f32_16x16x32_bf16 v[238:241], a[68:71], v[72:75], v[238:241]
    ds_read_b128 v[124:127], v219 offset:1024
    ds_read_b128 v[128:131], v219 offset:2048
    v_mfma_f32_16x16x32_bf16 v[242:245], a[72:75], v[72:75], v[242:245]
    ds_read_b128 v[132:135], v219 offset:3072
    ds_read_b128 v[136:139], v219 offset:4096
    v_mfma_f32_16x16x32_bf16 v[246:249], a[76:79], v[72:75], v[246:249]
    s_waitcnt vmcnt(6)
    ds_read_b32 v223, v224 offset:3080
    v_mfma_f32_16x16x32_bf16 v[230:233], a[80:83], v[76:79], v[230:233]
    buffer_load_dwordx4 v218, s[4:7], s98 offen offset:1024 sc1 lds
    v_mfma_f32_16x16x32_bf16 v[234:237], a[84:87], v[76:79], v[234:237]
    v_mfma_f32_16x16x32_bf16 v[238:241], a[88:91], v[76:79], v[238:241]
    v_mfma_f32_16x16x32_bf16 v[242:245], a[92:95], v[76:79], v[242:245]
    v_mfma_f32_16x16x32_bf16 v[246:249], a[96:99], v[76:79], v[246:249]
    s_waitcnt lgkmcnt(5)
    v_pk_add_f32 v[100:101], v[100:101], v[120:121]
    v_pk_add_f32 v[102:103], v[102:103], v[122:123]
    s_waitcnt lgkmcnt(4)
    v_pk_add_f32 v[104:105], v[104:105], v[124:125]
    v_pk_add_f32 v[106:107], v[106:107], v[126:127]
    s_waitcnt lgkmcnt(3)
    v_pk_add_f32 v[108:109], v[108:109], v[128:129]
    v_pk_add_f32 v[110:111], v[110:111], v[130:131]
    s_waitcnt lgkmcnt(2)
    v_pk_add_f32 v[112:113], v[112:113], v[132:133]
    v_pk_add_f32 v[114:115], v[114:115], v[134:135]
    s_waitcnt lgkmcnt(1)
    v_pk_add_f32 v[116:117], v[116:117], v[136:137]
    v_pk_add_f32 v[118:119], v[118:119], v[138:139]
    v_pk_add_f32 v[230:231], v[230:231], v[100:101]
    v_cvt_pk_bf16_f32 v208, v230, v231
    v_pk_add_f32 v[232:233], v[232:233], v[102:103]
    v_cvt_pk_bf16_f32 v209, v232, v233
    v_pk_add_f32 v[234:235], v[234:235], v[104:105]
    v_cvt_pk_bf16_f32 v210, v234, v235
    v_pk_add_f32 v[236:237], v[236:237], v[106:107]
    v_cvt_pk_bf16_f32 v211, v236, v237
    buffer_store_dwordx4 v[208:211], v218, s[4:7], s75 offen
    v_pk_add_f32 v[238:239], v[238:239], v[108:109]
    v_cvt_pk_bf16_f32 v212, v238, v239
    v_pk_add_f32 v[240:241], v[240:241], v[110:111]
    v_cvt_pk_bf16_f32 v213, v240, v241
    v_pk_add_f32 v[242:243], v[242:243], v[112:113]
    v_cvt_pk_bf16_f32 v214, v242, v243
    v_pk_add_f32 v[244:245], v[244:245], v[114:115]
    v_cvt_pk_bf16_f32 v215, v244, v245
    buffer_store_dwordx4 v[212:215], v218, s[4:7], s75 offen offset:1024
    v_pk_add_f32 v[246:247], v[246:247], v[116:117]
    v_cvt_pk_bf16_f32 v216, v246, v247
    v_pk_add_f32 v[248:249], v[248:249], v[118:119]
    v_cvt_pk_bf16_f32 v217, v248, v249
    s_waitcnt lgkmcnt(0)
    buffer_store_dwordx2 v[216:217], v223, s[4:7], s76 offen
    s_mov_b32 s60, 0x3f803f80
    v_dot2_f32_bf16 v204, v208, s60, 0
    v_dot2_f32_bf16 v205, v208, v208, 0
    v_dot2_f32_bf16 v206, v209, s60, 0
    v_dot2_f32_bf16 v207, v209, v209, 0
    v_dot2c_f32_bf16 v204, s60, v210
    v_dot2c_f32_bf16 v205, v210, v210
    v_dot2c_f32_bf16 v206, s60, v211
    v_dot2c_f32_bf16 v207, v211, v211
    v_dot2c_f32_bf16 v204, s60, v212
    v_dot2c_f32_bf16 v205, v212, v212
    v_dot2c_f32_bf16 v206, s60, v213
    v_dot2c_f32_bf16 v207, v213, v213
    v_dot2c_f32_bf16 v204, s60, v214
    v_dot2c_f32_bf16 v205, v214, v214
    v_dot2c_f32_bf16 v206, s60, v215
    v_dot2c_f32_bf16 v207, v215, v215
    v_dot2c_f32_bf16 v204, s60, v216
    v_dot2c_f32_bf16 v205, v216, v216
    v_dot2c_f32_bf16 v206, s60, v217
    v_dot2c_f32_bf16 v207, v217, v217
    s_add_u32 s35, s78, 0
    s_nop 1
    v_pk_add_f32 v[204:205], v[204:205], v[206:207]
    v_mov_b32 v206, v204
    v_mov_b32 v207, v205
    s_nop 0
    v_permlane16_swap_b32 v204, v206
    v_permlane16_swap_b32 v205, v207
    v_add_f32 v204, v204, v206
    v_add_f32 v205, v205, v207
    v_mov_b32 v206, v204
    v_mov_b32 v207, v205
    s_nop 0
    v_permlane32_swap_b32 v204, v206
    v_permlane32_swap_b32 v205, v207
    v_add_f32 v204, v204, v206
    v_add_f32 v205, v205, v207
    s_mov_b64 exec, 0xffff
    buffer_store_dwordx2 v[204:205], v218, s[4:7], s77 offen
    s_mov_b64 exec, 1
    v_mov_b32 v206, s28
    v_mov_b32 v207, s29
    s_cmp_lg_u32 s27, 0
    s_cbranch_scc1 L_slowpub_17
    s_waitcnt vmcnt(0)
    buffer_store_dwordx2 v[206:207], off, s[4:7], s35 offset:2048
L_pubdone_18:
    s_mov_b64 exec, -1
    buffer_load_dwordx4 v218, s[4:7], s98 offen offset:2048 sc1 lds
    buffer_load_dwordx4 v218, s[4:7], s98 offen offset:3072 sc1 lds
    s_add_u32 m0, m0, 4096
    s_add_u32 s98, s98, 4096
    buffer_load_dwordx4 v218, s[4:7], s98 offen offset:0 sc1 lds
    buffer_load_dwordx4 v218, s[4:7], s98 offen offset:1024 sc1 lds
    s_mul_i32 s98, s24, 3072
    s_min_u32 s98, s98, 7168
    s_add_u32 m0, s98, 102400
    s_add_u32 s98, m0, s83
    buffer_load_dwordx4 v218, s[4:7], s98 offen offset:0 sc1 lds
    buffer_load_dwordx4 v218, s[4:7], s98 offen offset:1024 sc1 lds
    buffer_load_dwordx4 v218, s[4:7], s98 offen offset:2048 sc1 lds
    s_barrier
    s_mul_i32 s98, s24, 3072
    s_min_u32 s98, s98, 7168
    s_add_u32 m0, s98, 112640
    s_add_u32 s98, m0, s83
    buffer_load_dwordx4 v218, s[4:7], s98 offen offset:0 sc1 lds
    buffer_load_dwordx4 v218, s[4:7], s98 offen offset:1024 sc1 lds
    buffer_load_dwordx4 v218, s[4:7], s98 offen offset:2048 sc1 lds
    v_accvgpr_read_b32 v160, a120
    v_accvgpr_read_b32 v161, a121
    v_accvgpr_read_b32 v164, a124
    v_accvgpr_read_b32 v165, a125
    v_add_f32 v160, v160, v164
    v_add_f32 v161, v161, v165
    v_accvgpr_read_b32 v164, a128
    v_accvgpr_read_b32 v165, a129
    v_add_f32 v160, v160, v164
    v_add_f32 v161, v161, v165
    v_accvgpr_read_b32 v164, a132
    v_accvgpr_read_b32 v165, a133
    v_add_f32 v160, v160, v164
    v_add_f32 v161, v161, v165
    v_accvgpr_read_b32 v164, a136
    v_accvgpr_read_b32 v165, a137
    v_add_f32 v160, v160, v164
    v_add_f32 v161, v161, v165
    v_mov_b32 v164, v160
    v_mov_b32 v165, v161
    s_nop 0
    v_permlane16_swap_b32 v160, v164
    v_permlane16_swap_b32 v161, v165
    v_add_f32 v160, v160, v164
    v_add_f32 v161, v161, v165
    v_mov_b32 v164, v160
    v_mov_b32 v165, v161
    s_nop 0
    v_permlane32_swap_b32 v160, v164
    v_permlane32_swap_b32 v161, v165
    v_add_f32 v160, v160, v164
    v_add_f32 v161, v161, v165
    s_min_u32 s61, s24, 2
    v_lshrrev_b32 v164, 2, v218
    s_lshl_b32 s35, s61, 7
    s_add_u32 s35, s35, 154112
    v_add_u32 v164, s35, v164
    s_mov_b64 exec, 0xffff
    ds_write2_b32 v164, v160, v161 offset0:0 offset1:16
    s_mov_b64 exec, -1
    v_lshrrev_b32 v232, 1, v218
    s_mov_b32 exec_lo, 0xffff
    s_mov_b32 exec_hi, 0x0
    s_mov_b32 s65, 262144
L_poll_19:
    buffer_load_dwordx2 v[230:231], v232, s[4:7], s79 offen offset:2048 sc1
    s_sub_u32 s65, s65, 1
    s_cbranch_scc1 L_polled_20
    s_waitcnt vmcnt(0)
    v_cmp_ne_u64 vcc, s[28:29], v[230:231]
    s_cbranch_vccnz L_poll_19
L_polled_20:
    s_mov_b64 exec, -1
    s_cmp_lg_u32 s27, 0
    s_cbranch_scc1 L_slowacq_21
L_acqdone_22:
    s_add_u32 s62, s66, 0
    buffer_load_dwordx4 v[0:3], v218, s[4:7], s62 offen offset:0 sc1
    s_add_u32 s63, s66, 20480
    buffer_load_dwordx4 v[4:7], v218, s[4:7], s63 offen offset:0 sc1
    buffer_load_dwordx4 v[8:11], v218, s[4:7], s62 offen offset:1024 sc1
    buffer_load_dwordx4 v[12:15], v218, s[4:7], s63 offen offset:1024 sc1
    buffer_load_dwordx4 v[16:19], v218, s[4:7], s62 offen offset:2048 sc1
    buffer_load_dwordx4 v[20:23], v218, s[4:7], s63 offen offset:2048 sc1
    buffer_load_dwordx4 v[230:233], v218, s[4:7], s67 offen sc1
    buffer_load_dwordx4 v[234:237], v218, s[4:7], s67 offen offset:1024 sc1
    v_add_u32 v223, 0x10000, v218
    s_waitcnt lgkmcnt(0)
    s_barrier
    s_add_u32 s60, s70, 49152
    ds_read_b128 a[240:243], v218 offset:0
    ds_read_b128 a[244:247], v218 offset:1024
    ds_read_b128 a[248:251], v218 offset:2048
    ds_read_b128 a[252:255], v218 offset:3072
    s_waitcnt vmcnt(7) lgkmcnt(3)
    buffer_load_dwordx4 v[24:27], v218, s[4:7], s62 offen offset:3072 sc1
    v_mfma_f32_16x16x32_bf16 v[160:163], a[240:243], v[0:3], 0
    s_waitcnt vmcnt(7)
    ds_read_b128 v[240:243], v218 offset:4096
    v_mfma_f32_16x16x32_bf16 v[164:167], a[240:243], v[4:7], 0
    s_waitcnt lgkmcnt(3)
    v_mfma_f32_16x16x32_bf16 v[168:171], a[244:247], v[0:3], 0
    ds_read_b128 v[244:247], v218 offset:5120
    v_mfma_f32_16x16x32_bf16 v[172:175], a[244:247], v[4:7], 0
    s_waitcnt lgkmcnt(3)
    buffer_load_dwordx4 v[28:31], v218, s[4:7], s63 offen offset:3072 sc1
    v_mfma_f32_16x16x32_bf16 v[176:179], a[248:251], v[0:3], 0
    ds_read_b128 a[240:243], v218 offset:6144
    v_mfma_f32_16x16x32_bf16 v[180:183], a[248:251], v[4:7], 0
    s_waitcnt lgkmcnt(3)
    v_mfma_f32_16x16x32_bf16 v[184:187], a[252:255], v[0:3], 0
    ds_read_b128 a[244:247], v218 offset:7168
    v_mfma_f32_16x16x32_bf16 v[188:191], a[252:255], v[4:7], 0
    s_waitcnt lgkmcnt(3)
    s_add_u32 s62, s66, 4096
    v_mfma_f32_16x16x32_bf16 v[192:195], v[240:243], v[0:3], 0
    ds_read_b128 a[248:251], v218 offset:8192
    v_mfma_f32_16x16x32_bf16 v[196:199], v[240:243], v[4:7], 0
    s_waitcnt lgkmcnt(3)
    buffer_load_dwordx4 v[32:35], v218, s[4:7], s62 offen offset:0 sc1
    v_mfma_f32_16x16x32_bf16 v[200:203], v[244:247], v[0:3], 0
    ds_read_b128 a[252:255], v218 offset:9216
    v_mfma_f32_16x16x32_bf16 v[204:207], v[244:247], v[4:7], 0
    s_waitcnt vmcnt(8) lgkmcnt(3)
    v_mfma_f32_16x16x32_bf16 v[160:163], a[240:243], v[8:11], v[160:163]
    s_waitcnt vmcnt(7)
    ds_read_b128 v[240:243], v218 offset:10240
    s_add_u32 s63, s66, 24576
    v_mfma_f32_16x16x32_bf16 v[164:167], a[240:243], v[12:15], v[164:167]
    s_waitcnt lgkmcnt(3)
    buffer_load_dwordx4 v[36:39], v218, s[4:7], s63 offen offset:0 sc1
    v_mfma_f32_16x16x32_bf16 v[168:171], a[244:247], v[8:11], v[168:171]
    ds_read_b128 v[244:247], v218 offset:11264
    v_mfma_f32_16x16x32_bf16 v[172:175], a[244:247], v[12:15], v[172:175]
    s_waitcnt lgkmcnt(3)
    v_mfma_f32_16x16x32_bf16 v[176:179], a[248:251], v[8:11], v[176:179]
    ds_read_b128 a[240:243], v218 offset:12288
    v_mfma_f32_16x16x32_bf16 v[180:183], a[248:251], v[12:15], v[180:183]
    s_waitcnt lgkmcnt(3)
    buffer_load_dwordx4 v[40:43], v218, s[4:7], s62 offen offset:1024 sc1
    v_mfma_f32_16x16x32_bf16 v[184:187], a[252:255], v[8:11], v[184:187]
    ds_read_b128 a[244:247], v218 offset:13312
    v_mfma_f32_16x16x32_bf16 v[188:191], a[252:255], v[12:15], v[188:191]
    s_waitcnt lgkmcnt(3)
    v_mfma_f32_16x16x32_bf16 v[192:195], v[240:243], v[8:11], v[192:195]
    ds_read_b128 a[248:251], v218 offset:14336
    v_mfma_f32_16x16x32_bf16 v[196:199], v[240:243], v[12:15], v[196:199]
    s_waitcnt lgkmcnt(3)
    buffer_load_dwordx4 v[44:47], v218, s[4:7], s63 offen offset:1024 sc1
    v_mfma_f32_16x16x32_bf16 v[200:203], v[244:247], v[8:11], v[200:203]
    ds_read_b128 a[252:255], v218 offset:15360
    v_mfma_f32_16x16x32_bf16 v[204:207], v[244:247], v[12:15], v[204:207]
    s_waitcnt vmcnt(9) lgkmcnt(3)
    v_mfma_f32_16x16x32_bf16 v[160:163], a[240:243], v[16:19], v[160:163]
    s_waitcnt vmcnt(8)
    ds_read_b128 v[240:243], v218 offset:16384
    v_mfma_f32_16x16x32_bf16 v[164:167], a[240:243], v[20:23], v[164:167]
    s_waitcnt lgkmcnt(3)
    buffer_load_dwordx4 v[48:51], v218, s[4:7], s62 offen offset:2048 sc1
    v_mfma_f32_16x16x32_bf16 v[168:171], a[244:247], v[16:19], v[168:171]
    ds_read_b128 v[244:247], v218 offset:17408
    v_mfma_f32_16x16x32_bf16 v[172:175], a[244:247], v[20:23], v[172:175]
    s_waitcnt lgkmcnt(3)
    v_mfma_f32_16x16x32_bf16 v[176:179], a[248:251], v[16:19], v[176:179]
    ds_read_b128 a[240:243], v218 offset:18432
    v_mfma_f32_16x16x32_bf16 v[180:183], a[248:251], v[20:23], v[180:183]
    s_waitcnt lgkmcnt(3)
    buffer_load_dwordx4 v[52:55], v218, s[4:7], s63 offen offset:2048 sc1
    v_mfma_f32_16x16x32_bf16 v[184:187], a[252:255], v[16:19], v[184:187]
    s_waitcnt vmcnt(9)
    v_add_f32 v226, v230, v232
    ds_read_b128 a[244:247], v218 offset:19456
    v_mfma_f32_16x16x32_bf16 v[188:191], a[252:255], v[20:23], v[188:191]
    s_waitcnt lgkmcnt(3)
    v_add_f32 v228, v231, v233
    v_mfma_f32_16x16x32_bf16 v[192:195], v[240:243], v[16:19], v[192:195]
    ds_read_b128 a[248:251], v218 offset:20480
    v_mfma_f32_16x16x32_bf16 v[196:199], v[240:243], v[20:23], v[196:199]
    s_waitcnt lgkmcnt(3)
    s_waitcnt vmcnt(8)
    v_add_f32 v227, v234, v236
    v_mfma_f32_16x16x32_bf16 v[200:203], v[244:247], v[16:19], v[200:203]
    ds_read_b128 a[252:255], v218 offset:21504
    v_mfma_f32_16x16x32_bf16 v[204:207], v[244:247], v[20:23], v[204:207]
    s_waitcnt vmcnt(7) lgkmcnt(3)
    buffer_load_dwordx4 v[56:59], v218, s[4:7], s62 offen offset:3072 sc1
    v_mfma_f32_16x16x32_bf16 v[160:163], a[240:243], v[24:27], v[160:163]
    s_waitcnt vmcnt(7)
    ds_read_b128 v[240:243], v218 offset:22528
    v_add_f32 v229, v235, v237
    v_mfma_f32_16x16x32_bf16 v[164:167], a[240:243], v[28:31], v[164:167]
    s_waitcnt lgkmcnt(3)
    v_mov_b32 v230, v226
    v_mfma_f32_16x16x32_bf16 v[168:171], a[244:247], v[24:27], v[168:171]
    ds_read_b128 v[244:247], v218 offset:23552
    v_mfma_f32_16x16x32_bf16 v[172:175], a[244:247], v[28:31], v[172:175]
    s_waitcnt lgkmcnt(3)
    buffer_load_dwordx4 v[60:63], v218, s[4:7], s63 offen offset:3072 sc1
    v_mfma_f32_16x16x32_bf16 v[176:179], a[248:251], v[24:27], v[176:179]
    ds_read_b128 a[240:243], v218 offset:24576
    v_mov_b32 v231, v227
    v_mfma_f32_16x16x32_bf16 v[180:183], a[248:251], v[28:31], v[180:183]
    s_waitcnt lgkmcnt(3)
    v_mov_b32 v232, v228
    v_mfma_f32_16x16x32_bf16 v[184:187], a[252:255], v[24:27], v[184:187]
    s_add_u32 s62, s66, 8192
    ds_read_b128 a[244:247], v218 offset:25600
    v_mfma_f32_16x16x32_bf16 v[188:191], a[252:255], v[28:31], v[188:191]
    s_waitcnt lgkmcnt(3)
    buffer_load_dwordx4 v[64:67], v218, s[4:7], s62 offen offset:0 sc1
    v_mfma_f32_16x16x32_bf16 v[192:195], v[240:243], v[24:27], v[192:195]
    ds_read_b128 a[248:251], v218 offset:26624
    v_mov_b32 v233, v229
    v_mfma_f32_16x16x32_bf16 v[196:199], v[240:243], v[28:31], v[196:199]
    s_waitcnt lgkmcnt(3)
    v_permlane16_swap_b32 v226, v230
    v_mfma_f32_16x16x32_bf16 v[200:203], v[244:247], v[24:27], v[200:203]
    ds_read_b128 a[252:255], v218 offset:27648
    v_mfma_f32_16x16x32_bf16 v[204:207], v[244:247], v[28:31], v[204:207]
    s_waitcnt vmcnt(8) lgkmcnt(3)
    s_add_u32 s63, s66, 28672
    v_mfma_f32_16x16x32_bf16 v[160:163], a[240:243], v[32:35], v[160:163]
    s_waitcnt vmcnt(7)
    ds_read_b128 v[240:243], v218 offset:28672
    v_mfma_f32_16x16x32_bf16 v[164:167], a[240:243], v[36:39], v[164:167]
    s_waitcnt lgkmcnt(3)
    buffer_load_dwordx4 v[68:71], v218, s[4:7], s63 offen offset:0 sc1
    v_mfma_f32_16x16x32_bf16 v[168:171], a[244:247], v[32:35], v[168:171]
    ds_read_b128 v[244:247], v218 offset:29696
    v_permlane16_swap_b32 v227, v231
    v_mfma_f32_16x16x32_bf16 v[172:175], a[244:247], v[36:39], v[172:175]
    s_waitcnt lgkmcnt(3)
    buffer_load_dwordx4 v[72:75], v218, s[4:7], s62 offen offset:1024 sc1
    v_mfma_f32_16x16x32_bf16 v[176:179], a[248:251], v[32:35], v[176:179]
    ds_read_b128 a[240:243], v218 offset:30720
    v_permlane16_swap_b32 v228, v232
    v_mfma_f32_16x16x32_bf16 v[180:183], a[248:251], v[36:39], v[180:183]
    s_waitcnt lgkmcnt(3)
    v_permlane16_swap_b32 v229, v233
    v_mfma_f32_16x16x32_bf16 v[184:187], a[252:255], v[32:35], v[184:187]
    ds_read_b128 a[244:247], v218 offset:31744
    v_add_f32 v226, v226, v230
    v_mfma_f32_16x16x32_bf16 v[188:191], a[252:255], v[36:39], v[188:191]
    s_waitcnt lgkmcnt(3)
    v_add_f32 v227, v227, v231
    v_mfma_f32_16x16x32_bf16 v[192:195], v[240:243], v[32:35], v[192:195]
    ds_read_b128 a[248:251], v218 offset:32768
    v_mfma_f32_16x16x32_bf16 v[196:199], v[240:243], v[36:39], v[196:199]
    s_waitcnt lgkmcnt(3)
    buffer_load_dwordx4 v[76:79], v218, s[4:7], s63 offen offset:1024 sc1
    v_mfma_f32_16x16x32_bf16 v[200:203], v[244:247], v[32:35], v[200:203]
    ds_read_b128 a[252:255], v218 offset:33792
    v_add_f32 v228, v228, v232
    v_mfma_f32_16x16x32_bf16 v[204:207], v[244:247], v[36:39], v[204:207]
    s_waitcnt vmcnt(9) lgkmcnt(3)
    v_add_f32 v229, v229, v233
    v_mfma_f32_16x16x32_bf16 v[160:163], a[240:243], v[40:43], v[160:163]
    s_waitcnt vmcnt(8)
    ds_read_b128 v[240:243], v218 offset:34816
    v_mfma_f32_16x16x32_bf16 v[164:167], a[240:243], v[44:47], v[164:167]
    s_waitcnt lgkmcnt(3)
    buffer_load_dwordx4 v[80:83], v218, s[4:7], s62 offen offset:2048 sc1
    v_mfma_f32_16x16x32_bf16 v[168:171], a[244:247], v[40:43], v[168:171]
    ds_read_b128 v[244:247], v218 offset:35840
    v_mov_b32 v230, v226
    v_mfma_f32_16x16x32_bf16 v[172:175], a[244:247], v[44:47], v[172:175]
    s_waitcnt lgkmcnt(3)
    v_mov_b32 v231, v227
    v_mfma_f32_16x16x32_bf16 v[176:179], a[248:251], v[40:43], v[176:179]
    ds_read_b128 a[240:243], v218 offset:36864
    v_mfma_f32_16x16x32_bf16 v[180:183], a[248:251], v[44:47], v[180:183]
    s_waitcnt lgkmcnt(3)
    buffer_load_dwordx4 v[84:87], v218, s[4:7], s63 offen offset:2048 sc1
    v_mfma_f32_16x16x32_bf16 v[184:187], a[252:255], v[40:43], v[184:187]
    ds_read_b128 a[244:247], v218 offset:37888
    v_mov_b32 v232, v228
    v_mfma_f32_16x16x32_bf16 v[188:191], a[252:255], v[44:47], v[188:191]
    s_waitcnt lgkmcnt(3)
    v_mov_b32 v233, v229
    v_mfma_f32_16x16x32_bf16 v[192:195], v[240:243], v[40:43], v[192:195]
    ds_read_b128 a[248:251], v218 offset:38912
    v_mfma_f32_16x16x32_bf16 v[196:199], v[240:243], v[44:47], v[196:199]
    s_waitcnt lgkmcnt(3)
    buffer_load_dwordx4 v[88:91], v218, s[4:7], s62 offen offset:3072 sc1
    v_mfma_f32_16x16x32_bf16 v[200:203], v[244:247], v[40:43], v[200:203]
    ds_read_b128 a[252:255], v218 offset:39936
    v_mfma_f32_16x16x32_bf16 v[204:207], v[244:247], v[44:47], v[204:207]
    s_waitcnt vmcnt(10) lgkmcnt(3)
    v_permlane32_swap_b32 v226, v230
    v_mfma_f32_16x16x32_bf16 v[160:163], a[240:243], v[48:51], v[160:163]
    s_waitcnt vmcnt(9)
    ds_read_b128 v[240:243], v218 offset:40960
    v_mfma_f32_16x16x32_bf16 v[164:167], a[240:243], v[52:55], v[164:167]
    s_waitcnt lgkmcnt(3)
    buffer_load_dwordx4 v[92:95], v218, s[4:7], s63 offen offset:3072 sc1
    v_mfma_f32_16x16x32_bf16 v[168:171], a[244:247], v[48:51], v[168:171]
    ds_read_b128 v[244:247], v218 offset:41984
    v_permlane32_swap_b32 v227, v231
    v_mfma_f32_16x16x32_bf16 v[172:175], a[244:247], v[52:55], v[172:175]
    s_waitcnt lgkmcnt(3)
    v_permlane32_swap_b32 v228, v232
    v_mfma_f32_16x16x32_bf16 v[176:179], a[248:251], v[48:51], v[176:179]
    ds_read_b128 a[240:243], v218 offset:43008
    v_mfma_f32_16x16x32_bf16 v[180:183], a[248:251], v[52:55], v[180:183]
    s_waitcnt lgkmcnt(3)
    v_permlane32_swap_b32 v229, v233
    v_mfma_f32_16x16x32_bf16 v[184:187], a[252:255], v[48:51], v[184:187]
    s_add_u32 s62, s66, 12288
    ds_read_b128 a[244:247], v218 offset:44032
    v_add_f32 v226, v226, v230
    v_mfma_f32_16x16x32_bf16 v[188:191], a[252:255], v[52:55], v[188:191]
    s_waitcnt lgkmcnt(3)
    buffer_load_dwordx4 v[96:99], v218, s[4:7], s62 offen offset:0 sc1
    v_mfma_f32_16x16x32_bf16 v[192:195], v[240:243], v[48:51], v[192:195]
    ds_read_b128 a[248:251], v218 offset:45056
    v_add_f32 v227, v227, v231
    v_mfma_f32_16x16x32_bf16 v[196:199], v[240:243], v[52:55], v[196:199]
    s_waitcnt lgkmcnt(3)
    v_add_f32 v228, v228, v232
    v_mfma_f32_16x16x32_bf16 v[200:203], v[244:247], v[48:51], v[200:203]
    s_add_u32 s63, s66, 32768
    ds_read_b128 a[252:255], v218 offset:46080
    v_mfma_f32_16x16x32_bf16 v[204:207], v[244:247], v[52:55], v[204:207]
    s_waitcnt vmcnt(10) lgkmcnt(3)
    buffer_load_dwordx4 v[100:103], v218, s[4:7], s63 offen offset:0 sc1
    v_mfma_f32_16x16x32_bf16 v[160:163], a[240:243], v[56:59], v[160:163]
    s_waitcnt vmcnt(10)
    ds_read_b128 v[240:243], v218 offset:47104
    v_add_f32 v229, v229, v233
    v_mfma_f32_16x16x32_bf16 v[164:167], a[240:243], v[60:63], v[164:167]
    s_waitcnt lgkmcnt(3)
    v_mul_f32 v226, 0xbacccccd, v226
    v_mfma_f32_16x16x32_bf16 v[168:171], a[244:247], v[56:59], v[168:171]
    ds_read_b128 v[244:247], v218 offset:48128
    v_mfma_f32_16x16x32_bf16 v[172:175], a[244:247], v[60:63], v[172:175]
    s_waitcnt lgkmcnt(3)
    buffer_load_dwordx4 v[104:107], v218, s[4:7], s62 offen offset:1024 sc1
    v_mfma_f32_16x16x32_bf16 v[176:179], a[248:251], v[56:59], v[176:179]
    ds_read_b128 a[240:243], v218 offset:49152
    v_mul_f32 v228, 0x3acccccd, v228
    v_mfma_f32_16x16x32_bf16 v[180:183], a[248:251], v[60:63], v[180:183]
    s_waitcnt lgkmcnt(3)
    v_mul_f32 v227, 0xbacccccd, v227
    v_mfma_f32_16x16x32_bf16 v[184:187], a[252:255], v[56:59], v[184:187]
    ds_read_b128 a[244:247], v218 offset:50176
    v_mfma_f32_16x16x32_bf16 v[188:191], a[252:255], v[60:63], v[188:191]
    s_waitcnt lgkmcnt(3)
    buffer_load_dwordx4 v[108:111], v218, s[4:7], s63 offen offset:1024 sc1
    v_mfma_f32_16x16x32_bf16 v[192:195], v[240:243], v[56:59], v[192:195]
    ds_read_b128 a[248:251], v218 offset:51200
    v_mul_f32 v229, 0x3acccccd, v229
    v_mfma_f32_16x16x32_bf16 v[196:199], v[240:243], v[60:63], v[196:199]
    s_waitcnt lgkmcnt(3)
    v_fma_f32 v228, -v226, v226, v228
    v_mfma_f32_16x16x32_bf16 v[200:203], v[244:247], v[56:59], v[200:203]
    ds_read_b128 a[252:255], v218 offset:52224
    v_mfma_f32_16x16x32_bf16 v[204:207], v[244:247], v[60:63], v[204:207]
    s_waitcnt vmcnt(11) lgkmcnt(3)
    buffer_load_dwordx4 v[112:115], v218, s[4:7], s62 offen offset:2048 sc1
    v_mfma_f32_16x16x32_bf16 v[160:163], a[240:243], v[64:67], v[160:163]
    s_waitcnt vmcnt(11)
    ds_read_b128 v[240:243], v218 offset:53248
    v_fma_f32 v229, -v227, v227, v229
    v_mfma_f32_16x16x32_bf16 v[164:167], a[240:243], v[68:71], v[164:167]
    s_waitcnt lgkmcnt(3)
    v_max_f32 v228, 0, v228
    v_mfma_f32_16x16x32_bf16 v[168:171], a[244:247], v[64:67], v[168:171]
    ds_read_b128 v[244:247], v218 offset:54272
    v_mfma_f32_16x16x32_bf16 v[172:175], a[244:247], v[68:71], v[172:175]
    s_waitcnt lgkmcnt(3)
    v_max_f32 v229, 0, v229
    v_mfma_f32_16x16x32_bf16 v[176:179], a[248:251], v[64:67], v[176:179]
    ds_read_b128 a[240:243], v218 offset:55296
    v_mfma_f32_16x16x32_bf16 v[180:183], a[248:251], v[68:71], v[180:183]
    s_waitcnt lgkmcnt(3)
    buffer_load_dwordx4 v[116:119], v218, s[4:7], s63 offen offset:2048 sc1
    v_mfma_f32_16x16x32_bf16 v[184:187], a[252:255], v[64:67], v[184:187]
    ds_read_b128 a[244:247], v218 offset:56320
    v_add_f32 v228, 0x3727c5ac, v228
    v_mfma_f32_16x16x32_bf16 v[188:191], a[252:255], v[68:71], v[188:191]
    s_waitcnt lgkmcnt(3)
    v_add_f32 v229, 0x3727c5ac, v229
    v_mfma_f32_16x16x32_bf16 v[192:195], v[240:243], v[64:67], v[192:195]
    ds_read_b128 a[248:251], v218 offset:57344
    v_mfma_f32_16x16x32_bf16 v[196:199], v[240:243], v[68:71], v[196:199]
    s_waitcnt lgkmcnt(3)
    buffer_load_dwordx4 v[120:123], v218, s[4:7], s62 offen offset:3072 sc1
    v_mfma_f32_16x16x32_bf16 v[200:203], v[244:247], v[64:67], v[200:203]
    ds_read_b128 a[252:255], v218 offset:58368
    v_mfma_f32_16x16x32_bf16 v[204:207], v[244:247], v[68:71], v[204:207]
    s_waitcnt vmcnt(12) lgkmcnt(3)
    v_rsq_f32 v228, v228
    v_mfma_f32_16x16x32_bf16 v[160:163], a[240:243], v[72:75], v[160:163]
    s_waitcnt vmcnt(11)
    ds_read_b128 v[240:243], v218 offset:59392
    v_mfma_f32_16x16x32_bf16 v[164:167], a[240:243], v[76:79], v[164:167]
    s_waitcnt lgkmcnt(3)
    buffer_load_dwordx4 v[124:127], v218, s[4:7], s63 offen offset:3072 sc1
    v_mfma_f32_16x16x32_bf16 v[168:171], a[244:247], v[72:75], v[168:171]
    ds_read_b128 v[244:247], v218 offset:60416
    v_rsq_f32 v229, v229
    v_mfma_f32_16x16x32_bf16 v[172:175], a[244:247], v[76:79], v[172:175]
    s_waitcnt lgkmcnt(3)
    v_mfma_f32_16x16x32_bf16 v[176:179], a[248:251], v[72:75], v[176:179]
    ds_read_b128 a[240:243], v218 offset:61440
    v_mfma_f32_16x16x32_bf16 v[180:183], a[248:251], v[76:79], v[180:183]
    s_waitcnt lgkmcnt(3)
    s_add_u32 s62, s66, 16384
    v_mfma_f32_16x16x32_bf16 v[184:187], a[252:255], v[72:75], v[184:187]
    ds_read_b128 a[244:247], v218 offset:62464
    v_mfma_f32_16x16x32_bf16 v[188:191], a[252:255], v[76:79], v[188:191]
    s_waitcnt lgkmcnt(3)
    buffer_load_dwordx4 v[128:131], v218, s[4:7], s62 offen offset:0 sc1
    v_mfma_f32_16x16x32_bf16 v[192:195], v[240:243], v[72:75], v[192:195]
    ds_read_b128 a[248:251], v218 offset:63488
    v_mfma_f32_16x16x32_bf16 v[196:199], v[240:243], v[76:79], v[196:199]
    s_waitcnt lgkmcnt(3)
    s_add_u32 s63, s66, 36864
    v_mfma_f32_16x16x32_bf16 v[200:203], v[244:247], v[72:75], v[200:203]
    ds_read_b128 a[252:255], v218 offset:64512
    v_mfma_f32_16x16x32_bf16 v[204:207], v[244:247], v[76:79], v[204:207]
    s_waitcnt vmcnt(12) lgkmcnt(3)
    buffer_load_dwordx4 v[132:135], v218, s[4:7], s63 offen offset:0 sc1
    v_mfma_f32_16x16x32_bf16 v[160:163], a[240:243], v[80:83], v[160:163]
    s_waitcnt vmcnt(12)
    ds_read_b128 v[240:243], v223 offset:0
    v_mfma_f32_16x16x32_bf16 v[164:167], a[240:243], v[84:87], v[164:167]
    s_waitcnt lgkmcnt(3)
    v_mfma_f32_16x16x32_bf16 v[168:171], a[244:247], v[80:83], v[168:171]
    ds_read_b128 v[244:247], v223 offset:1024
    v_mfma_f32_16x16x32_bf16 v[172:175], a[244:247], v[84:87], v[172:175]
    s_waitcnt lgkmcnt(3)
    buffer_load_dwordx4 v[136:139], v218, s[4:7], s62 offen offset:1024 sc1
    v_mfma_f32_16x16x32_bf16 v[176:179], a[248:251], v[80:83], v[176:179]
    ds_read_b128 a[240:243], v223 offset:2048
    v_mfma_f32_16x16x32_bf16 v[180:183], a[248:251], v[84:87], v[180:183]
    s_waitcnt lgkmcnt(3)
    v_mfma_f32_16x16x32_bf16 v[184:187], a[252:255], v[80:83], v[184:187]
    ds_read_b128 a[244:247], v223 offset:3072
    v_mfma_f32_16x16x32_bf16 v[188:191], a[252:255], v[84:87], v[188:191]
    s_waitcnt lgkmcnt(3)
    buffer_load_dwordx4 v[140:143], v218, s[4:7], s63 offen offset:1024 sc1
    v_mfma_f32_16x16x32_bf16 v[192:195], v[240:243], v[80:83], v[192:195]
    ds_read_b128 a[248:251], v223 offset:4096
    v_mfma_f32_16x16x32_bf16 v[196:199], v[240:243], v[84:87], v[196:199]
    s_waitcnt lgkmcnt(3)
    v_mfma_f32_16x16x32_bf16 v[200:203], v[244:247], v[80:83], v[200:203]
    ds_read_b128 a[252:255], v223 offset:5120
    v_mfma_f32_16x16x32_bf16 v[204:207], v[244:247], v[84:87], v[204:207]
    s_waitcnt vmcnt(13) lgkmcnt(3)
    buffer_load_dwordx4 v[144:147], v218, s[4:7], s62 offen offset:2048 sc1
    v_mfma_f32_16x16x32_bf16 v[160:163], a[240:243], v[88:91], v[160:163]
    s_waitcnt vmcnt(13)
    ds_read_b128 v[240:243], v223 offset:6144
    v_mfma_f32_16x16x32_bf16 v[164:167], a[240:243], v[92:95], v[164:167]
    s_waitcnt lgkmcnt(3)
    v_mfma_f32_16x16x32_bf16 v[168:171], a[244:247], v[88:91], v[168:171]
    ds_read_b128 v[244:247], v223 offset:7168
    v_mfma_f32_16x16x32_bf16 v[172:175], a[244:247], v[92:95], v[172:175]
    s_waitcnt lgkmcnt(3)
    buffer_load_dwordx4 v[148:151], v218, s[4:7], s63 offen offset:2048 sc1
    v_mfma_f32_16x16x32_bf16 v[176:179], a[248:251], v[88:91], v[176:179]
    ds_read_b128 a[240:243], v223 offset:8192
    v_mfma_f32_16x16x32_bf16 v[180:183], a[248:251], v[92:95], v[180:183]
    s_waitcnt lgkmcnt(3)
    v_mfma_f32_16x16x32_bf16 v[184:187], a[252:255], v[88:91], v[184:187]
    ds_read_b128 a[244:247], v223 offset:9216
    v_mfma_f32_16x16x32_bf16 v[188:191], a[252:255], v[92:95], v[188:191]
    s_waitcnt lgkmcnt(3)
    buffer_load_dwordx4 v[152:155], v218, s[4:7], s62 offen offset:3072 sc1
    v_mfma_f32_16x16x32_bf16 v[192:195], v[240:243], v[88:91], v[192:195]
    ds_read_b128 a[248:251], v223 offset:10240
    v_mfma_f32_16x16x32_bf16 v[196:199], v[240:243], v[92:95], v[196:199]
    s_waitcnt lgkmcnt(3)
    v_mfma_f32_16x16x32_bf16 v[200:203], v[244:247], v[88:91], v[200:203]
    ds_read_b128 a[252:255], v223 offset:11264
    v_mfma_f32_16x16x32_bf16 v[204:207], v[244:247], v[92:95], v[204:207]
    s_waitcnt vmcnt(14) lgkmcnt(3)
    v_mfma_f32_16x16x32_bf16 v[160:163], a[240:243], v[96:99], v[160:163]
    s_waitcnt vmcnt(13)
    ds_read_b128 v[240:243], v223 offset:12288
    v_mfma_f32_16x16x32_bf16 v[164:167], a[240:243], v[100:103], v[164:167]
    s_waitcnt lgkmcnt(3)
    buffer_load_dwordx4 v[156:159], v218, s[4:7], s63 offen offset:3072 sc1
    v_mfma_f32_16x16x32_bf16 v[168:171], a[244:247], v[96:99], v[168:171]
    ds_read_b128 v[244:247], v223 offset:13312
    v_mfma_f32_16x16x32_bf16 v[172:175], a[244:247], v[100:103], v[172:175]
    s_waitcnt lgkmcnt(3)
    v_mfma_f32_16x16x32_bf16 v[176:179], a[248:251], v[96:99], v[176:179]
    ds_read_b128 a[240:243], v223 offset:14336
    v_lshlrev_b32 v219, 2, v218
    v_mfma_f32_16x16x32_bf16 v[180:183], a[248:251], v[100:103], v[180:183]
    s_waitcnt lgkmcnt(3)
    v_min_u32 v219, 3008, v219
    s_add_u32 s60, s70, 49152
    v_mfma_f32_16x16x32_bf16 v[184:187], a[252:255], v[96:99], v[184:187]
    ds_read_b128 a[244:247], v223 offset:15360
    v_mfma_f32_16x16x32_bf16 v[188:191], a[252:255], v[100:103], v[188:191]
    s_waitcnt lgkmcnt(3)
    buffer_load_dword v220, v219, s[4:7], s70 offen offset:0 sc1
    v_mfma_f32_16x16x32_bf16 v[192:195], v[240:243], v[96:99], v[192:195]
    ds_read_b128 a[248:251], v223 offset:16384
    v_mfma_f32_16x16x32_bf16 v[196:199], v[240:243], v[100:103], v[196:199]
    s_waitcnt lgkmcnt(3)
    buffer_load_dword v220, v219, s[4:7], s60 offen offset:0 sc1
    v_mfma_f32_16x16x32_bf16 v[200:203], v[244:247], v[96:99], v[200:203]
    ds_read_b128 a[252:255], v223 offset:17408
    v_mfma_f32_16x16x32_bf16 v[204:207], v[244:247], v[100:103], v[204:207]
    s_waitcnt vmcnt(15) lgkmcnt(3)
    buffer_load_dword v220, v221, s[16:19], 0 offen sc1
    v_mfma_f32_16x16x32_bf16 v[160:163], a[240:243], v[104:107], v[160:163]
    s_waitcnt vmcnt(15)
    ds_read_b128 v[240:243], v223 offset:18432
    s_add_u32 s100, s85, 0
    v_mfma_f32_16x16x32_bf16 v[164:167], a[240:243], v[108:111], v[164:167]
    s_waitcnt lgkmcnt(3)
    buffer_load_dwordx4 a[100:103], v218, s[4:7], s100 offen offset:0 sc1
    v_mfma_f32_16x16x32_bf16 v[168:171], a[244:247], v[104:107], v[168:171]
    ds_read_b128 v[244:247], v223 offset:19456
    v_mfma_f32_16x16x32_bf16 v[172:175], a[244:247], v[108:111], v[172:175]
    s_waitcnt lgkmcnt(3)
    v_mfma_f32_16x16x32_bf16 v[176:179], a[248:251], v[104:107], v[176:179]
    ds_read_b128 a[240:243], v223 offset:20480
    v_mfma_f32_16x16x32_bf16 v[180:183], a[248:251], v[108:111], v[180:183]
    s_waitcnt lgkmcnt(3)
    buffer_load_dwordx4 a[104:107], v218, s[4:7], s100 offen offset:1024 sc1
    v_mfma_f32_16x16x32_bf16 v[184:187], a[252:255], v[104:107], v[184:187]
    ds_read_b128 a[244:247], v223 offset:21504
    v_mfma_f32_16x16x32_bf16 v[188:191], a[252:255], v[108:111], v[188:191]
    s_waitcnt lgkmcnt(3)
    v_mfma_f32_16x16x32_bf16 v[192:195], v[240:243], v[104:107], v[192:195]
    ds_read_b128 a[248:251], v223 offset:22528
    v_mfma_f32_16x16x32_bf16 v[196:199], v[240:243], v[108:111], v[196:199]
    s_waitcnt lgkmcnt(3)
    v_mfma_f32_16x16x32_bf16 v[200:203], v[244:247], v[104:107], v[200:203]
    ds_read_b128 a[252:255], v223 offset:23552
    v_mfma_f32_16x16x32_bf16 v[204:207], v[244:247], v[108:111], v[204:207]
    s_waitcnt vmcnt(16) lgkmcnt(3)
    buffer_load_dwordx4 a[108:111], v218, s[4:7], s100 offen offset:2048 sc1
    v_mfma_f32_16x16x32_bf16 v[160:163], a[240:243], v[112:115], v[160:163]
    s_waitcnt vmcnt(16)
    ds_read_b128 v[240:243], v223 offset:24576
    v_mfma_f32_16x16x32_bf16 v[164:167], a[240:243], v[116:119], v[164:167]
    s_waitcnt lgkmcnt(3)
    v_mfma_f32_16x16x32_bf16 v[168:171], a[244:247], v[112:115], v[168:171]
    ds_read_b128 v[244:247], v223 offset:25600
    v_mfma_f32_16x16x32_bf16 v[172:175], a[244:247], v[116:119], v[172:175]
    s_waitcnt lgkmcnt(3)
    buffer_load_dwordx4 a[112:115], v218, s[4:7], s100 offen offset:3072 sc1
    v_mfma_f32_16x16x32_bf16 v[176:179], a[248:251], v[112:115], v[176:179]
    ds_read_b128 a[240:243], v223 offset:26624
    v_mfma_f32_16x16x32_bf16 v[180:183], a[248:251], v[116:119], v[180:183]
    s_waitcnt lgkmcnt(3)
    v_mfma_f32_16x16x32_bf16 v[184:187], a[252:255], v[112:115], v[184:187]
    ds_read_b128 a[244:247], v223 offset:27648
    v_mfma_f32_16x16x32_bf16 v[188:191], a[252:255], v[116:119], v[188:191]
    s_waitcnt lgkmcnt(3)
    v_mfma_f32_16x16x32_bf16 v[192:195], v[240:243], v[112:115], v[192:195]
    s_add_u32 s100, s85, 4096
    ds_read_b128 a[248:251], v223 offset:28672
    v_mfma_f32_16x16x32_bf16 v[196:199], v[240:243], v[116:119], v[196:199]
    s_waitcnt lgkmcnt(3)
    buffer_load_dwordx4 a[116:119], v218, s[4:7], s100 offen offset:0 sc1
    v_mfma_f32_16x16x32_bf16 v[200:203], v[244:247], v[112:115], v[200:203]
    ds_read_b128 a[252:255], v223 offset:29696
    v_mfma_f32_16x16x32_bf16 v[204:207], v[244:247], v[116:119], v[204:207]
    s_waitcnt vmcnt(17) lgkmcnt(3)
    v_mfma_f32_16x16x32_bf16 v[160:163], a[240:243], v[120:123], v[160:163]
    s_waitcnt vmcnt(16)
    ds_read_b128 v[240:243], v223 offset:30720
    v_mfma_f32_16x16x32_bf16 v[164:167], a[240:243], v[124:127], v[164:167]
    s_waitcnt lgkmcnt(3)
    buffer_load_dwordx4 a[120:123], v218, s[4:7], s100 offen offset:1024 sc1
    v_mfma_f32_16x16x32_bf16 v[168:171], a[244:247], v[120:123], v[168:171]
    ds_read_b128 v[244:247], v223 offset:31744
    v_mfma_f32_16x16x32_bf16 v[172:175], a[244:247], v[124:127], v[172:175]
    s_waitcnt lgkmcnt(3)
    v_mfma_f32_16x16x32_bf16 v[176:179], a[248:251], v[120:123], v[176:179]
    ds_read_b128 a[240:243], v223 offset:32768
    v_mfma_f32_16x16x32_bf16 v[180:183], a[248:251], v[124:127], v[180:183]
    s_waitcnt lgkmcnt(3)
    v_mfma_f32_16x16x32_bf16 v[184:187], a[252:255], v[120:123], v[184:187]
    ds_read_b128 a[244:247], v223 offset:33792
    v_mfma_f32_16x16x32_bf16 v[188:191], a[252:255], v[124:127], v[188:191]
    s_waitcnt lgkmcnt(3)
    buffer_load_dwordx4 a[124:127], v218, s[4:7], s100 offen offset:2048 sc1
    v_mfma_f32_16x16x32_bf16 v[192:195], v[240:243], v[120:123], v[192:195]
    ds_read_b128 a[248:251], v223 offset:34816
    v_mfma_f32_16x16x32_bf16 v[196:199], v[240:243], v[124:127], v[196:199]
    s_waitcnt lgkmcnt(3)
    v_mfma_f32_16x16x32_bf16 v[200:203], v[244:247], v[120:123], v[200:203]
    ds_read_b128 a[252:255], v223 offset:35840
    v_mfma_f32_16x16x32_bf16 v[204:207], v[244:247], v[124:127], v[204:207]
    s_waitcnt vmcnt(17) lgkmcnt(3)
    buffer_load_dwordx4 a[128:131], v218, s[4:7], s100 offen offset:3072 sc1
    v_mfma_f32_16x16x32_bf16 v[160:163], a[240:243], v[128:131], v[160:163]
    s_waitcnt vmcnt(17)
    ds_read_b128 v[240:243], v223 offset:36864
    v_mfma_f32_16x16x32_bf16 v[164:167], a[240:243], v[132:135], v[164:167]
    s_waitcnt lgkmcnt(3)
    v_mfma_f32_16x16x32_bf16 v[168:171], a[244:247], v[128:131], v[168:171]
    ds_read_b128 v[244:247], v223 offset:37888
    v_mfma_f32_16x16x32_bf16 v[172:175], a[244:247], v[132:135], v[172:175]
    s_waitcnt lgkmcnt(3)
    v_mfma_f32_16x16x32_bf16 v[176:179], a[248:251], v[128:131], v[176:179]
    s_add_u32 s100, s85, 8192
    ds_read_b128 a[240:243], v223 offset:38912
    v_mfma_f32_16x16x32_bf16 v[180:183], a[248:251], v[132:135], v[180:183]
    s_waitcnt lgkmcnt(3)
    buffer_load_dwordx4 a[132:135], v218, s[4:7], s100 offen offset:0 sc1
    v_mfma_f32_16x16x32_bf16 v[184:187], a[252:255], v[128:131], v[184:187]
    ds_read_b128 a[244:247], v223 offset:39936
    v_mfma_f32_16x16x32_bf16 v[188:191], a[252:255], v[132:135], v[188:191]
    s_waitcnt lgkmcnt(3)
    v_mfma_f32_16x16x32_bf16 v[192:195], v[240:243], v[128:131], v[192:195]
    ds_read_b128 a[248:251], v223 offset:40960
    v_mfma_f32_16x16x32_bf16 v[196:199], v[240:243], v[132:135], v[196:199]
    s_waitcnt lgkmcnt(3)
    buffer_load_dwordx4 a[136:139], v218, s[4:7], s100 offen offset:1024 sc1
    v_mfma_f32_16x16x32_bf16 v[200:203], v[244:247], v[128:131], v[200:203]
    ds_read_b128 a[252:255], v223 offset:41984
    v_mfma_f32_16x16x32_bf16 v[204:207], v[244:247], v[132:135], v[204:207]
    s_waitcnt vmcnt(18) lgkmcnt(3)
    v_mfma_f32_16x16x32_bf16 v[160:163], a[240:243], v[136:139], v[160:163]
    s_waitcnt vmcnt(17)
    ds_read_b128 v[240:243], v223 offset:43008
    v_mfma_f32_16x16x32_bf16 v[164:167], a[240:243], v[140:143], v[164:167]
    s_waitcnt lgkmcnt(3)
    v_mfma_f32_16x16x32_bf16 v[168:171], a[244:247], v[136:139], v[168:171]
    s_add_u32 s100, s85, 35840
    ds_read_b128 v[244:247], v223 offset:44032
    v_mfma_f32_16x16x32_bf16 v[172:175], a[244:247], v[140:143], v[172:175]
    s_waitcnt lgkmcnt(3)
    buffer_load_dwordx4 v[0:3], v218, s[4:7], s100 offen offset:0 sc1
    v_mfma_f32_16x16x32_bf16 v[176:179], a[248:251], v[136:139], v[176:179]
    ds_read_b128 a[240:243], v223 offset:45056
    v_mfma_f32_16x16x32_bf16 v[180:183], a[248:251], v[140:143], v[180:183]
    s_waitcnt lgkmcnt(3)
    v_mfma_f32_16x16x32_bf16 v[184:187], a[252:255], v[136:139], v[184:187]
    ds_read_b128 a[244:247], v223 offset:46080
    v_mfma_f32_16x16x32_bf16 v[188:191], a[252:255], v[140:143], v[188:191]
    s_waitcnt lgkmcnt(3)
    buffer_load_dwordx4 v[4:7], v218, s[4:7], s100 offen offset:1024 sc1
    v_mfma_f32_16x16x32_bf16 v[192:195], v[240:243], v[136:139], v[192:195]
    ds_read_b128 a[248:251], v223 offset:47104
    v_mfma_f32_16x16x32_bf16 v[196:199], v[240:243], v[140:143], v[196:199]
    s_waitcnt lgkmcnt(3)
    v_mfma_f32_16x16x32_bf16 v[200:203], v[244:247], v[136:139], v[200:203]
    ds_read_b128 a[252:255], v223 offset:48128
    v_mfma_f32_16x16x32_bf16 v[204:207], v[244:247], v[140:143], v[204:207]
    s_waitcnt vmcnt(18) lgkmcnt(3)
    v_mfma_f32_16x16x32_bf16 v[160:163], a[240:243], v[144:147], v[160:163]
    s_waitcnt vmcnt(17)
    ds_read_b128 v[240:243], v223 offset:49152
    v_mfma_f32_16x16x32_bf16 v[164:167], a[240:243], v[148:151], v[164:167]
    s_waitcnt lgkmcnt(3)
    buffer_load_dwordx4 v[8:11], v218, s[4:7], s100 offen offset:2048 sc1
    v_mfma_f32_16x16x32_bf16 v[168:171], a[244:247], v[144:147], v[168:171]
    ds_read_b128 v[244:247], v223 offset:50176
    v_mfma_f32_16x16x32_bf16 v[172:175], a[244:247], v[148:151], v[172:175]
    s_waitcnt lgkmcnt(3)
    v_mfma_f32_16x16x32_bf16 v[176:179], a[248:251], v[144:147], v[176:179]
    ds_read_b128 a[240:243], v223 offset:51200
    v_mfma_f32_16x16x32_bf16 v[180:183], a[248:251], v[148:151], v[180:183]
    s_waitcnt lgkmcnt(3)
    buffer_load_dwordx4 v[12:15], v218, s[4:7], s100 offen offset:3072 sc1
    v_mfma_f32_16x16x32_bf16 v[184:187], a[252:255], v[144:147], v[184:187]
    ds_read_b128 a[244:247], v223 offset:52224
    v_mfma_f32_16x16x32_bf16 v[188:191], a[252:255], v[148:151], v[188:191]
    s_waitcnt lgkmcnt(3)
    v_mfma_f32_16x16x32_bf16 v[192:195], v[240:243], v[144:147], v[192:195]
    ds_read_b128 a[248:251], v223 offset:53248
    v_mfma_f32_16x16x32_bf16 v[196:199], v[240:243], v[148:151], v[196:199]
    s_waitcnt lgkmcnt(3)
    v_mfma_f32_16x16x32_bf16 v[200:203], v[244:247], v[144:147], v[200:203]
    s_add_u32 s100, s85, 39936
    ds_read_b128 a[252:255], v223 offset:54272
    v_mfma_f32_16x16x32_bf16 v[204:207], v[244:247], v[148:151], v[204:207]
    s_waitcnt vmcnt(18) lgkmcnt(3)
    ds_read_b128 v[100:103], v225 offset:512
    ds_read_b128 v[124:127], v225 offset:1024
    v_mfma_f32_16x16x32_bf16 v[160:163], a[240:243], v[152:155], v[160:163]
    s_waitcnt vmcnt(17)
    ds_read_b128 v[240:243], v223 offset:55296
    ds_read_b128 v[104:107], v225 offset:576
    v_mfma_f32_16x16x32_bf16 v[164:167], a[240:243], v[156:159], v[164:167]
    s_waitcnt lgkmcnt(6)
    ds_read_b128 v[128:131], v225 offset:1088
    buffer_load_dwordx4 v[16:19], v218, s[4:7], s100 offen offset:0 sc1
    v_mfma_f32_16x16x32_bf16 v[168:171], a[244:247], v[152:155], v[168:171]
    ds_read_b128 v[244:247], v223 offset:56320
    ds_read_b128 v[108:111], v225 offset:640
    v_mfma_f32_16x16x32_bf16 v[172:175], a[244:247], v[156:159], v[172:175]
    s_waitcnt lgkmcnt(8)
    buffer_load_dwordx4 v[20:23], v218, s[4:7], s100 offen offset:1024 sc1
    ds_read_b128 v[132:135], v225 offset:1152
    ds_read_b128 v[112:115], v225 offset:704
    v_mfma_f32_16x16x32_bf16 v[176:179], a[248:251], v[152:155], v[176:179]
    ds_read_b128 v[136:139], v225 offset:1216
    v_mfma_f32_16x16x32_bf16 v[180:183], a[248:251], v[156:159], v[180:183]
    s_waitcnt lgkmcnt(10)
    ds_read_b128 v[116:119], v225 offset:768
    v_mfma_f32_16x16x32_bf16 v[184:187], a[252:255], v[152:155], v[184:187]
    ds_read_b128 v[140:143], v225 offset:1280
    v_mfma_f32_16x16x32_bf16 v[188:191], a[252:255], v[156:159], v[188:191]
    s_waitcnt lgkmcnt(9)
    ds_read_b128 v[120:123], v225 offset:832
    ds_read_b128 v[144:147], v225 offset:1344
    v_mfma_f32_16x16x32_bf16 v[192:195], v[240:243], v[152:155], v[192:195]
    v_mfma_f32_16x16x32_bf16 v[196:199], v[240:243], v[156:159], v[196:199]
    s_waitcnt lgkmcnt(8)
    v_mfma_f32_16x16x32_bf16 v[200:203], v[244:247], v[152:155], v[200:203]
    v_mfma_f32_16x16x32_bf16 v[204:207], v[244:247], v[156:159], v[204:207]
    s_add_u32 s35, s80, 0
    v_pk_fma_f32 v[160:161], v[226:227], v[100:101], v[160:161] op_sel:[0,0,0] op_sel_hi:[0,1,1]
    v_pk_fma_f32 v[162:163], v[226:227], v[102:103], v[162:163] op_sel:[0,0,0] op_sel_hi:[0,1,1]
    v_pk_fma_f32 v[168:169], v[226:227], v[104:105], v[168:169] op_sel:[0,0,0] op_sel_hi:[0,1,1]
    v_pk_fma_f32 v[170:171], v[226:227], v[106:107], v[170:171] op_sel:[0,0,0] op_sel_hi:[0,1,1]
    v_pk_fma_f32 v[160:161], v[228:229], v[160:161], v[124:125] op_sel:[0,0,0] op_sel_hi:[0,1,1]
    v_pk_fma_f32 v[162:163], v[228:229], v[162:163], v[126:127] op_sel:[0,0,0] op_sel_hi:[0,1,1]
    v_pk_fma_f32 v[168:169], v[228:229], v[168:169], v[128:129] op_sel:[0,0,0] op_sel_hi:[0,1,1]
    v_pk_fma_f32 v[170:171], v[228:229], v[170:171], v[130:131] op_sel:[0,0,0] op_sel_hi:[0,1,1]
    v_max_f32 v160, 0, v160
    v_max_f32 v161, 0, v161
    v_max_f32 v162, 0, v162
    v_max_f32 v163, 0, v163
    v_max_f32 v168, 0, v168
    v_max_f32 v169, 0, v169
    v_max_f32 v170, 0, v170
    v_max_f32 v171, 0, v171
    v_pk_mul_f32 v[160:161], v[160:161], v[160:161]
    v_pk_mul_f32 v[162:163], v[162:163], v[162:163]
    v_pk_mul_f32 v[168:169], v[168:169], v[168:169]
    v_pk_mul_f32 v[170:171], v[170:171], v[170:171]
    v_cvt_pk_bf16_f32 v160, v160, v161
    v_cvt_pk_bf16_f32 v161, v162, v163
    v_cvt_pk_bf16_f32 v162, v168, v169
    v_cvt_pk_bf16_f32 v163, v170, v171
    buffer_store_dwordx4 v[160:163], v218, s[4:7], s70 offen offset:0
    v_pk_fma_f32 v[164:165], v[226:227], v[100:101], v[164:165] op_sel:[1,0,0] op_sel_hi:[1,1,1]
    v_pk_fma_f32 v[166:167], v[226:227], v[102:103], v[166:167] op_sel:[1,0,0] op_sel_hi:[1,1,1]
    v_pk_fma_f32 v[172:173], v[226:227], v[104:105], v[172:173] op_sel:[1,0,0] op_sel_hi:[1,1,1]
    v_pk_fma_f32 v[174:175], v[226:227], v[106:107], v[174:175] op_sel:[1,0,0] op_sel_hi:[1,1,1]
    v_pk_fma_f32 v[164:165], v[228:229], v[164:165], v[124:125] op_sel:[1,0,0] op_sel_hi:[1,1,1]
    v_pk_fma_f32 v[166:167], v[228:229], v[166:167], v[126:127] op_sel:[1,0,0] op_sel_hi:[1,1,1]
    v_pk_fma_f32 v[172:173], v[228:229], v[172:173], v[128:129] op_sel:[1,0,0] op_sel_hi:[1,1,1]
    v_pk_fma_f32 v[174:175], v[228:229], v[174:175], v[130:131] op_sel:[1,0,0] op_sel_hi:[1,1,1]
    v_max_f32 v164, 0, v164
    v_max_f32 v165, 0, v165
    v_max_f32 v166, 0, v166
    v_max_f32 v167, 0, v167
    v_max_f32 v172, 0, v172
    v_max_f32 v173, 0, v173
    v_max_f32 v174, 0, v174
    v_max_f32 v175, 0, v175
    v_pk_mul_f32 v[164:165], v[164:165], v[164:165]
    v_pk_mul_f32 v[166:167], v[166:167], v[166:167]
    v_pk_mul_f32 v[172:173], v[172:173], v[172:173]
    v_pk_mul_f32 v[174:175], v[174:175], v[174:175]
    v_cvt_pk_bf16_f32 v164, v164, v165
    v_cvt_pk_bf16_f32 v165, v166, v167
    v_cvt_pk_bf16_f32 v166, v172, v173
    v_cvt_pk_bf16_f32 v167, v174, v175
    buffer_store_dwordx4 v[164:167], v218, s[4:7], s60 offen offset:0
    s_waitcnt lgkmcnt(7)
    v_pk_fma_f32 v[176:177], v[226:227], v[108:109], v[176:177] op_sel:[0,0,0] op_sel_hi:[0,1,1]
    v_pk_fma_f32 v[178:179], v[226:227], v[110:111], v[178:179] op_sel:[0,0,0] op_sel_hi:[0,1,1]
    s_waitcnt lgkmcnt(5)
    v_pk_fma_f32 v[184:185], v[226:227], v[112:113], v[184:185] op_sel:[0,0,0] op_sel_hi:[0,1,1]
    v_pk_fma_f32 v[186:187], v[226:227], v[114:115], v[186:187] op_sel:[0,0,0] op_sel_hi:[0,1,1]
    v_pk_fma_f32 v[176:177], v[228:229], v[176:177], v[132:133] op_sel:[0,0,0] op_sel_hi:[0,1,1]
    v_pk_fma_f32 v[178:179], v[228:229], v[178:179], v[134:135] op_sel:[0,0,0] op_sel_hi:[0,1,1]
    s_waitcnt lgkmcnt(4)
    v_pk_fma_f32 v[184:185], v[228:229], v[184:185], v[136:137] op_sel:[0,0,0] op_sel_hi:[0,1,1]
    v_pk_fma_f32 v[186:187], v[228:229], v[186:187], v[138:139] op_sel:[0,0,0] op_sel_hi:[0,1,1]
    v_max_f32 v176, 0, v176
    v_max_f32 v177, 0, v177
    v_max_f32 v178, 0, v178
    v_max_f32 v179, 0, v179
    v_max_f32 v184, 0, v184
    v_max_f32 v185, 0, v185
    v_max_f32 v186, 0, v186
    v_max_f32 v187, 0, v187
    v_pk_mul_f32 v[176:177], v[176:177], v[176:177]
    v_pk_mul_f32 v[178:179], v[178:179], v[178:179]
    v_pk_mul_f32 v[184:185], v[184:185], v[184:185]
    v_pk_mul_f32 v[186:187], v[186:187], v[186:187]
    v_cvt_pk_bf16_f32 v176, v176, v177
    v_cvt_pk_bf16_f32 v177, v178, v179
    v_cvt_pk_bf16_f32 v178, v184, v185
    v_cvt_pk_bf16_f32 v179, v186, v187
    buffer_store_dwordx4 v[176:179], v218, s[4:7], s70 offen offset:1024
    v_pk_fma_f32 v[180:181], v[226:227], v[108:109], v[180:181] op_sel:[1,0,0] op_sel_hi:[1,1,1]
    v_pk_fma_f32 v[182:183], v[226:227], v[110:111], v[182:183] op_sel:[1,0,0] op_sel_hi:[1,1,1]
    v_pk_fma_f32 v[188:189], v[226:227], v[112:113], v[188:189] op_sel:[1,0,0] op_sel_hi:[1,1,1]
    v_pk_fma_f32 v[190:191], v[226:227], v[114:115], v[190:191] op_sel:[1,0,0] op_sel_hi:[1,1,1]
    v_pk_fma_f32 v[180:181], v[228:229], v[180:181], v[132:133] op_sel:[1,0,0] op_sel_hi:[1,1,1]
    v_pk_fma_f32 v[182:183], v[228:229], v[182:183], v[134:135] op_sel:[1,0,0] op_sel_hi:[1,1,1]
    v_pk_fma_f32 v[188:189], v[228:229], v[188:189], v[136:137] op_sel:[1,0,0] op_sel_hi:[1,1,1]
    v_pk_fma_f32 v[190:191], v[228:229], v[190:191], v[138:139] op_sel:[1,0,0] op_sel_hi:[1,1,1]
    v_max_f32 v180, 0, v180
    v_max_f32 v181, 0, v181
    v_max_f32 v182, 0, v182
    v_max_f32 v183, 0, v183
    v_max_f32 v188, 0, v188
    v_max_f32 v189, 0, v189
    v_max_f32 v190, 0, v190
    v_max_f32 v191, 0, v191
    v_pk_mul_f32 v[180:181], v[180:181], v[180:181]
    v_pk_mul_f32 v[182:183], v[182:183], v[182:183]
    v_pk_mul_f32 v[188:189], v[188:189], v[188:189]
    v_pk_mul_f32 v[190:191], v[190:191], v[190:191]
    v_cvt_pk_bf16_f32 v180, v180, v181
    v_cvt_pk_bf16_f32 v181, v182, v183
    v_cvt_pk_bf16_f32 v182, v188, v189
    v_cvt_pk_bf16_f32 v183, v190, v191
    buffer_store_dwordx4 v[180:183], v218, s[4:7], s60 offen offset:1024
    s_waitcnt lgkmcnt(3)
    v_pk_fma_f32 v[192:193], v[226:227], v[116:117], v[192:193] op_sel:[0,0,0] op_sel_hi:[0,1,1]
    v_pk_fma_f32 v[194:195], v[226:227], v[118:119], v[194:195] op_sel:[0,0,0] op_sel_hi:[0,1,1]
    s_waitcnt lgkmcnt(1)
    v_pk_fma_f32 v[200:201], v[226:227], v[120:121], v[200:201] op_sel:[0,0,0] op_sel_hi:[0,1,1]
    v_pk_fma_f32 v[202:203], v[226:227], v[122:123], v[202:203] op_sel:[0,0,0] op_sel_hi:[0,1,1]
    v_pk_fma_f32 v[192:193], v[228:229], v[192:193], v[140:141] op_sel:[0,0,0] op_sel_hi:[0,1,1]
    v_pk_fma_f32 v[194:195], v[228:229], v[194:195], v[142:143] op_sel:[0,0,0] op_sel_hi:[0,1,1]
    s_waitcnt lgkmcnt(0)
    v_pk_fma_f32 v[200:201], v[228:229], v[200:201], v[144:145] op_sel:[0,0,0] op_sel_hi:[0,1,1]
    v_pk_fma_f32 v[202:203], v[228:229], v[202:203], v[146:147] op_sel:[0,0,0] op_sel_hi:[0,1,1]
    v_max_f32 v192, 0, v192
    v_max_f32 v193, 0, v193
    v_max_f32 v194, 0, v194
    v_max_f32 v195, 0, v195
    v_max_f32 v200, 0, v200
    v_max_f32 v201, 0, v201
    v_max_f32 v202, 0, v202
    v_max_f32 v203, 0, v203
    v_pk_mul_f32 v[192:193], v[192:193], v[192:193]
    v_pk_mul_f32 v[194:195], v[194:195], v[194:195]
    v_pk_mul_f32 v[200:201], v[200:201], v[200:201]
    v_pk_mul_f32 v[202:203], v[202:203], v[202:203]
    v_cvt_pk_bf16_f32 v192, v192, v193
    v_cvt_pk_bf16_f32 v193, v194, v195
    v_cvt_pk_bf16_f32 v194, v200, v201
    v_cvt_pk_bf16_f32 v195, v202, v203
    buffer_store_dwordx4 v[192:195], v218, s[4:7], s70 offen offset:2048
    v_pk_fma_f32 v[196:197], v[226:227], v[116:117], v[196:197] op_sel:[1,0,0] op_sel_hi:[1,1,1]
    v_pk_fma_f32 v[198:199], v[226:227], v[118:119], v[198:199] op_sel:[1,0,0] op_sel_hi:[1,1,1]
    v_pk_fma_f32 v[204:205], v[226:227], v[120:121], v[204:205] op_sel:[1,0,0] op_sel_hi:[1,1,1]
    v_pk_fma_f32 v[206:207], v[226:227], v[122:123], v[206:207] op_sel:[1,0,0] op_sel_hi:[1,1,1]
    v_pk_fma_f32 v[196:197], v[228:229], v[196:197], v[140:141] op_sel:[1,0,0] op_sel_hi:[1,1,1]
    v_pk_fma_f32 v[198:199], v[228:229], v[198:199], v[142:143] op_sel:[1,0,0] op_sel_hi:[1,1,1]
    v_pk_fma_f32 v[204:205], v[228:229], v[204:205], v[144:145] op_sel:[1,0,0] op_sel_hi:[1,1,1]
    v_pk_fma_f32 v[206:207], v[228:229], v[206:207], v[146:147] op_sel:[1,0,0] op_sel_hi:[1,1,1]
    v_max_f32 v196, 0, v196
    v_max_f32 v197, 0, v197
    v_max_f32 v198, 0, v198
    v_max_f32 v199, 0, v199
    v_max_f32 v204, 0, v204
    v_max_f32 v205, 0, v205
    v_max_f32 v206, 0, v206
    v_max_f32 v207, 0, v207
    v_pk_mul_f32 v[196:197], v[196:197], v[196:197]
    v_pk_mul_f32 v[198:199], v[198:199], v[198:199]
    v_pk_mul_f32 v[204:205], v[204:205], v[204:205]
    v_pk_mul_f32 v[206:207], v[206:207], v[206:207]
    v_cvt_pk_bf16_f32 v196, v196, v197
    v_cvt_pk_bf16_f32 v197, v198, v199
    v_cvt_pk_bf16_f32 v198, v204, v205
    v_cvt_pk_bf16_f32 v199, v206, v207
    buffer_store_dwordx4 v[196:199], v218, s[4:7], s60 offen offset:2048
    s_mov_b64 exec, 1
    v_mov_b32 v230, s28
    v_mov_b32 v231, s29
    s_cmp_lg_u32 s27, 0
    s_cbranch_scc1 L_slowpub_23
    s_waitcnt vmcnt(0)
    buffer_store_dwordx2 v[230:231], off, s[4:7], s35 offset:3072
L_pubdone_24:
    s_mov_b64 exec, -1
    s_barrier
    s_mul_i32 s64, s24, 25600
    v_add_u32 v219, s64, v218
    ds_write_b128 v219, a[140:143] offset:0
    buffer_load_dwordx4 v[24:27], v218, s[4:7], s100 offen offset:2048 sc1
    ds_write_b128 v219, a[144:147] offset:1024
    buffer_load_dwordx4 v[28:31], v218, s[4:7], s100 offen offset:3072 sc1
    ds_write_b128 v219, a[148:151] offset:2048
    s_add_u32 s100, s85, 44032
    buffer_load_dwordx4 v[32:35], v218, s[4:7], s100 offen offset:0 sc1
    ds_write_b128 v219, a[152:155] offset:3072
    buffer_load_dwordx4 v[36:39], v218, s[4:7], s100 offen offset:1024 sc1
    ds_write_b128 v219, a[156:159] offset:4096
    buffer_load_dwordx4 v[40:43], v218, s[4:7], s100 offen offset:2048 sc1
    ds_write_b128 v219, a[160:163] offset:5120
    buffer_load_dwordx4 v[44:47], v218, s[4:7], s100 offen offset:3072 sc1
    ds_write_b128 v219, a[164:167] offset:6144
    s_add_u32 s100, s85, 48128
    buffer_load_dwordx4 v[48:51], v218, s[4:7], s100 offen offset:0 sc1
    ds_write_b128 v219, a[168:171] offset:7168
    buffer_load_dwordx4 v[52:55], v218, s[4:7], s100 offen offset:1024 sc1
    ds_write_b128 v219, a[172:175] offset:8192
    buffer_load_dwordx4 v[56:59], v218, s[4:7], s100 offen offset:2048 sc1
    ds_write_b128 v219, a[176:179] offset:9216
    buffer_load_dwordx4 v[60:63], v218, s[4:7], s100 offen offset:3072 sc1
    ds_write_b128 v219, a[180:183] offset:10240
    s_add_u32 s100, s85, 52224
    buffer_load_dwordx4 v[64:67], v218, s[4:7], s100 offen offset:0 sc1
    ds_write_b128 v219, a[184:187] offset:11264
    buffer_load_dwordx4 v[68:71], v218, s[4:7], s100 offen offset:1024 sc1
    ds_write_b128 v219, a[188:191] offset:12288
    buffer_load_dwordx4 v[72:75], v218, s[4:7], s100 offen offset:2048 sc1
    ds_write_b128 v219, a[192:195] offset:13312
    buffer_load_dwordx4 v[76:79], v218, s[4:7], s100 offen offset:3072 sc1
    ds_write_b128 v219, a[196:199] offset:14336
    s_add_u32 s100, s85, 56320
    buffer_load_dwordx4 v[80:83], v218, s[4:7], s100 offen offset:0 sc1
    s_waitcnt lgkmcnt(14)
    ds_write_b128 v219, a[200:203] offset:15360
    buffer_load_dwordx4 v[84:87], v218, s[4:7], s100 offen offset:1024 sc1
    s_waitcnt lgkmcnt(14)
    ds_write_b128 v219, a[204:207] offset:16384
    buffer_load_dwordx4 v[88:91], v218, s[4:7], s100 offen offset:2048 sc1
    s_waitcnt lgkmcnt(14)
    ds_write_b128 v219, a[208:211] offset:17408
    buffer_load_dwordx4 v[92:95], v218, s[4:7], s100 offen offset:3072 sc1
    s_waitcnt lgkmcnt(14)
    ds_write_b128 v219, a[212:215] offset:18432
    s_add_u32 s100, s85, 60416
    buffer_load_dwordx4 v[96:99], v218, s[4:7], s100 offen offset:0 sc1
    s_waitcnt lgkmcnt(14)
    ds_write_b128 v219, a[216:219] offset:19456
    s_waitcnt lgkmcnt(14)
    ds_write_b128 v219, a[220:223] offset:20480
    s_waitcnt lgkmcnt(14)
    ds_write_b128 v219, a[224:227] offset:21504
    s_waitcnt lgkmcnt(14)
    ds_write_b128 v219, a[228:231] offset:22528
    s_waitcnt lgkmcnt(14)
    ds_write_b128 v219, a[232:235] offset:23552
    s_waitcnt lgkmcnt(14)
    ds_write_b128 v219, a[236:239] offset:24576
    s_add_u32 s100, s85, 10240
    buffer_load_dwordx4 a[140:143], v218, s[4:7], s100 offen offset:0 sc1
    buffer_load_dwordx4 a[144:147], v218, s[4:7], s100 offen offset:1024 sc1
    buffer_load_dwordx4 a[148:151], v218, s[4:7], s100 offen offset:2048 sc1
    buffer_load_dwordx4 a[152:155], v218, s[4:7], s100 offen offset:3072 sc1
    s_add_u32 s100, s85, 14336
    buffer_load_dwordx4 a[156:159], v218, s[4:7], s100 offen offset:0 sc1
    buffer_load_dwordx4 a[160:163], v218, s[4:7], s100 offen offset:1024 sc1
    buffer_load_dwordx4 a[164:167], v218, s[4:7], s100 offen offset:2048 sc1
    buffer_load_dwordx4 a[168:171], v218, s[4:7], s100 offen offset:3072 sc1
    s_add_u32 s100, s85, 18432
    buffer_load_dwordx4 a[172:175], v218, s[4:7], s100 offen offset:0 sc1
    buffer_load_dwordx4 a[176:179], v218, s[4:7], s100 offen offset:1024 sc1
    buffer_load_dwordx4 a[180:183], v218, s[4:7], s100 offen offset:2048 sc1
    buffer_load_dwordx4 a[184:187], v218, s[4:7], s100 offen offset:3072 sc1
    s_add_u32 s100, s85, 22528
    buffer_load_dwordx4 a[188:191], v218, s[4:7], s100 offen offset:0 sc1
    buffer_load_dwordx4 a[192:195], v218, s[4:7], s100 offen offset:1024 sc1
    buffer_load_dwordx4 a[196:199], v218, s[4:7], s100 offen offset:2048 sc1
    buffer_load_dwordx4 a[200:203], v218, s[4:7], s100 offen offset:3072 sc1
    s_add_u32 s100, s85, 26624
    buffer_load_dwordx4 a[204:207], v218, s[4:7], s100 offen offset:0 sc1
    buffer_load_dwordx4 a[208:211], v218, s[4:7], s100 offen offset:1024 sc1
    buffer_load_dwordx4 a[212:215], v218, s[4:7], s100 offen offset:2048 sc1
    buffer_load_dwordx4 a[216:219], v218, s[4:7], s100 offen offset:3072 sc1
    s_add_u32 s100, s85, 30720
    buffer_load_dwordx4 a[220:223], v218, s[4:7], s100 offen offset:0 sc1
    buffer_load_dwordx4 a[224:227], v218, s[4:7], s100 offen offset:1024 sc1
    buffer_load_dwordx4 a[228:231], v218, s[4:7], s100 offen offset:2048 sc1
    buffer_load_dwordx4 a[232:235], v218, s[4:7], s100 offen offset:3072 sc1
    s_add_u32 s100, s85, 34816
    buffer_load_dwordx4 a[236:239], v218, s[4:7], s100 offen offset:0 sc1
    s_mul_i32 s35, s24, 12288
    s_add_u32 s35, s35, s94
    s_mul_i32 s90, s71, 49152
    s_add_u32 s90, s90, s35
    s_mul_i32 s91, s72, 49152
    s_add_u32 s91, s91, s35
    s_mul_i32 s92, s73, 49152
    s_add_u32 s92, s92, s35
    s_mul_i32 s93, s74, 49152
    s_add_u32 s93, s93, s35
    v_lshrrev_b32 v206, 1, v218
    s_mov_b32 exec_lo, 0xff
    s_mov_b32 exec_hi, 0x0
    s_mov_b32 s65, 262144
L_poll_25:
    buffer_load_dwordx2 v[204:205], v206, s[4:7], s81 offen offset:3072 sc1
    s_sub_u32 s65, s65, 1
    s_cbranch_scc1 L_polled_26
    s_waitcnt vmcnt(0)
    v_cmp_ne_u64 vcc, s[28:29], v[204:205]
    s_cbranch_vccnz L_poll_25
L_polled_26:
    s_mov_b64 exec, -1
    s_cmp_lg_u32 s27, 0
    s_cbranch_scc1 L_slowacq_27
L_acqdone_28:
    s_add_u32 s62, s90, 0
    buffer_load_dwordx4 v[100:103], v218, s[4:7], s62 offen offset:0 sc1
    buffer_load_dwordx4 v[104:107], v218, s[4:7], s62 offen offset:1024 sc1
    buffer_load_dwordx4 v[108:111], v218, s[4:7], s62 offen offset:2048 sc1
    buffer_load_dwordx4 v[112:115], v218, s[4:7], s62 offen offset:3072 sc1
    s_add_u32 s62, s90, 4096
    buffer_load_dwordx4 v[116:119], v218, s[4:7], s62 offen offset:0 sc1
    buffer_load_dwordx4 v[120:123], v218, s[4:7], s62 offen offset:1024 sc1
    s_waitcnt vmcnt(5)
    v_mfma_f32_16x16x32_bf16 v[164:167], a[100:103], v[100:103], 0
    buffer_load_dwordx4 v[124:127], v218, s[4:7], s62 offen offset:2048 sc1
    v_mfma_f32_16x16x32_bf16 v[168:171], a[104:107], v[100:103], 0
    v_mfma_f32_16x16x32_bf16 v[172:175], a[108:111], v[100:103], 0
    v_mfma_f32_16x16x32_bf16 v[176:179], a[112:115], v[100:103], 0
    v_mfma_f32_16x16x32_bf16 v[180:183], a[116:119], v[100:103], 0
    s_waitcnt vmcnt(5)
    buffer_load_dwordx4 v[128:131], v218, s[4:7], s62 offen offset:3072 sc1
    v_mfma_f32_16x16x32_bf16 v[164:167], a[120:123], v[104:107], v[164:167]
    s_mul_i32 s35, s24, 10240
    s_add_u32 s35, s35, 112640
    v_mfma_f32_16x16x32_bf16 v[168:171], a[124:127], v[104:107], v[168:171]
    v_add_u32 v219, s35, v218
    v_mfma_f32_16x16x32_bf16 v[172:175], a[128:131], v[104:107], v[172:175]
    v_lshlrev_b32 v230, 16, v208
    v_and_b32 v231, 0xffff0000, v208
    v_mfma_f32_16x16x32_bf16 v[176:179], a[132:135], v[104:107], v[176:179]
    v_lshlrev_b32 v232, 16, v209
    v_mfma_f32_16x16x32_bf16 v[180:183], a[136:139], v[104:107], v[180:183]
    s_waitcnt vmcnt(5)
    s_add_u32 s62, s90, 8192
    v_and_b32 v233, 0xffff0000, v209
    v_mfma_f32_16x16x32_bf16 v[164:167], a[140:143], v[108:111], v[164:167]
    buffer_load_dwordx4 v[132:135], v218, s[4:7], s62 offen offset:0 sc1
    v_mfma_f32_16x16x32_bf16 v[168:171], a[144:147], v[108:111], v[168:171]
    v_lshlrev_b32 v234, 16, v210
    v_and_b32 v235, 0xffff0000, v210
    v_mfma_f32_16x16x32_bf16 v[172:175], a[148:151], v[108:111], v[172:175]
    v_lshlrev_b32 v236, 16, v211
    v_and_b32 v237, 0xffff0000, v211
    v_mfma_f32_16x16x32_bf16 v[176:179], a[152:155], v[108:111], v[176:179]
    v_lshlrev_b32 v238, 16, v212
    v_mfma_f32_16x16x32_bf16 v[180:183], a[156:159], v[108:111], v[180:183]
    s_waitcnt vmcnt(5)
    buffer_load_dwordx4 v[136:139], v218, s[4:7], s62 offen offset:1024 sc1
    v_mfma_f32_16x16x32_bf16 v[164:167], a[160:163], v[112:115], v[164:167]
    v_and_b32 v239, 0xffff0000, v212
    v_lshlrev_b32 v240, 16, v213
    v_mfma_f32_16x16x32_bf16 v[168:171], a[164:167], v[112:115], v[168:171]
    v_and_b32 v241, 0xffff0000, v213
    v_lshlrev_b32 v242, 16, v214
    v_mfma_f32_16x16x32_bf16 v[172:175], a[168:171], v[112:115], v[172:175]
    v_and_b32 v243, 0xffff0000, v214
    v_mfma_f32_16x16x32_bf16 v[176:179], a[172:175], v[112:115], v[176:179]
    v_lshlrev_b32 v244, 16, v215
    v_mfma_f32_16x16x32_bf16 v[180:183], a[176:179], v[112:115], v[180:183]
    s_waitcnt vmcnt(5)
    buffer_load_dwordx4 v[140:143], v218, s[4:7], s62 offen offset:2048 sc1
    v_mfma_f32_16x16x32_bf16 v[164:167], a[180:183], v[116:119], v[164:167]
    v_and_b32 v245, 0xffff0000, v215
    v_lshlrev_b32 v246, 16, v216
    v_mfma_f32_16x16x32_bf16 v[168:171], a[184:187], v[116:119], v[168:171]
    v_and_b32 v247, 0xffff0000, v216
    v_lshlrev_b32 v248, 16, v217
    v_mfma_f32_16x16x32_bf16 v[172:175], a[188:191], v[116:119], v[172:175]
    v_and_b32 v249, 0xffff0000, v217
    v_mfma_f32_16x16x32_bf16 v[176:179], a[192:195], v[116:119], v[176:179]
    v_mfma_f32_16x16x32_bf16 v[180:183], a[196:199], v[116:119], v[180:183]
    s_waitcnt vmcnt(5)
    buffer_load_dwordx4 v[100:103], v218, s[4:7], s62 offen offset:3072 sc1
    v_mfma_f32_16x16x32_bf16 v[164:167], a[200:203], v[120:123], v[164:167]
    v_mfma_f32_16x16x32_bf16 v[168:171], a[204:207], v[120:123], v[168:171]
    v_mfma_f32_16x16x32_bf16 v[172:175], a[208:211], v[120:123], v[172:175]
    v_mfma_f32_16x16x32_bf16 v[176:179], a[212:215], v[120:123], v[176:179]
    s_add_u32 s62, s91, 0
    buffer_load_dwordx4 v[104:107], v218, s[4:7], s62 offen offset:0 sc1
    v_mfma_f32_16x16x32_bf16 v[180:183], a[216:219], v[120:123], v[180:183]
    s_waitcnt vmcnt(6)
    v_mfma_f32_16x16x32_bf16 v[164:167], a[220:223], v[124:127], v[164:167]
    v_mfma_f32_16x16x32_bf16 v[168:171], a[224:227], v[124:127], v[168:171]
    v_mfma_f32_16x16x32_bf16 v[172:175], a[228:231], v[124:127], v[172:175]
    v_mfma_f32_16x16x32_bf16 v[176:179], a[232:235], v[124:127], v[176:179]
    buffer_load_dwordx4 v[108:111], v218, s[4:7], s62 offen offset:1024 sc1
    v_mfma_f32_16x16x32_bf16 v[180:183], a[236:239], v[124:127], v[180:183]
    s_waitcnt vmcnt(6)
    v_mfma_f32_16x16x32_bf16 v[164:167], v[0:3], v[128:131], v[164:167]
    v_mfma_f32_16x16x32_bf16 v[168:171], v[4:7], v[128:131], v[168:171]
    v_mfma_f32_16x16x32_bf16 v[172:175], v[8:11], v[128:131], v[172:175]
    v_mfma_f32_16x16x32_bf16 v[176:179], v[12:15], v[128:131], v[176:179]
    buffer_load_dwordx4 v[112:115], v218, s[4:7], s62 offen offset:2048 sc1
    v_mfma_f32_16x16x32_bf16 v[180:183], v[16:19], v[128:131], v[180:183]
    s_waitcnt vmcnt(6)
    v_mfma_f32_16x16x32_bf16 v[164:167], v[20:23], v[132:135], v[164:167]
    v_mfma_f32_16x16x32_bf16 v[168:171], v[24:27], v[132:135], v[168:171]
    v_mfma_f32_16x16x32_bf16 v[172:175], v[28:31], v[132:135], v[172:175]
    v_mfma_f32_16x16x32_bf16 v[176:179], v[32:35], v[132:135], v[176:179]
    buffer_load_dwordx4 v[116:119], v218, s[4:7], s62 offen offset:3072 sc1
    v_mfma_f32_16x16x32_bf16 v[180:183], v[36:39], v[132:135], v[180:183]
    s_waitcnt vmcnt(6)
    v_mfma_f32_16x16x32_bf16 v[164:167], v[40:43], v[136:139], v[164:167]
    v_mfma_f32_16x16x32_bf16 v[168:171], v[44:47], v[136:139], v[168:171]
    v_mfma_f32_16x16x32_bf16 v[172:175], v[48:51], v[136:139], v[172:175]
    s_add_u32 s62, s91, 4096
    buffer_load_dwordx4 v[120:123], v218, s[4:7], s62 offen offset:0 sc1
    v_mfma_f32_16x16x32_bf16 v[176:179], v[52:55], v[136:139], v[176:179]
    v_mfma_f32_16x16x32_bf16 v[180:183], v[56:59], v[136:139], v[180:183]
    s_waitcnt vmcnt(6)
    v_mfma_f32_16x16x32_bf16 v[164:167], v[60:63], v[140:143], v[164:167]
    v_mfma_f32_16x16x32_bf16 v[168:171], v[64:67], v[140:143], v[168:171]
    v_mfma_f32_16x16x32_bf16 v[172:175], v[68:71], v[140:143], v[172:175]
    buffer_load_dwordx4 v[124:127], v218, s[4:7], s62 offen offset:1024 sc1
    v_mfma_f32_16x16x32_bf16 v[176:179], v[72:75], v[140:143], v[176:179]
    v_mfma_f32_16x16x32_bf16 v[180:183], v[76:79], v[140:143], v[180:183]
    s_waitcnt vmcnt(6)
    s_and_b32 s35, s71, 3
    v_mfma_f32_16x16x32_bf16 v[164:167], v[80:83], v[100:103], v[164:167]
    s_mul_i32 s35, s35, 10240
    v_mfma_f32_16x16x32_bf16 v[168:171], v[84:87], v[100:103], v[168:171]
    s_add_u32 s35, s35, 112640
    v_mfma_f32_16x16x32_bf16 v[172:175], v[88:91], v[100:103], v[172:175]
    buffer_load_dwordx4 v[128:131], v218, s[4:7], s62 offen offset:2048 sc1
    v_mfma_f32_16x16x32_bf16 v[176:179], v[92:95], v[100:103], v[176:179]
    v_add_u32 v223, s35, v218
    v_mfma_f32_16x16x32_bf16 v[180:183], v[96:99], v[100:103], v[180:183]
    s_waitcnt vmcnt(6)
    v_mfma_f32_16x16x32_bf16 v[184:187], a[100:103], v[104:107], 0
    v_mfma_f32_16x16x32_bf16 v[188:191], a[104:107], v[104:107], 0
    s_waitcnt lgkmcnt(14)
    ds_write_b128 v223, v[164:167] offset:0
    v_mfma_f32_16x16x32_bf16 v[192:195], a[108:111], v[104:107], 0
    buffer_load_dwordx4 v[132:135], v218, s[4:7], s62 offen offset:3072 sc1
    v_mfma_f32_16x16x32_bf16 v[196:199], a[112:115], v[104:107], 0
    v_mfma_f32_16x16x32_bf16 v[200:203], a[116:119], v[104:107], 0
    s_waitcnt vmcnt(6)
    s_waitcnt lgkmcnt(14)
    ds_write_b128 v223, v[168:171] offset:1024
    v_mfma_f32_16x16x32_bf16 v[184:187], a[120:123], v[108:111], v[184:187]
    v_mfma_f32_16x16x32_bf16 v[188:191], a[124:127], v[108:111], v[188:191]
    v_mfma_f32_16x16x32_bf16 v[192:195], a[128:131], v[108:111], v[192:195]
    s_add_u32 s62, s91, 8192
    buffer_load_dwordx4 v[136:139], v218, s[4:7], s62 offen offset:0 sc1
    v_mfma_f32_16x16x32_bf16 v[196:199], a[132:135], v[108:111], v[196:199]
    s_waitcnt lgkmcnt(14)
    ds_write_b128 v223, v[172:175] offset:2048
    v_mfma_f32_16x16x32_bf16 v[200:203], a[136:139], v[108:111], v[200:203]
    s_waitcnt vmcnt(6)
    v_mfma_f32_16x16x32_bf16 v[184:187], a[140:143], v[112:115], v[184:187]
    s_waitcnt lgkmcnt(14)
    ds_write_b128 v223, v[176:179] offset:3072
    v_mfma_f32_16x16x32_bf16 v[188:191], a[144:147], v[112:115], v[188:191]
    buffer_load_dwordx4 v[140:143], v218, s[4:7], s62 offen offset:1024 sc1
    v_mfma_f32_16x16x32_bf16 v[192:195], a[148:151], v[112:115], v[192:195]
    v_mfma_f32_16x16x32_bf16 v[196:199], a[152:155], v[112:115], v[196:199]
    s_waitcnt lgkmcnt(14)
    ds_write_b128 v223, v[180:183] offset:4096
    v_mfma_f32_16x16x32_bf16 v[200:203], a[156:159], v[112:115], v[200:203]
    s_waitcnt vmcnt(6)
    v_mfma_f32_16x16x32_bf16 v[184:187], a[160:163], v[116:119], v[184:187]
    v_mfma_f32_16x16x32_bf16 v[188:191], a[164:167], v[116:119], v[188:191]
    buffer_load_dwordx4 v[100:103], v218, s[4:7], s62 offen offset:2048 sc1
    v_mfma_f32_16x16x32_bf16 v[192:195], a[168:171], v[116:119], v[192:195]
    v_mfma_f32_16x16x32_bf16 v[196:199], a[172:175], v[116:119], v[196:199]
    v_mfma_f32_16x16x32_bf16 v[200:203], a[176:179], v[116:119], v[200:203]
    s_waitcnt vmcnt(6)
    s_waitcnt lgkmcnt(14)
    ds_read_b128 v[144:147], v225 offset:1536
    v_mfma_f32_16x16x32_bf16 v[184:187], a[180:183], v[120:123], v[184:187]
    s_waitcnt lgkmcnt(14)
    ds_read_b128 v[148:151], v225 offset:1600
    v_mfma_f32_16x16x32_bf16 v[188:191], a[184:187], v[120:123], v[188:191]
    s_waitcnt lgkmcnt(14)
    ds_read_b128 v[152:155], v225 offset:1664
    v_mfma_f32_16x16x32_bf16 v[192:195], a[188:191], v[120:123], v[192:195]
    s_waitcnt lgkmcnt(14)
    ds_read_b128 v[156:159], v225 offset:1728
    v_mfma_f32_16x16x32_bf16 v[196:199], a[192:195], v[120:123], v[196:199]
    s_waitcnt lgkmcnt(14)
    ds_read_b128 v[160:163], v225 offset:1792
    v_mfma_f32_16x16x32_bf16 v[200:203], a[196:199], v[120:123], v[200:203]
    s_waitcnt vmcnt(5)
    buffer_load_dwordx4 v[104:107], v218, s[4:7], s62 offen offset:3072 sc1
    v_mfma_f32_16x16x32_bf16 v[184:187], a[200:203], v[124:127], v[184:187]
    v_mfma_f32_16x16x32_bf16 v[188:191], a[204:207], v[124:127], v[188:191]
    s_add_u32 s62, s92, 0
    buffer_load_dwordx4 v[108:111], v218, s[4:7], s62 offen offset:0 sc1
    v_mfma_f32_16x16x32_bf16 v[192:195], a[208:211], v[124:127], v[192:195]
    v_mfma_f32_16x16x32_bf16 v[196:199], a[212:215], v[124:127], v[196:199]
    v_mfma_f32_16x16x32_bf16 v[200:203], a[216:219], v[124:127], v[200:203]
    s_waitcnt vmcnt(6)
    v_mfma_f32_16x16x32_bf16 v[184:187], a[220:223], v[128:131], v[184:187]
    v_mfma_f32_16x16x32_bf16 v[188:191], a[224:227], v[128:131], v[188:191]
    s_waitcnt lgkmcnt(4)
    v_add_f32 v230, v230, v144
    v_mfma_f32_16x16x32_bf16 v[192:195], a[228:231], v[128:131], v[192:195]
    buffer_load_dwordx4 v[112:115], v218, s[4:7], s62 offen offset:1024 sc1
    v_mfma_f32_16x16x32_bf16 v[196:199], a[232:235], v[128:131], v[196:199]
    v_add_f32 v231, v231, v145
    v_add_f32 v232, v232, v146
    v_mfma_f32_16x16x32_bf16 v[200:203], a[236:239], v[128:131], v[200:203]
    s_waitcnt vmcnt(6)
    v_add_f32 v233, v233, v147
    v_mfma_f32_16x16x32_bf16 v[184:187], v[0:3], v[132:135], v[184:187]
    s_waitcnt lgkmcnt(3)
    v_add_f32 v234, v234, v148
    v_mfma_f32_16x16x32_bf16 v[188:191], v[4:7], v[132:135], v[188:191]
    buffer_load_dwordx4 v[116:119], v218, s[4:7], s62 offen offset:2048 sc1
    v_mfma_f32_16x16x32_bf16 v[192:195], v[8:11], v[132:135], v[192:195]
    v_add_f32 v235, v235, v149
    v_add_f32 v236, v236, v150
    v_mfma_f32_16x16x32_bf16 v[196:199], v[12:15], v[132:135], v[196:199]
    v_add_f32 v237, v237, v151
    v_mfma_f32_16x16x32_bf16 v[200:203], v[16:19], v[132:135], v[200:203]
    s_waitcnt vmcnt(6)
    s_waitcnt lgkmcnt(2)
    v_add_f32 v238, v238, v152
    v_mfma_f32_16x16x32_bf16 v[184:187], v[20:23], v[136:139], v[184:187]
    buffer_load_dwordx4 v[120:123], v218, s[4:7], s62 offen offset:3072 sc1
    v_mfma_f32_16x16x32_bf16 v[188:191], v[24:27], v[136:139], v[188:191]
    v_add_f32 v239, v239, v153
    v_add_f32 v240, v240, v154
    v_mfma_f32_16x16x32_bf16 v[192:195], v[28:31], v[136:139], v[192:195]
    v_add_f32 v241, v241, v155
    v_mfma_f32_16x16x32_bf16 v[196:199], v[32:35], v[136:139], v[196:199]
    s_waitcnt lgkmcnt(1)
    v_add_f32 v242, v242, v156
    v_mfma_f32_16x16x32_bf16 v[200:203], v[36:39], v[136:139], v[200:203]
    s_waitcnt vmcnt(6)
    v_add_f32 v243, v243, v157
    v_mfma_f32_16x16x32_bf16 v[184:187], v[40:43], v[140:143], v[184:187]
    s_add_u32 s62, s92, 4096
    buffer_load_dwordx4 v[124:127], v218, s[4:7], s62 offen offset:0 sc1
    v_mfma_f32_16x16x32_bf16 v[188:191], v[44:47], v[140:143], v[188:191]
    v_add_f32 v244, v244, v158
    v_add_f32 v245, v245, v159
    v_mfma_f32_16x16x32_bf16 v[192:195], v[48:51], v[140:143], v[192:195]
    s_waitcnt lgkmcnt(0)
    v_add_f32 v246, v246, v160
    v_mfma_f32_16x16x32_bf16 v[196:199], v[52:55], v[140:143], v[196:199]
    v_add_f32 v247, v247, v161
    v_mfma_f32_16x16x32_bf16 v[200:203], v[56:59], v[140:143], v[200:203]
    s_waitcnt vmcnt(6)
    v_add_f32 v248, v248, v162
    v_mfma_f32_16x16x32_bf16 v[184:187], v[60:63], v[100:103], v[184:187]
    buffer_load_dwordx4 v[128:131], v218, s[4:7], s62 offen offset:1024 sc1
    v_mfma_f32_16x16x32_bf16 v[188:191], v[64:67], v[100:103], v[188:191]
    v_add_f32 v249, v249, v163
    v_mfma_f32_16x16x32_bf16 v[192:195], v[68:71], v[100:103], v[192:195]
    v_mfma_f32_16x16x32_bf16 v[196:199], v[72:75], v[100:103], v[196:199]
    v_mfma_f32_16x16x32_bf16 v[200:203], v[76:79], v[100:103], v[200:203]
    s_waitcnt vmcnt(6)
    s_and_b32 s35, s72, 3
    v_mfma_f32_16x16x32_bf16 v[184:187], v[80:83], v[104:107], v[184:187]
    s_mul_i32 s35, s35, 10240
    buffer_load_dwordx4 v[132:135], v218, s[4:7], s62 offen offset:2048 sc1
    v_mfma_f32_16x16x32_bf16 v[188:191], v[84:87], v[104:107], v[188:191]
    s_add_u32 s35, s35, 117760
    v_mfma_f32_16x16x32_bf16 v[192:195], v[88:91], v[104:107], v[192:195]
    v_add_u32 v223, s35, v218
    v_mfma_f32_16x16x32_bf16 v[196:199], v[92:95], v[104:107], v[196:199]
    v_mfma_f32_16x16x32_bf16 v[200:203], v[96:99], v[104:107], v[200:203]
    s_waitcnt vmcnt(6)
    buffer_load_dwordx4 v[136:139], v218, s[4:7], s62 offen offset:3072 sc1
    v_mfma_f32_16x16x32_bf16 v[164:167], a[100:103], v[108:111], 0
    s_barrier
    ds_read_b128 v[144:147], v219 offset:0
    ds_read_b128 v[148:151], v219 offset:1024
    v_mfma_f32_16x16x32_bf16 v[168:171], a[104:107], v[108:111], 0
    ds_read_b128 v[152:155], v219 offset:2048
    ds_read_b128 v[156:159], v219 offset:3072
    v_mfma_f32_16x16x32_bf16 v[172:175], a[108:111], v[108:111], 0
    ds_write_b128 v223, v[184:187] offset:0
    v_mfma_f32_16x16x32_bf16 v[176:179], a[112:115], v[108:111], 0
    ds_read_b128 v[160:163], v219 offset:4096
    v_mfma_f32_16x16x32_bf16 v[180:183], a[116:119], v[108:111], 0
    s_waitcnt vmcnt(6)
    s_add_u32 s62, s92, 8192
    v_mfma_f32_16x16x32_bf16 v[164:167], a[120:123], v[112:115], v[164:167]
    buffer_load_dwordx4 v[140:143], v218, s[4:7], s62 offen offset:0 sc1
    v_mfma_f32_16x16x32_bf16 v[168:171], a[124:127], v[112:115], v[168:171]
    ds_write_b128 v223, v[188:191] offset:1024
    v_mfma_f32_16x16x32_bf16 v[172:175], a[128:131], v[112:115], v[172:175]
    ds_write_b128 v223, v[192:195] offset:2048
    v_mfma_f32_16x16x32_bf16 v[176:179], a[132:135], v[112:115], v[176:179]
    s_waitcnt lgkmcnt(7)
    v_add_f32 v230, v230, v144
    v_add_f32 v231, v231, v145
    v_mfma_f32_16x16x32_bf16 v[180:183], a[136:139], v[112:115], v[180:183]
    s_waitcnt vmcnt(6)
    buffer_load_dwordx4 v[100:103], v218, s[4:7], s62 offen offset:1024 sc1
    v_mfma_f32_16x16x32_bf16 v[164:167], a[140:143], v[116:119], v[164:167]
    v_add_f32 v232, v232, v146
    v_mfma_f32_16x16x32_bf16 v[168:171], a[144:147], v[116:119], v[168:171]
    ds_write_b128 v223, v[196:199] offset:3072
    v_mfma_f32_16x16x32_bf16 v[172:175], a[148:151], v[116:119], v[172:175]
    v_add_f32 v233, v233, v147
    v_mfma_f32_16x16x32_bf16 v[176:179], a[152:155], v[116:119], v[176:179]
    s_waitcnt lgkmcnt(7)
    v_add_f32 v234, v234, v148
    v_add_f32 v235, v235, v149
    v_mfma_f32_16x16x32_bf16 v[180:183], a[156:159], v[116:119], v[180:183]
    s_waitcnt vmcnt(6)
    buffer_load_dwordx4 v[104:107], v218, s[4:7], s62 offen offset:2048 sc1
    v_mfma_f32_16x16x32_bf16 v[164:167], a[160:163], v[120:123], v[164:167]
    ds_write_b128 v223, v[200:203] offset:4096
    v_add_f32 v236, v236, v150
    v_mfma_f32_16x16x32_bf16 v[168:171], a[164:167], v[120:123], v[168:171]
    v_add_f32 v237, v237, v151
    v_mfma_f32_16x16x32_bf16 v[172:175], a[168:171], v[120:123], v[172:175]
    s_waitcnt lgkmcnt(7)
    v_add_f32 v238, v238, v152
    v_add_f32 v239, v239, v153
    v_mfma_f32_16x16x32_bf16 v[176:179], a[172:175], v[120:123], v[176:179]
    v_add_f32 v240, v240, v154
    v_add_f32 v241, v241, v155
    v_mfma_f32_16x16x32_bf16 v[180:183], a[176:179], v[120:123], v[180:183]
    s_waitcnt vmcnt(6)
    buffer_load_dwordx4 v[108:111], v218, s[4:7], s62 offen offset:3072 sc1
    v_mfma_f32_16x16x32_bf16 v[164:167], a[180:183], v[124:127], v[164:167]
    s_waitcnt lgkmcnt(6)
    v_add_f32 v242, v242, v156
    v_add_f32 v243, v243, v157
    v_mfma_f32_16x16x32_bf16 v[168:171], a[184:187], v[124:127], v[168:171]
    v_add_f32 v244, v244, v158
    v_mfma_f32_16x16x32_bf16 v[172:175], a[188:191], v[124:127], v[172:175]
    v_add_f32 v245, v245, v159
    v_mfma_f32_16x16x32_bf16 v[176:179], a[192:195], v[124:127], v[176:179]
    s_waitcnt lgkmcnt(4)
    v_add_f32 v246, v246, v160
    v_mfma_f32_16x16x32_bf16 v[180:183], a[196:199], v[124:127], v[180:183]
    s_waitcnt vmcnt(6)
    s_add_u32 s62, s93, 0
    v_add_f32 v247, v247, v161
    v_mfma_f32_16x16x32_bf16 v[164:167], a[200:203], v[128:131], v[164:167]
    buffer_load_dwordx4 v[112:115], v218, s[4:7], s62 offen offset:0 sc1
    v_mfma_f32_16x16x32_bf16 v[168:171], a[204:207], v[128:131], v[168:171]
    v_add_f32 v248, v248, v162
    v_add_f32 v249, v249, v163
    v_mfma_f32_16x16x32_bf16 v[172:175], a[208:211], v[128:131], v[172:175]
    v_mfma_f32_16x16x32_bf16 v[176:179], a[212:215], v[128:131], v[176:179]
    buffer_load_dwordx4 v[116:119], v218, s[4:7], s62 offen offset:1024 sc1
    v_mfma_f32_16x16x32_bf16 v[180:183], a[216:219], v[128:131], v[180:183]
    s_waitcnt vmcnt(7)
    v_mfma_f32_16x16x32_bf16 v[164:167], a[220:223], v[132:135], v[164:167]
    v_mfma_f32_16x16x32_bf16 v[168:171], a[224:227], v[132:135], v[168:171]
    v_mfma_f32_16x16x32_bf16 v[172:175], a[228:231], v[132:135], v[172:175]
    v_mfma_f32_16x16x32_bf16 v[176:179], a[232:235], v[132:135], v[176:179]
    buffer_load_dwordx4 v[120:123], v218, s[4:7], s62 offen offset:2048 sc1
    v_mfma_f32_16x16x32_bf16 v[180:183], a[236:239], v[132:135], v[180:183]
    s_waitcnt vmcnt(7)
    v_mfma_f32_16x16x32_bf16 v[164:167], v[0:3], v[136:139], v[164:167]
    v_mfma_f32_16x16x32_bf16 v[168:171], v[4:7], v[136:139], v[168:171]
    v_mfma_f32_16x16x32_bf16 v[172:175], v[8:11], v[136:139], v[172:175]
    v_mfma_f32_16x16x32_bf16 v[176:179], v[12:15], v[136:139], v[176:179]
    buffer_load_dwordx4 v[124:127], v218, s[4:7], s62 offen offset:3072 sc1
    v_mfma_f32_16x16x32_bf16 v[180:183], v[16:19], v[136:139], v[180:183]
    s_waitcnt vmcnt(7)
    v_mfma_f32_16x16x32_bf16 v[164:167], v[20:23], v[140:143], v[164:167]
    v_mfma_f32_16x16x32_bf16 v[168:171], v[24:27], v[140:143], v[168:171]
    v_mfma_f32_16x16x32_bf16 v[172:175], v[28:31], v[140:143], v[172:175]
    v_mfma_f32_16x16x32_bf16 v[176:179], v[32:35], v[140:143], v[176:179]
    s_add_u32 s62, s93, 4096
    buffer_load_dwordx4 v[128:131], v218, s[4:7], s62 offen offset:0 sc1
    v_mfma_f32_16x16x32_bf16 v[180:183], v[36:39], v[140:143], v[180:183]
    s_waitcnt vmcnt(7)
    v_mfma_f32_16x16x32_bf16 v[164:167], v[40:43], v[100:103], v[164:167]
    v_mfma_f32_16x16x32_bf16 v[168:171], v[44:47], v[100:103], v[168:171]
    v_mfma_f32_16x16x32_bf16 v[172:175], v[48:51], v[100:103], v[172:175]
    v_mfma_f32_16x16x32_bf16 v[176:179], v[52:55], v[100:103], v[176:179]
    buffer_load_dwordx4 v[132:135], v218, s[4:7], s62 offen offset:1024 sc1
    v_mfma_f32_16x16x32_bf16 v[180:183], v[56:59], v[100:103], v[180:183]
    s_waitcnt vmcnt(7)
    v_mfma_f32_16x16x32_bf16 v[164:167], v[60:63], v[104:107], v[164:167]
    v_mfma_f32_16x16x32_bf16 v[168:171], v[64:67], v[104:107], v[168:171]
    v_mfma_f32_16x16x32_bf16 v[172:175], v[68:71], v[104:107], v[172:175]
    buffer_load_dwordx4 v[136:139], v218, s[4:7], s62 offen offset:2048 sc1
    v_mfma_f32_16x16x32_bf16 v[176:179], v[72:75], v[104:107], v[176:179]
    v_mfma_f32_16x16x32_bf16 v[180:183], v[76:79], v[104:107], v[180:183]
    s_waitcnt vmcnt(7)
    s_and_b32 s35, s73, 3
    v_mfma_f32_16x16x32_bf16 v[164:167], v[80:83], v[108:111], v[164:167]
    s_mul_i32 s35, s35, 10240
    v_mfma_f32_16x16x32_bf16 v[168:171], v[84:87], v[108:111], v[168:171]
    s_add_u32 s35, s35, 112640
    v_mfma_f32_16x16x32_bf16 v[172:175], v[88:91], v[108:111], v[172:175]
    buffer_load_dwordx4 v[140:143], v218, s[4:7], s62 offen offset:3072 sc1
    v_mfma_f32_16x16x32_bf16 v[176:179], v[92:95], v[108:111], v[176:179]
    v_add_u32 v223, s35, v218
    v_mfma_f32_16x16x32_bf16 v[180:183], v[96:99], v[108:111], v[180:183]
    s_waitcnt vmcnt(7)
    s_waitcnt lgkmcnt(0)
    s_barrier
    ds_read_b128 v[184:187], v219 offset:5120
    v_mfma_f32_16x16x32_bf16 v[230:233], a[100:103], v[112:115], v[230:233]
    ds_read_b128 v[188:191], v219 offset:6144
    ds_read_b128 v[192:195], v219 offset:7168
    v_mfma_f32_16x16x32_bf16 v[234:237], a[104:107], v[112:115], v[234:237]
    ds_read_b128 v[196:199], v219 offset:8192
    v_mfma_f32_16x16x32_bf16 v[238:241], a[108:111], v[112:115], v[238:241]
    s_add_u32 s62, s93, 8192
    buffer_load_dwordx4 v[100:103], v218, s[4:7], s62 offen offset:0 sc1
    v_mfma_f32_16x16x32_bf16 v[242:245], a[112:115], v[112:115], v[242:245]
    ds_write_b128 v223, v[164:167] offset:0
    ds_read_b128 v[200:203], v219 offset:9216
    v_mfma_f32_16x16x32_bf16 v[246:249], a[116:119], v[112:115], v[246:249]
    s_waitcnt vmcnt(7)
    ds_write_b128 v223, v[168:171] offset:1024
    v_mfma_f32_16x16x32_bf16 v[230:233], a[120:123], v[116:119], v[230:233]
    v_mfma_f32_16x16x32_bf16 v[234:237], a[124:127], v[116:119], v[234:237]
    v_mfma_f32_16x16x32_bf16 v[238:241], a[128:131], v[116:119], v[238:241]
    buffer_load_dwordx4 v[104:107], v218, s[4:7], s62 offen offset:1024 sc1
    v_mfma_f32_16x16x32_bf16 v[242:245], a[132:135], v[116:119], v[242:245]
    ds_write_b128 v223, v[172:175] offset:2048
    v_mfma_f32_16x16x32_bf16 v[246:249], a[136:139], v[116:119], v[246:249]
    s_waitcnt vmcnt(7)
    v_mfma_f32_16x16x32_bf16 v[230:233], a[140:143], v[120:123], v[230:233]
    ds_write_b128 v223, v[176:179] offset:3072
    v_mfma_f32_16x16x32_bf16 v[234:237], a[144:147], v[120:123], v[234:237]
    v_mfma_f32_16x16x32_bf16 v[238:241], a[148:151], v[120:123], v[238:241]
    buffer_load_dwordx4 v[108:111], v218, s[4:7], s62 offen offset:2048 sc1
    v_mfma_f32_16x16x32_bf16 v[242:245], a[152:155], v[120:123], v[242:245]
    ds_write_b128 v223, v[180:183] offset:4096
    v_mfma_f32_16x16x32_bf16 v[246:249], a[156:159], v[120:123], v[246:249]
    s_waitcnt vmcnt(7)
    v_mfma_f32_16x16x32_bf16 v[230:233], a[160:163], v[124:127], v[230:233]
    v_mfma_f32_16x16x32_bf16 v[234:237], a[164:167], v[124:127], v[234:237]
    s_waitcnt lgkmcnt(0)
    buffer_load_dwordx4 v[112:115], v218, s[4:7], s62 offen offset:3072 sc1
    v_mfma_f32_16x16x32_bf16 v[238:241], a[168:171], v[124:127], v[238:241]
    s_barrier
    ds_read_b128 v[164:167], v219 offset:0
    ds_read_b128 v[168:171], v219 offset:1024
    v_mfma_f32_16x16x32_bf16 v[242:245], a[172:175], v[124:127], v[242:245]
    ds_read_b128 v[172:175], v219 offset:2048
    ds_read_b128 v[176:179], v219 offset:3072
    v_mfma_f32_16x16x32_bf16 v[246:249], a[176:179], v[124:127], v[246:249]
    s_waitcnt vmcnt(7)
    ds_read_b128 v[180:183], v219 offset:4096
    ds_read_b32 v223, v224 offset:3080
    v_mfma_f32_16x16x32_bf16 v[230:233], a[180:183], v[128:131], v[230:233]
    v_mfma_f32_16x16x32_bf16 v[234:237], a[184:187], v[128:131], v[234:237]
    buffer_load_dword v220, v218, s[4:7], s75 offen offset:0 sc1
    v_mfma_f32_16x16x32_bf16 v[238:241], a[188:191], v[128:131], v[238:241]
    buffer_load_dword v220, v218, s[4:7], s75 offen offset:1024 sc1
    v_mfma_f32_16x16x32_bf16 v[242:245], a[192:195], v[128:131], v[242:245]
    buffer_load_dword v220, v218, s[4:7], s76 offen offset:0 sc1
    v_mfma_f32_16x16x32_bf16 v[246:249], a[196:199], v[128:131], v[246:249]
    s_waitcnt vmcnt(9)
    buffer_load_dword v220, v218, s[4:7], s77 offen offset:0 sc1
    v_mfma_f32_16x16x32_bf16 v[230:233], a[200:203], v[132:135], v[230:233]
    s_add_u32 s64, s78, 4096
    buffer_load_dword v220, off, s[4:7], s64 offset:0 sc1
    v_mfma_f32_16x16x32_bf16 v[234:237], a[204:207], v[132:135], v[234:237]
    s_waitcnt lgkmcnt(5)
    v_add_f32 v184, v184, v164
    v_mfma_f32_16x16x32_bf16 v[238:241], a[208:211], v[132:135], v[238:241]
    s_mul_i32 s98, s24, 3072
    v_add_f32 v185, v185, v165
    s_min_u32 s98, s98, 7168
    v_mfma_f32_16x16x32_bf16 v[242:245], a[212:215], v[132:135], v[242:245]
    s_add_u32 m0, s98, 102400
    v_add_f32 v186, v186, v166
    s_add_u32 s98, m0, s82
    v_mfma_f32_16x16x32_bf16 v[246:249], a[216:219], v[132:135], v[246:249]
    s_waitcnt vmcnt(10)
    v_add_f32 v187, v187, v167
    buffer_load_dword v220, v221, s[16:19], 0 offen sc1
    v_mfma_f32_16x16x32_bf16 v[230:233], a[220:223], v[136:139], v[230:233]
    s_waitcnt lgkmcnt(4)
    v_add_f32 v188, v188, v168
    buffer_load_dwordx4 v218, s[4:7], s98 offen offset:0 sc1 lds
    v_mfma_f32_16x16x32_bf16 v[234:237], a[224:227], v[136:139], v[234:237]
    v_add_f32 v189, v189, v169
    v_mfma_f32_16x16x32_bf16 v[238:241], a[228:231], v[136:139], v[238:241]
    v_add_f32 v190, v190, v170
    v_mfma_f32_16x16x32_bf16 v[242:245], a[232:235], v[136:139], v[242:245]
    v_add_f32 v191, v191, v171
    v_mfma_f32_16x16x32_bf16 v[246:249], a[236:239], v[136:139], v[246:249]
    s_waitcnt vmcnt(11)
    s_waitcnt lgkmcnt(3)
    v_add_f32 v192, v192, v172
    v_mfma_f32_16x16x32_bf16 v[230:233], v[0:3], v[140:143], v[230:233]
    v_add_f32 v193, v193, v173
    v_mfma_f32_16x16x32_bf16 v[234:237], v[4:7], v[140:143], v[234:237]
    v_add_f32 v194, v194, v174
    buffer_load_dwordx4 v218, s[4:7], s98 offen offset:1024 sc1 lds
    v_mfma_f32_16x16x32_bf16 v[238:241], v[8:11], v[140:143], v[238:241]
    v_add_f32 v195, v195, v175
    v_mfma_f32_16x16x32_bf16 v[242:245], v[12:15], v[140:143], v[242:245]
    s_waitcnt lgkmcnt(2)
    v_add_f32 v196, v196, v176
    v_mfma_f32_16x16x32_bf16 v[246:249], v[16:19], v[140:143], v[246:249]
    s_waitcnt vmcnt(11)
    v_add_f32 v197, v197, v177
    v_mfma_f32_16x16x32_bf16 v[230:233], v[20:23], v[100:103], v[230:233]
    v_add_f32 v198, v198, v178
    v_mfma_f32_16x16x32_bf16 v[234:237], v[24:27], v[100:103], v[234:237]
    v_add_f32 v199, v199, v179
    v_mfma_f32_16x16x32_bf16 v[238:241], v[28:31], v[100:103], v[238:241]
    s_waitcnt lgkmcnt(1)
    v_add_f32 v200, v200, v180
    v_mfma_f32_16x16x32_bf16 v[242:245], v[32:35], v[100:103], v[242:245]
    v_add_f32 v201, v201, v181
    buffer_load_dwordx4 v218, s[4:7], s98 offen offset:2048 sc1 lds
    v_mfma_f32_16x16x32_bf16 v[246:249], v[36:39], v[100:103], v[246:249]
    s_waitcnt vmcnt(11)
    v_add_f32 v202, v202, v182
    v_mfma_f32_16x16x32_bf16 v[230:233], v[40:43], v[104:107], v[230:233]
    v_add_f32 v203, v203, v183
    v_mfma_f32_16x16x32_bf16 v[234:237], v[44:47], v[104:107], v[234:237]
    v_mfma_f32_16x16x32_bf16 v[238:241], v[48:51], v[104:107], v[238:241]
    v_mfma_f32_16x16x32_bf16 v[242:245], v[52:55], v[104:107], v[242:245]
    v_mfma_f32_16x16x32_bf16 v[246:249], v[56:59], v[104:107], v[246:249]
    s_waitcnt vmcnt(10)
    v_mfma_f32_16x16x32_bf16 v[230:233], v[60:63], v[108:111], v[230:233]
    v_mfma_f32_16x16x32_bf16 v[234:237], v[64:67], v[108:111], v[234:237]
    v_mfma_f32_16x16x32_bf16 v[238:241], v[68:71], v[108:111], v[238:241]
    v_mfma_f32_16x16x32_bf16 v[242:245], v[72:75], v[108:111], v[242:245]
    v_mfma_f32_16x16x32_bf16 v[246:249], v[76:79], v[108:111], v[246:249]
    s_waitcnt vmcnt(9)
    v_mfma_f32_16x16x32_bf16 v[230:233], v[80:83], v[112:115], v[230:233]
    v_mfma_f32_16x16x32_bf16 v[234:237], v[84:87], v[112:115], v[234:237]
    v_mfma_f32_16x16x32_bf16 v[238:241], v[88:91], v[112:115], v[238:241]
    v_mfma_f32_16x16x32_bf16 v[242:245], v[92:95], v[112:115], v[242:245]
    v_mfma_f32_16x16x32_bf16 v[246:249], v[96:99], v[112:115], v[246:249]
    s_nop 3
    v_pk_add_f32 v[230:231], v[230:231], v[184:185]
    v_cvt_pk_bf16_f32 v208, v230, v231
    v_pk_add_f32 v[232:233], v[232:233], v[186:187]
    v_cvt_pk_bf16_f32 v209, v232, v233
    v_pk_add_f32 v[234:235], v[234:235], v[188:189]
    v_cvt_pk_bf16_f32 v210, v234, v235
    v_pk_add_f32 v[236:237], v[236:237], v[190:191]
    v_cvt_pk_bf16_f32 v211, v236, v237
    buffer_store_dwordx4 v[208:211], v218, s[4:7], s75 offen
    v_pk_add_f32 v[238:239], v[238:239], v[192:193]
    v_cvt_pk_bf16_f32 v212, v238, v239
    v_pk_add_f32 v[240:241], v[240:241], v[194:195]
    v_cvt_pk_bf16_f32 v213, v240, v241
    v_pk_add_f32 v[242:243], v[242:243], v[196:197]
    v_cvt_pk_bf16_f32 v214, v242, v243
    v_pk_add_f32 v[244:245], v[244:245], v[198:199]
    v_cvt_pk_bf16_f32 v215, v244, v245
    buffer_store_dwordx4 v[212:215], v218, s[4:7], s75 offen offset:1024
    v_pk_add_f32 v[246:247], v[246:247], v[200:201]
    v_cvt_pk_bf16_f32 v216, v246, v247
    v_pk_add_f32 v[248:249], v[248:249], v[202:203]
    v_cvt_pk_bf16_f32 v217, v248, v249
    s_waitcnt lgkmcnt(0)
    buffer_store_dwordx2 v[216:217], v223, s[4:7], s76 offen
    s_mov_b32 s60, 0x3f803f80
    v_dot2_f32_bf16 v204, v208, s60, 0
    v_dot2_f32_bf16 v205, v208, v208, 0
    v_dot2_f32_bf16 v206, v209, s60, 0
    v_dot2_f32_bf16 v207, v209, v209, 0
    v_dot2c_f32_bf16 v204, s60, v210
    v_dot2c_f32_bf16 v205, v210, v210
    v_dot2c_f32_bf16 v206, s60, v211
    v_dot2c_f32_bf16 v207, v211, v211
    v_dot2c_f32_bf16 v204, s60, v212
    v_dot2c_f32_bf16 v205, v212, v212
    v_dot2c_f32_bf16 v206, s60, v213
    v_dot2c_f32_bf16 v207, v213, v213
    v_dot2c_f32_bf16 v204, s60, v214
    v_dot2c_f32_bf16 v205, v214, v214
    v_dot2c_f32_bf16 v206, s60, v215
    v_dot2c_f32_bf16 v207, v215, v215
    v_dot2c_f32_bf16 v204, s60, v216
    v_dot2c_f32_bf16 v205, v216, v216
    v_dot2c_f32_bf16 v206, s60, v217
    v_dot2c_f32_bf16 v207, v217, v217
    s_add_u32 s35, s78, 4096
    s_nop 1
    v_pk_add_f32 v[204:205], v[204:205], v[206:207]
    v_mov_b32 v206, v204
    v_mov_b32 v207, v205
    s_nop 0
    v_permlane16_swap_b32 v204, v206
    v_permlane16_swap_b32 v205, v207
    v_add_f32 v204, v204, v206
    v_add_f32 v205, v205, v207
    v_mov_b32 v206, v204
    v_mov_b32 v207, v205
    s_nop 0
    v_permlane32_swap_b32 v204, v206
    v_permlane32_swap_b32 v205, v207
    v_add_f32 v204, v204, v206
    v_add_f32 v205, v205, v207
    s_mov_b64 exec, 0xffff
    buffer_store_dwordx2 v[204:205], v218, s[4:7], s77 offen
    s_mov_b64 exec, 1
    v_mov_b32 v206, s28
    v_mov_b32 v207, s29
    s_cmp_lg_u32 s27, 0
    s_cbranch_scc1 L_slowpub_29
    s_waitcnt vmcnt(0)
    buffer_store_dwordx2 v[206:207], off, s[4:7], s35 offset:0
L_pubdone_30:
    s_mov_b64 exec, -1
    s_barrier
    v_lshrrev_b32 v232, 1, v218
    s_add_u32 s35, s79, 4096
    s_mov_b32 exec_lo, 0xffff
    s_mov_b32 exec_hi, 0x0
    s_mov_b32 s65, 262144
L_poll_31:
    buffer_load_dwordx2 v[230:231], v232, s[4:7], s35 offen offset:0 sc1
    s_sub_u32 s65, s65, 1
    s_cbranch_scc1 L_polled_32
    s_waitcnt vmcnt(0)
    v_cmp_ne_u64 vcc, s[28:29], v[230:231]
    s_cbranch_vccnz L_poll_31
L_polled_32:
    s_mov_b64 exec, -1
    s_cmp_lg_u32 s27, 0
    s_cbranch_scc1 L_slowacq_33
L_acqdone_34:
    s_add_u32 s62, s66, 0
    buffer_load_dwordx4 v[0:3], v218, s[4:7], s62 offen offset:0 sc1
    s_add_u32 s63, s66, 20480
    buffer_load_dwordx4 v[4:7], v218, s[4:7], s63 offen offset:0 sc1
    buffer_load_dwordx4 v[8:11], v218, s[4:7], s62 offen offset:1024 sc1
    buffer_load_dwordx4 v[12:15], v218, s[4:7], s63 offen offset:1024 sc1
    buffer_load_dwordx4 v[16:19], v218, s[4:7], s62 offen offset:2048 sc1
    buffer_load_dwordx4 v[20:23], v218, s[4:7], s63 offen offset:2048 sc1
    buffer_load_dwordx4 v[230:233], v218, s[4:7], s67 offen sc1
    buffer_load_dwordx4 v[234:237], v218, s[4:7], s67 offen offset:1024 sc1
    s_barrier
    ds_read_b32 v219, v224 offset:1036
    v_add_u32 v223, 0x10000, v218
    ds_read_b128 a[240:243], v218 offset:0
    ds_read_b128 a[244:247], v218 offset:1024
    s_waitcnt lgkmcnt(2)
    ds_read_b128 a[248:251], v219 offset:2048
    ds_read_b128 a[252:255], v218 offset:3072
    s_waitcnt vmcnt(7) lgkmcnt(3)
    buffer_load_dwordx4 v[24:27], v218, s[4:7], s62 offen offset:3072 sc1
    v_mfma_f32_16x16x32_bf16 v[160:163], a[240:243], v[0:3], 0
    s_waitcnt vmcnt(7)
    ds_read_b128 v[240:243], v218 offset:4096
    v_mfma_f32_16x16x32_bf16 v[164:167], a[240:243], v[4:7], 0
    s_waitcnt lgkmcnt(3)
    v_mfma_f32_16x16x32_bf16 v[168:171], a[244:247], v[0:3], 0
    ds_read_b128 v[244:247], v218 offset:5120
    v_mfma_f32_16x16x32_bf16 v[172:175], a[244:247], v[4:7], 0
    s_waitcnt lgkmcnt(3)
    buffer_load_dwordx4 v[28:31], v218, s[4:7], s63 offen offset:3072 sc1
    v_mfma_f32_16x16x32_bf16 v[176:179], a[248:251], v[0:3], 0
    ds_read_b128 a[240:243], v218 offset:6144
    v_mfma_f32_16x16x32_bf16 v[180:183], a[248:251], v[4:7], 0
    s_waitcnt lgkmcnt(3)
    v_mfma_f32_16x16x32_bf16 v[184:187], a[252:255], v[0:3], 0
    ds_read_b128 a[244:247], v219 offset:7168
    v_mfma_f32_16x16x32_bf16 v[188:191], a[252:255], v[4:7], 0
    s_waitcnt lgkmcnt(3)
    s_add_u32 s62, s66, 4096
    v_mfma_f32_16x16x32_bf16 v[192:195], v[240:243], v[0:3], 0
    ds_read_b128 a[248:251], v218 offset:8192
    v_mfma_f32_16x16x32_bf16 v[196:199], v[240:243], v[4:7], 0
    s_waitcnt vmcnt(7) lgkmcnt(3)
    buffer_load_dwordx4 v[32:35], v218, s[4:7], s62 offen offset:0 sc1
    v_mfma_f32_16x16x32_bf16 v[160:163], v[244:247], v[8:11], v[160:163]
    s_waitcnt vmcnt(7)
    ds_read_b128 a[252:255], v218 offset:9216
    v_mfma_f32_16x16x32_bf16 v[164:167], v[244:247], v[12:15], v[164:167]
    s_waitcnt lgkmcnt(3)
    v_mfma_f32_16x16x32_bf16 v[168:171], a[240:243], v[8:11], v[168:171]
    s_add_u32 s63, s66, 24576
    ds_read_b128 v[240:243], v218 offset:10240
    v_mfma_f32_16x16x32_bf16 v[172:175], a[240:243], v[12:15], v[172:175]
    s_waitcnt lgkmcnt(3)
    buffer_load_dwordx4 v[36:39], v218, s[4:7], s63 offen offset:0 sc1
    v_mfma_f32_16x16x32_bf16 v[176:179], a[244:247], v[8:11], v[176:179]
    ds_read_b128 v[244:247], v218 offset:11264
    v_mfma_f32_16x16x32_bf16 v[180:183], a[244:247], v[12:15], v[180:183]
    s_waitcnt lgkmcnt(3)
    v_mfma_f32_16x16x32_bf16 v[184:187], a[248:251], v[8:11], v[184:187]
    ds_read_b128 a[240:243], v219 offset:12288
    v_mfma_f32_16x16x32_bf16 v[188:191], a[248:251], v[12:15], v[188:191]
    s_waitcnt lgkmcnt(3)
    buffer_load_dwordx4 v[40:43], v218, s[4:7], s62 offen offset:1024 sc1
    v_mfma_f32_16x16x32_bf16 v[192:195], a[252:255], v[8:11], v[192:195]
    ds_read_b128 a[244:247], v218 offset:13312
    v_mfma_f32_16x16x32_bf16 v[196:199], a[252:255], v[12:15], v[196:199]
    s_waitcnt vmcnt(8) lgkmcnt(3)
    v_mfma_f32_16x16x32_bf16 v[160:163], v[240:243], v[16:19], v[160:163]
    s_waitcnt vmcnt(7)
    ds_read_b128 a[248:251], v218 offset:14336
    v_mfma_f32_16x16x32_bf16 v[164:167], v[240:243], v[20:23], v[164:167]
    s_waitcnt lgkmcnt(3)
    buffer_load_dwordx4 v[44:47], v218, s[4:7], s63 offen offset:1024 sc1
    v_mfma_f32_16x16x32_bf16 v[168:171], v[244:247], v[16:19], v[168:171]
    ds_read_b128 a[252:255], v218 offset:15360
    v_mfma_f32_16x16x32_bf16 v[172:175], v[244:247], v[20:23], v[172:175]
    s_waitcnt lgkmcnt(3)
    v_mfma_f32_16x16x32_bf16 v[176:179], a[240:243], v[16:19], v[176:179]
    ds_read_b128 v[240:243], v218 offset:16384
    v_mfma_f32_16x16x32_bf16 v[180:183], a[240:243], v[20:23], v[180:183]
    s_waitcnt lgkmcnt(3)
    buffer_load_dwordx4 v[48:51], v218, s[4:7], s62 offen offset:2048 sc1
    v_mfma_f32_16x16x32_bf16 v[184:187], a[244:247], v[16:19], v[184:187]
    ds_read_b128 v[244:247], v219 offset:17408
    v_mfma_f32_16x16x32_bf16 v[188:191], a[244:247], v[20:23], v[188:191]
    s_waitcnt lgkmcnt(3)
    v_mfma_f32_16x16x32_bf16 v[192:195], a[248:251], v[16:19], v[192:195]
    ds_read_b128 a[240:243], v218 offset:18432
    v_mfma_f32_16x16x32_bf16 v[196:199], a[248:251], v[20:23], v[196:199]
    s_waitcnt vmcnt(6) lgkmcnt(3)
    buffer_load_dwordx4 v[52:55], v218, s[4:7], s63 offen offset:2048 sc1
    v_mfma_f32_16x16x32_bf16 v[160:163], a[252:255], v[24:27], v[160:163]
    s_waitcnt vmcnt(6)
    ds_read_b128 a[244:247], v218 offset:19456
    v_add_f32 v226, v230, v232
    v_mfma_f32_16x16x32_bf16 v[164:167], a[252:255], v[28:31], v[164:167]
    s_waitcnt lgkmcnt(3)
    v_add_f32 v228, v231, v233
    v_mfma_f32_16x16x32_bf16 v[168:171], v[240:243], v[24:27], v[168:171]
    ds_read_b128 a[248:251], v218 offset:20480
    v_mfma_f32_16x16x32_bf16 v[172:175], v[240:243], v[28:31], v[172:175]
    s_waitcnt lgkmcnt(3)
    v_add_f32 v227, v234, v236
    v_mfma_f32_16x16x32_bf16 v[176:179], v[244:247], v[24:27], v[176:179]
    ds_read_b128 a[252:255], v218 offset:21504
    v_mfma_f32_16x16x32_bf16 v[180:183], v[244:247], v[28:31], v[180:183]
    s_waitcnt lgkmcnt(3)
    buffer_load_dwordx4 v[56:59], v218, s[4:7], s62 offen offset:3072 sc1
    v_mfma_f32_16x16x32_bf16 v[184:187], a[240:243], v[24:27], v[184:187]
    ds_read_b128 v[240:243], v219 offset:22528
    v_add_f32 v229, v235, v237
    v_mfma_f32_16x16x32_bf16 v[188:191], a[240:243], v[28:31], v[188:191]
    s_waitcnt lgkmcnt(3)
    v_mov_b32 v230, v226
    v_mfma_f32_16x16x32_bf16 v[192:195], a[244:247], v[24:27], v[192:195]
    ds_read_b128 v[244:247], v218 offset:23552
    v_mfma_f32_16x16x32_bf16 v[196:199], a[244:247], v[28:31], v[196:199]
    s_waitcnt vmcnt(6) lgkmcnt(3)
    buffer_load_dwordx4 v[60:63], v218, s[4:7], s63 offen offset:3072 sc1
    v_mfma_f32_16x16x32_bf16 v[160:163], a[248:251], v[32:35], v[160:163]
    s_waitcnt vmcnt(6)
    ds_read_b128 a[240:243], v218 offset:24576
    v_mov_b32 v231, v227
    v_mfma_f32_16x16x32_bf16 v[164:167], a[248:251], v[36:39], v[164:167]
    s_waitcnt lgkmcnt(3)
    v_mov_b32 v232, v228
    v_mfma_f32_16x16x32_bf16 v[168:171], a[252:255], v[32:35], v[168:171]
    s_add_u32 s62, s66, 8192
    ds_read_b128 a[244:247], v218 offset:25600
    v_mfma_f32_16x16x32_bf16 v[172:175], a[252:255], v[36:39], v[172:175]
    s_waitcnt lgkmcnt(3)
    buffer_load_dwordx4 v[64:67], v218, s[4:7], s62 offen offset:0 sc1
    v_mfma_f32_16x16x32_bf16 v[176:179], v[240:243], v[32:35], v[176:179]
    ds_read_b128 a[248:251], v218 offset:26624
    v_mov_b32 v233, v229
    v_mfma_f32_16x16x32_bf16 v[180:183], v[240:243], v[36:39], v[180:183]
    s_waitcnt lgkmcnt(3)
    v_permlane16_swap_b32 v226, v230
    v_mfma_f32_16x16x32_bf16 v[184:187], v[244:247], v[32:35], v[184:187]
    ds_read_b128 a[252:255], v219 offset:27648
    v_mfma_f32_16x16x32_bf16 v[188:191], v[244:247], v[36:39], v[188:191]
    s_waitcnt lgkmcnt(3)
    s_add_u32 s63, s66, 28672
    v_mfma_f32_16x16x32_bf16 v[192:195], a[240:243], v[32:35], v[192:195]
    ds_read_b128 v[240:243], v218 offset:28672
    v_mfma_f32_16x16x32_bf16 v[196:199], a[240:243], v[36:39], v[196:199]
    s_waitcnt vmcnt(6) lgkmcnt(3)
    buffer_load_dwordx4 v[68:71], v218, s[4:7], s63 offen offset:0 sc1
    v_mfma_f32_16x16x32_bf16 v[160:163], a[244:247], v[40:43], v[160:163]
    s_waitcnt vmcnt(6)
    ds_read_b128 v[244:247], v218 offset:29696
    v_permlane16_swap_b32 v227, v231
    v_mfma_f32_16x16x32_bf16 v[164:167], a[244:247], v[44:47], v[164:167]
    s_waitcnt lgkmcnt(3)
    buffer_load_dwordx4 v[72:75], v218, s[4:7], s62 offen offset:1024 sc1
    v_mfma_f32_16x16x32_bf16 v[168:171], a[248:251], v[40:43], v[168:171]
    ds_read_b128 a[240:243], v218 offset:30720
    v_permlane16_swap_b32 v228, v232
    v_mfma_f32_16x16x32_bf16 v[172:175], a[248:251], v[44:47], v[172:175]
    s_waitcnt lgkmcnt(3)
    v_permlane16_swap_b32 v229, v233
    v_mfma_f32_16x16x32_bf16 v[176:179], a[252:255], v[40:43], v[176:179]
    ds_read_b128 a[244:247], v218 offset:31744
    v_add_f32 v226, v226, v230
    v_mfma_f32_16x16x32_bf16 v[180:183], a[252:255], v[44:47], v[180:183]
    s_waitcnt lgkmcnt(3)
    v_add_f32 v227, v227, v231
    v_mfma_f32_16x16x32_bf16 v[184:187], v[240:243], v[40:43], v[184:187]
    ds_read_b128 a[248:251], v219 offset:32768
    v_mfma_f32_16x16x32_bf16 v[188:191], v[240:243], v[44:47], v[188:191]
    s_waitcnt lgkmcnt(3)
    buffer_load_dwordx4 v[76:79], v218, s[4:7], s63 offen offset:1024 sc1
    v_mfma_f32_16x16x32_bf16 v[192:195], v[244:247], v[40:43], v[192:195]
    ds_read_b128 a[252:255], v218 offset:33792
    v_add_f32 v228, v228, v232
    v_mfma_f32_16x16x32_bf16 v[196:199], v[244:247], v[44:47], v[196:199]
    s_waitcnt vmcnt(7) lgkmcnt(3)
    v_add_f32 v229, v229, v233
    v_mfma_f32_16x16x32_bf16 v[160:163], a[240:243], v[48:51], v[160:163]
    s_waitcnt vmcnt(6)
    ds_read_b128 v[240:243], v218 offset:34816
    v_mfma_f32_16x16x32_bf16 v[164:167], a[240:243], v[52:55], v[164:167]
    s_waitcnt lgkmcnt(3)
    buffer_load_dwordx4 v[80:83], v218, s[4:7], s62 offen offset:2048 sc1
    v_mfma_f32_16x16x32_bf16 v[168:171], a[244:247], v[48:51], v[168:171]
    ds_read_b128 v[244:247], v218 offset:35840
    v_mov_b32 v230, v226
    v_mfma_f32_16x16x32_bf16 v[172:175], a[244:247], v[52:55], v[172:175]
    s_waitcnt lgkmcnt(3)
    v_mov_b32 v231, v227
    v_mfma_f32_16x16x32_bf16 v[176:179], a[248:251], v[48:51], v[176:179]
    ds_read_b128 a[240:243], v218 offset:36864
    v_mfma_f32_16x16x32_bf16 v[180:183], a[248:251], v[52:55], v[180:183]
    s_waitcnt lgkmcnt(3)
    buffer_load_dwordx4 v[84:87], v218, s[4:7], s63 offen offset:2048 sc1
    v_mfma_f32_16x16x32_bf16 v[184:187], a[252:255], v[48:51], v[184:187]
    ds_read_b128 a[244:247], v219 offset:37888
    v_mov_b32 v232, v228
    v_mfma_f32_16x16x32_bf16 v[188:191], a[252:255], v[52:55], v[188:191]
    s_waitcnt lgkmcnt(3)
    v_mov_b32 v233, v229
    v_mfma_f32_16x16x32_bf16 v[192:195], v[240:243], v[48:51], v[192:195]
    ds_read_b128 a[248:251], v218 offset:38912
    v_mfma_f32_16x16x32_bf16 v[196:199], v[240:243], v[52:55], v[196:199]
    s_waitcnt vmcnt(7) lgkmcnt(3)
    buffer_load_dwordx4 v[88:91], v218, s[4:7], s62 offen offset:3072 sc1
    v_mfma_f32_16x16x32_bf16 v[160:163], v[244:247], v[56:59], v[160:163]
    s_waitcnt vmcnt(7)
    ds_read_b128 a[252:255], v218 offset:39936
    v_mfma_f32_16x16x32_bf16 v[164:167], v[244:247], v[60:63], v[164:167]
    s_waitcnt lgkmcnt(3)
    v_permlane32_swap_b32 v226, v230
    v_mfma_f32_16x16x32_bf16 v[168:171], a[240:243], v[56:59], v[168:171]
    ds_read_b128 v[240:243], v218 offset:40960
    v_mfma_f32_16x16x32_bf16 v[172:175], a[240:243], v[60:63], v[172:175]
    s_waitcnt lgkmcnt(3)
    buffer_load_dwordx4 v[92:95], v218, s[4:7], s63 offen offset:3072 sc1
    v_mfma_f32_16x16x32_bf16 v[176:179], a[244:247], v[56:59], v[176:179]
    ds_read_b128 v[244:247], v218 offset:41984
    v_permlane32_swap_b32 v227, v231
    v_mfma_f32_16x16x32_bf16 v[180:183], a[244:247], v[60:63], v[180:183]
    s_waitcnt lgkmcnt(3)
    v_permlane32_swap_b32 v228, v232
    v_mfma_f32_16x16x32_bf16 v[184:187], a[248:251], v[56:59], v[184:187]
    ds_read_b128 a[240:243], v219 offset:43008
    v_mfma_f32_16x16x32_bf16 v[188:191], a[248:251], v[60:63], v[188:191]
    s_waitcnt lgkmcnt(3)
    v_permlane32_swap_b32 v229, v233
    v_mfma_f32_16x16x32_bf16 v[192:195], a[252:255], v[56:59], v[192:195]
    s_add_u32 s62, s66, 12288
    ds_read_b128 a[244:247], v218 offset:44032
    v_add_f32 v226, v226, v230
    v_mfma_f32_16x16x32_bf16 v[196:199], a[252:255], v[60:63], v[196:199]
    s_waitcnt vmcnt(7) lgkmcnt(3)
    buffer_load_dwordx4 v[96:99], v218, s[4:7], s62 offen offset:0 sc1
    v_mfma_f32_16x16x32_bf16 v[160:163], v[240:243], v[64:67], v[160:163]
    s_waitcnt vmcnt(7)
    ds_read_b128 a[248:251], v218 offset:45056
    v_add_f32 v227, v227, v231
    v_mfma_f32_16x16x32_bf16 v[164:167], v[240:243], v[68:71], v[164:167]
    s_waitcnt lgkmcnt(3)
    v_add_f32 v228, v228, v232
    v_mfma_f32_16x16x32_bf16 v[168:171], v[244:247], v[64:67], v[168:171]
    s_add_u32 s63, s66, 32768
    ds_read_b128 a[252:255], v218 offset:46080
    v_mfma_f32_16x16x32_bf16 v[172:175], v[244:247], v[68:71], v[172:175]
    s_waitcnt lgkmcnt(3)
    buffer_load_dwordx4 v[100:103], v218, s[4:7], s63 offen offset:0 sc1
    v_mfma_f32_16x16x32_bf16 v[176:179], a[240:243], v[64:67], v[176:179]
    ds_read_b128 v[240:243], v218 offset:47104
    v_add_f32 v229, v229, v233
    v_mfma_f32_16x16x32_bf16 v[180:183], a[240:243], v[68:71], v[180:183]
    s_waitcnt lgkmcnt(3)
    v_mul_f32 v226, 0xbacccccd, v226
    v_mfma_f32_16x16x32_bf16 v[184:187], a[244:247], v[64:67], v[184:187]
    ds_read_b128 v[244:247], v219 offset:48128
    v_mfma_f32_16x16x32_bf16 v[188:191], a[244:247], v[68:71], v[188:191]
    s_waitcnt lgkmcnt(3)
    buffer_load_dwordx4 v[104:107], v218, s[4:7], s62 offen offset:1024 sc1
    v_mfma_f32_16x16x32_bf16 v[192:195], a[248:251], v[64:67], v[192:195]
    ds_read_b128 a[240:243], v218 offset:49152
    v_mul_f32 v228, 0x3acccccd, v228
    v_mfma_f32_16x16x32_bf16 v[196:199], a[248:251], v[68:71], v[196:199]
    s_waitcnt vmcnt(8) lgkmcnt(3)
    v_mul_f32 v227, 0xbacccccd, v227
    v_mfma_f32_16x16x32_bf16 v[160:163], a[252:255], v[72:75], v[160:163]
    s_waitcnt vmcnt(7)
    ds_read_b128 a[244:247], v218 offset:50176
    v_mfma_f32_16x16x32_bf16 v[164:167], a[252:255], v[76:79], v[164:167]
    s_waitcnt lgkmcnt(3)
    buffer_load_dwordx4 v[108:111], v218, s[4:7], s63 offen offset:1024 sc1
    v_mfma_f32_16x16x32_bf16 v[168:171], v[240:243], v[72:75], v[168:171]
    ds_read_b128 a[248:251], v218 offset:51200
    v_mul_f32 v229, 0x3acccccd, v229
    v_mfma_f32_16x16x32_bf16 v[172:175], v[240:243], v[76:79], v[172:175]
    s_waitcnt lgkmcnt(3)
    v_fma_f32 v228, -v226, v226, v228
    v_mfma_f32_16x16x32_bf16 v[176:179], v[244:247], v[72:75], v[176:179]
    ds_read_b128 a[252:255], v218 offset:52224
    v_mfma_f32_16x16x32_bf16 v[180:183], v[244:247], v[76:79], v[180:183]
    s_waitcnt lgkmcnt(3)
    buffer_load_dwordx4 v[112:115], v218, s[4:7], s62 offen offset:2048 sc1
    v_mfma_f32_16x16x32_bf16 v[184:187], a[240:243], v[72:75], v[184:187]
    ds_read_b128 v[240:243], v219 offset:53248
    v_fma_f32 v229, -v227, v227, v229
    v_mfma_f32_16x16x32_bf16 v[188:191], a[240:243], v[76:79], v[188:191]
    s_waitcnt lgkmcnt(3)
    v_max_f32 v228, 0, v228
    v_mfma_f32_16x16x32_bf16 v[192:195], a[244:247], v[72:75], v[192:195]
    ds_read_b128 v[244:247], v218 offset:54272
    v_mfma_f32_16x16x32_bf16 v[196:199], a[244:247], v[76:79], v[196:199]
    s_waitcnt vmcnt(8) lgkmcnt(3)
    v_max_f32 v229, 0, v229
    v_mfma_f32_16x16x32_bf16 v[160:163], a[248:251], v[80:83], v[160:163]
    s_waitcnt vmcnt(7)
    ds_read_b128 a[240:243], v218 offset:55296
    v_mfma_f32_16x16x32_bf16 v[164:167], a[248:251], v[84:87], v[164:167]
    s_waitcnt lgkmcnt(3)
    buffer_load_dwordx4 v[116:119], v218, s[4:7], s63 offen offset:2048 sc1
    v_mfma_f32_16x16x32_bf16 v[168:171], a[252:255], v[80:83], v[168:171]
    ds_read_b128 a[244:247], v218 offset:56320
    v_add_f32 v228, 0x3727c5ac, v228
    v_mfma_f32_16x16x32_bf16 v[172:175], a[252:255], v[84:87], v[172:175]
    s_waitcnt lgkmcnt(3)
    v_add_f32 v229, 0x3727c5ac, v229
    v_mfma_f32_16x16x32_bf16 v[176:179], v[240:243], v[80:83], v[176:179]
    ds_read_b128 a[248:251], v218 offset:57344
    v_mfma_f32_16x16x32_bf16 v[180:183], v[240:243], v[84:87], v[180:183]
    s_waitcnt lgkmcnt(3)
    buffer_load_dwordx4 v[120:123], v218, s[4:7], s62 offen offset:3072 sc1
    v_mfma_f32_16x16x32_bf16 v[184:187], v[244:247], v[80:83], v[184:187]
    ds_read_b128 a[252:255], v219 offset:58368
    v_mfma_f32_16x16x32_bf16 v[188:191], v[244:247], v[84:87], v[188:191]
    s_waitcnt lgkmcnt(3)
    v_rsq_f32 v228, v228
    v_mfma_f32_16x16x32_bf16 v[192:195], a[240:243], v[80:83], v[192:195]
    ds_read_b128 v[240:243], v218 offset:59392
    v_mfma_f32_16x16x32_bf16 v[196:199], a[240:243], v[84:87], v[196:199]
    s_waitcnt vmcnt(8) lgkmcnt(3)
    buffer_load_dwordx4 v[124:127], v218, s[4:7], s63 offen offset:3072 sc1
    v_mfma_f32_16x16x32_bf16 v[160:163], a[244:247], v[88:91], v[160:163]
    s_waitcnt vmcnt(8)
    ds_read_b128 v[244:247], v218 offset:60416
    v_rsq_f32 v229, v229
    v_mfma_f32_16x16x32_bf16 v[164:167], a[244:247], v[92:95], v[164:167]
    s_waitcnt lgkmcnt(3)
    v_mfma_f32_16x16x32_bf16 v[168:171], a[248:251], v[88:91], v[168:171]
    ds_read_b128 a[240:243], v218 offset:61440
    v_mfma_f32_16x16x32_bf16 v[172:175], a[248:251], v[92:95], v[172:175]
    s_waitcnt lgkmcnt(3)
    s_add_u32 s62, s66, 16384
    v_mfma_f32_16x16x32_bf16 v[176:179], a[252:255], v[88:91], v[176:179]
    ds_read_b128 a[244:247], v218 offset:62464
    v_mfma_f32_16x16x32_bf16 v[180:183], a[252:255], v[92:95], v[180:183]
    s_waitcnt lgkmcnt(3)
    buffer_load_dwordx4 v[128:131], v218, s[4:7], s62 offen offset:0 sc1
    v_mfma_f32_16x16x32_bf16 v[184:187], v[240:243], v[88:91], v[184:187]
    ds_read_b128 a[248:251], v219 offset:63488
    v_mfma_f32_16x16x32_bf16 v[188:191], v[240:243], v[92:95], v[188:191]
    s_waitcnt lgkmcnt(3)
    s_add_u32 s63, s66, 36864
    v_mfma_f32_16x16x32_bf16 v[192:195], v[244:247], v[88:91], v[192:195]
    ds_read_b128 a[252:255], v218 offset:64512
    v_mfma_f32_16x16x32_bf16 v[196:199], v[244:247], v[92:95], v[196:199]
    s_waitcnt vmcnt(8) lgkmcnt(3)
    buffer_load_dwordx4 v[132:135], v218, s[4:7], s63 offen offset:0 sc1
    v_mfma_f32_16x16x32_bf16 v[160:163], a[240:243], v[96:99], v[160:163]
    s_waitcnt vmcnt(8)
    ds_read_b128 v[240:243], v223 offset:0
    v_mfma_f32_16x16x32_bf16 v[164:167], a[240:243], v[100:103], v[164:167]
    s_waitcnt lgkmcnt(3)
    v_mfma_f32_16x16x32_bf16 v[168:171], a[244:247], v[96:99], v[168:171]
    ds_read_b128 v[244:247], v223 offset:1024
    v_mfma_f32_16x16x32_bf16 v[172:175], a[244:247], v[100:103], v[172:175]
    s_waitcnt lgkmcnt(3)
    buffer_load_dwordx4 v[136:139], v218, s[4:7], s62 offen offset:1024 sc1
    v_mfma_f32_16x16x32_bf16 v[176:179], a[248:251], v[96:99], v[176:179]
    ds_read_b128 a[240:243], v223 offset:2048
    v_mfma_f32_16x16x32_bf16 v[180:183], a[248:251], v[100:103], v[180:183]
    s_waitcnt lgkmcnt(3)
    v_mfma_f32_16x16x32_bf16 v[184:187], a[252:255], v[96:99], v[184:187]
    v_add_u32 v219, 0x10000, v219
    ds_read_b128 a[244:247], v219 offset:3072
    v_mfma_f32_16x16x32_bf16 v[188:191], a[252:255], v[100:103], v[188:191]
    s_waitcnt lgkmcnt(3)
    buffer_load_dwordx4 v[140:143], v218, s[4:7], s63 offen offset:1024 sc1
    v_mfma_f32_16x16x32_bf16 v[192:195], v[240:243], v[96:99], v[192:195]
    ds_read_b128 a[248:251], v223 offset:4096
    v_mfma_f32_16x16x32_bf16 v[196:199], v[240:243], v[100:103], v[196:199]
    s_waitcnt vmcnt(9) lgkmcnt(3)
    v_mfma_f32_16x16x32_bf16 v[160:163], v[244:247], v[104:107], v[160:163]
    s_waitcnt vmcnt(8)
    ds_read_b128 a[252:255], v223 offset:5120
    v_mfma_f32_16x16x32_bf16 v[164:167], v[244:247], v[108:111], v[164:167]
    s_waitcnt lgkmcnt(3)
    buffer_load_dwordx4 v[144:147], v218, s[4:7], s62 offen offset:2048 sc1
    v_mfma_f32_16x16x32_bf16 v[168:171], a[240:243], v[104:107], v[168:171]
    ds_read_b128 v[240:243], v223 offset:6144
    v_mfma_f32_16x16x32_bf16 v[172:175], a[240:243], v[108:111], v[172:175]
    s_waitcnt lgkmcnt(3)
    v_mfma_f32_16x16x32_bf16 v[176:179], a[244:247], v[104:107], v[176:179]
    ds_read_b128 v[244:247], v223 offset:7168
    v_mfma_f32_16x16x32_bf16 v[180:183], a[244:247], v[108:111], v[180:183]
    s_waitcnt lgkmcnt(3)
    buffer_load_dwordx4 v[148:151], v218, s[4:7], s63 offen offset:2048 sc1
    v_mfma_f32_16x16x32_bf16 v[184:187], a[248:251], v[104:107], v[184:187]
    ds_read_b128 a[240:243], v219 offset:8192
    v_mfma_f32_16x16x32_bf16 v[188:191], a[248:251], v[108:111], v[188:191]
    s_waitcnt lgkmcnt(3)
    v_mfma_f32_16x16x32_bf16 v[192:195], a[252:255], v[104:107], v[192:195]
    ds_read_b128 a[244:247], v223 offset:9216
    v_mfma_f32_16x16x32_bf16 v[196:199], a[252:255], v[108:111], v[196:199]
    s_waitcnt vmcnt(9) lgkmcnt(3)
    buffer_load_dwordx4 v[152:155], v218, s[4:7], s62 offen offset:3072 sc1
    v_mfma_f32_16x16x32_bf16 v[160:163], v[240:243], v[112:115], v[160:163]
    s_waitcnt vmcnt(9)
    ds_read_b128 a[248:251], v223 offset:10240
    v_mfma_f32_16x16x32_bf16 v[164:167], v[240:243], v[116:119], v[164:167]
    s_waitcnt lgkmcnt(3)
    v_mfma_f32_16x16x32_bf16 v[168:171], v[244:247], v[112:115], v[168:171]
    ds_read_b128 a[252:255], v223 offset:11264
    v_mfma_f32_16x16x32_bf16 v[172:175], v[244:247], v[116:119], v[172:175]
    s_waitcnt lgkmcnt(3)
    v_mfma_f32_16x16x32_bf16 v[176:179], a[240:243], v[112:115], v[176:179]
    ds_read_b128 v[240:243], v223 offset:12288
    v_mfma_f32_16x16x32_bf16 v[180:183], a[240:243], v[116:119], v[180:183]
    s_waitcnt lgkmcnt(3)
    buffer_load_dwordx4 v[156:159], v218, s[4:7], s63 offen offset:3072 sc1
    v_mfma_f32_16x16x32_bf16 v[184:187], a[244:247], v[112:115], v[184:187]
    ds_read_b128 v[244:247], v219 offset:13312
    v_mfma_f32_16x16x32_bf16 v[188:191], a[244:247], v[116:119], v[188:191]
    s_waitcnt lgkmcnt(3)
    buffer_load_dword v220, v221, s[16:19], 0 offen sc1
    v_mfma_f32_16x16x32_bf16 v[192:195], a[248:251], v[112:115], v[192:195]
    ds_read_b128 a[240:243], v223 offset:14336
    v_mfma_f32_16x16x32_bf16 v[196:199], a[248:251], v[116:119], v[196:199]
    s_waitcnt vmcnt(10) lgkmcnt(3)
    v_mfma_f32_16x16x32_bf16 v[160:163], a[252:255], v[120:123], v[160:163]
    s_waitcnt vmcnt(9)
    ds_read_b128 a[244:247], v223 offset:15360
    s_mul_i32 s98, s24, 10240
    v_mfma_f32_16x16x32_bf16 v[164:167], a[252:255], v[124:127], v[164:167]
    s_waitcnt lgkmcnt(3)
    s_add_u32 m0, s98, 112640
    s_add_u32 s98, m0, s82
    v_mfma_f32_16x16x32_bf16 v[168:171], v[240:243], v[120:123], v[168:171]
    ds_read_b128 a[248:251], v223 offset:16384
    v_mfma_f32_16x16x32_bf16 v[172:175], v[240:243], v[124:127], v[172:175]
    s_waitcnt lgkmcnt(3)
    buffer_load_dwordx4 v218, s[4:7], s98 offen offset:0 sc1 lds
    v_mfma_f32_16x16x32_bf16 v[176:179], v[244:247], v[120:123], v[176:179]
    ds_read_b128 a[252:255], v223 offset:17408
    v_mfma_f32_16x16x32_bf16 v[180:183], v[244:247], v[124:127], v[180:183]
    s_waitcnt lgkmcnt(3)
    v_mfma_f32_16x16x32_bf16 v[184:187], a[240:243], v[120:123], v[184:187]
    ds_read_b128 v[240:243], v219 offset:18432
    v_mfma_f32_16x16x32_bf16 v[188:191], a[240:243], v[124:127], v[188:191]
    s_waitcnt lgkmcnt(3)
    buffer_load_dwordx4 v218, s[4:7], s98 offen offset:1024 sc1 lds
    v_mfma_f32_16x16x32_bf16 v[192:195], a[244:247], v[120:123], v[192:195]
    ds_read_b128 v[244:247], v223 offset:19456
    v_mfma_f32_16x16x32_bf16 v[196:199], a[244:247], v[124:127], v[196:199]
    s_waitcnt vmcnt(10) lgkmcnt(3)
    v_mfma_f32_16x16x32_bf16 v[160:163], a[248:251], v[128:131], v[160:163]
    s_waitcnt vmcnt(9)
    ds_read_b128 a[240:243], v223 offset:20480
    v_mfma_f32_16x16x32_bf16 v[164:167], a[248:251], v[132:135], v[164:167]
    s_waitcnt lgkmcnt(3)
    v_mfma_f32_16x16x32_bf16 v[168:171], a[252:255], v[128:131], v[168:171]
    ds_read_b128 a[244:247], v223 offset:21504
    v_mfma_f32_16x16x32_bf16 v[172:175], a[252:255], v[132:135], v[172:175]
    s_waitcnt lgkmcnt(3)
    v_mfma_f32_16x16x32_bf16 v[176:179], v[240:243], v[128:131], v[176:179]
    ds_read_b128 a[248:251], v223 offset:22528
    v_mfma_f32_16x16x32_bf16 v[180:183], v[240:243], v[132:135], v[180:183]
    s_waitcnt lgkmcnt(3)
    buffer_load_dwordx4 v218, s[4:7], s98 offen offset:2048 sc1 lds
    v_mfma_f32_16x16x32_bf16 v[184:187], v[244:247], v[128:131], v[184:187]
    ds_read_b128 a[252:255], v219 offset:23552
    v_mfma_f32_16x16x32_bf16 v[188:191], v[244:247], v[132:135], v[188:191]
    s_waitcnt lgkmcnt(3)
    v_mfma_f32_16x16x32_bf16 v[192:195], a[240:243], v[128:131], v[192:195]
    ds_read_b128 v[240:243], v223 offset:24576
    v_mfma_f32_16x16x32_bf16 v[196:199], a[240:243], v[132:135], v[196:199]
    s_waitcnt vmcnt(9) lgkmcnt(3)
    v_mfma_f32_16x16x32_bf16 v[160:163], a[244:247], v[136:139], v[160:163]
    s_waitcnt vmcnt(8)
    ds_read_b128 v[244:247], v223 offset:25600
    v_mfma_f32_16x16x32_bf16 v[164:167], a[244:247], v[140:143], v[164:167]
    s_waitcnt lgkmcnt(3)
    buffer_load_dwordx4 v218, s[4:7], s98 offen offset:3072 sc1 lds
    v_mfma_f32_16x16x32_bf16 v[168:171], a[248:251], v[136:139], v[168:171]
    ds_read_b128 a[240:243], v223 offset:26624
    v_mfma_f32_16x16x32_bf16 v[172:175], a[248:251], v[140:143], v[172:175]
    s_waitcnt lgkmcnt(3)
    v_mfma_f32_16x16x32_bf16 v[176:179], a[252:255], v[136:139], v[176:179]
    ds_read_b128 a[244:247], v223 offset:27648
    v_mfma_f32_16x16x32_bf16 v[180:183], a[252:255], v[140:143], v[180:183]
    s_waitcnt lgkmcnt(3)
    v_mfma_f32_16x16x32_bf16 v[184:187], v[240:243], v[136:139], v[184:187]
    ds_read_b128 a[248:251], v219 offset:28672
    v_mfma_f32_16x16x32_bf16 v[188:191], v[240:243], v[140:143], v[188:191]
    s_waitcnt lgkmcnt(3)
    v_mfma_f32_16x16x32_bf16 v[192:195], v[244:247], v[136:139], v[192:195]
    s_add_u32 m0, m0, 4096
    ds_read_b128 a[252:255], v223 offset:29696
    s_add_u32 s98, s98, 4096
    v_mfma_f32_16x16x32_bf16 v[196:199], v[244:247], v[140:143], v[196:199]
    s_waitcnt vmcnt(8) lgkmcnt(3)
    ds_read_b128 v[230:233], v225 offset:0
    v_mfma_f32_16x16x32_bf16 v[160:163], a[240:243], v[144:147], v[160:163]
    s_waitcnt vmcnt(7)
    ds_read_b128 v[240:243], v223 offset:30720
    v_mfma_f32_16x16x32_bf16 v[164:167], a[240:243], v[148:151], v[164:167]
    s_waitcnt lgkmcnt(4)
    ds_read_b128 v[234:237], v225 offset:64
    buffer_load_dwordx4 v218, s[4:7], s98 offen offset:0 sc1 lds
    v_mfma_f32_16x16x32_bf16 v[168:171], a[244:247], v[144:147], v[168:171]
    ds_read_b128 v[244:247], v223 offset:31744
    v_mfma_f32_16x16x32_bf16 v[172:175], a[244:247], v[148:151], v[172:175]
    s_waitcnt lgkmcnt(5)
    ds_read_b128 v[248:251], v225 offset:128
    v_mfma_f32_16x16x32_bf16 v[176:179], a[248:251], v[144:147], v[176:179]
    ds_read_b128 a[240:243], v223 offset:32768
    v_mfma_f32_16x16x32_bf16 v[180:183], a[248:251], v[148:151], v[180:183]
    s_waitcnt lgkmcnt(6)
    ds_read_b128 v[252:255], v225 offset:192
    v_mfma_f32_16x16x32_bf16 v[184:187], a[252:255], v[144:147], v[184:187]
    ds_read_b128 a[244:247], v219 offset:33792
    v_mfma_f32_16x16x32_bf16 v[188:191], a[252:255], v[148:151], v[188:191]
    s_waitcnt lgkmcnt(6)
    ds_read_b128 v[200:203], v225 offset:256
    v_mfma_f32_16x16x32_bf16 v[192:195], v[240:243], v[144:147], v[192:195]
    ds_read_b128 a[248:251], v223 offset:34816
    buffer_load_dwordx4 v218, s[4:7], s98 offen offset:1024 sc1 lds
    v_mfma_f32_16x16x32_bf16 v[196:199], v[240:243], v[148:151], v[196:199]
    s_waitcnt vmcnt(8) lgkmcnt(6)
    v_mfma_f32_16x16x32_bf16 v[160:163], v[244:247], v[152:155], v[160:163]
    s_waitcnt vmcnt(7)
    ds_read_b128 a[252:255], v223 offset:35840
    v_mfma_f32_16x16x32_bf16 v[164:167], v[244:247], v[156:159], v[164:167]
    s_waitcnt lgkmcnt(5)
    v_mfma_f32_16x16x32_bf16 v[168:171], a[240:243], v[152:155], v[168:171]
    buffer_load_dwordx4 v218, s[4:7], s98 offen offset:2048 sc1 lds
    v_mfma_f32_16x16x32_bf16 v[172:175], a[240:243], v[156:159], v[172:175]
    s_waitcnt lgkmcnt(3)
    ds_read_b128 v[204:207], v224
    v_mfma_f32_16x16x32_bf16 v[176:179], a[244:247], v[152:155], v[176:179]
    v_mfma_f32_16x16x32_bf16 v[180:183], a[244:247], v[156:159], v[180:183]
    s_waitcnt lgkmcnt(2)
    v_mfma_f32_16x16x32_bf16 v[184:187], a[248:251], v[152:155], v[184:187]
    v_mfma_f32_16x16x32_bf16 v[188:191], a[248:251], v[156:159], v[188:191]
    s_waitcnt lgkmcnt(1)
    v_mfma_f32_16x16x32_bf16 v[192:195], a[252:255], v[152:155], v[192:195]
    v_mfma_f32_16x16x32_bf16 v[196:199], a[252:255], v[156:159], v[196:199]
    s_barrier
    s_mov_b32 s90, 0xffff0000
    buffer_load_dwordx4 v218, s[4:7], s98 offen offset:3072 sc1 lds
    s_mov_b32 s91, 0xffff0000
    v_pk_fma_f32 v[160:161], v[226:227], v[230:231], v[160:161] op_sel:[0,0,0] op_sel_hi:[0,1,1]
    v_pk_fma_f32 v[164:165], v[226:227], v[230:231], v[164:165] op_sel:[1,0,0] op_sel_hi:[1,1,1]
    v_pk_fma_f32 v[162:163], v[226:227], v[232:233], v[162:163] op_sel:[0,0,0] op_sel_hi:[0,1,1]
    v_pk_fma_f32 v[166:167], v[226:227], v[232:233], v[166:167] op_sel:[1,0,0] op_sel_hi:[1,1,1]
    v_pk_fma_f32 v[168:169], v[226:227], v[234:235], v[168:169] op_sel:[0,0,0] op_sel_hi:[0,1,1]
    v_pk_fma_f32 v[172:173], v[226:227], v[234:235], v[172:173] op_sel:[1,0,0] op_sel_hi:[1,1,1]
    v_pk_fma_f32 v[170:171], v[226:227], v[236:237], v[170:171] op_sel:[0,0,0] op_sel_hi:[0,1,1]
    v_pk_fma_f32 v[174:175], v[226:227], v[236:237], v[174:175] op_sel:[1,0,0] op_sel_hi:[1,1,1]
    v_pk_fma_f32 v[176:177], v[226:227], v[248:249], v[176:177] op_sel:[0,0,0] op_sel_hi:[0,1,1]
    v_pk_fma_f32 v[180:181], v[226:227], v[248:249], v[180:181] op_sel:[1,0,0] op_sel_hi:[1,1,1]
    v_pk_fma_f32 v[178:179], v[226:227], v[250:251], v[178:179] op_sel:[0,0,0] op_sel_hi:[0,1,1]
    v_pk_fma_f32 v[182:183], v[226:227], v[250:251], v[182:183] op_sel:[1,0,0] op_sel_hi:[1,1,1]
    v_pk_fma_f32 v[184:185], v[226:227], v[252:253], v[184:185] op_sel:[0,0,0] op_sel_hi:[0,1,1]
    v_pk_fma_f32 v[188:189], v[226:227], v[252:253], v[188:189] op_sel:[1,0,0] op_sel_hi:[1,1,1]
    v_pk_fma_f32 v[186:187], v[226:227], v[254:255], v[186:187] op_sel:[0,0,0] op_sel_hi:[0,1,1]
    v_pk_fma_f32 v[190:191], v[226:227], v[254:255], v[190:191] op_sel:[1,0,0] op_sel_hi:[1,1,1]
    v_pk_fma_f32 v[192:193], v[226:227], v[200:201], v[192:193] op_sel:[0,0,0] op_sel_hi:[0,1,1]
    v_pk_fma_f32 v[196:197], v[226:227], v[200:201], v[196:197] op_sel:[1,0,0] op_sel_hi:[1,1,1]
    v_pk_fma_f32 v[194:195], v[226:227], v[202:203], v[194:195] op_sel:[0,0,0] op_sel_hi:[0,1,1]
    v_pk_fma_f32 v[198:199], v[226:227], v[202:203], v[198:199] op_sel:[1,0,0] op_sel_hi:[1,1,1]
    v_cndmask_b32 v228, v228, v229, s[90:91]
    s_mul_i32 s35, s24, 9728
    v_permlane16_swap_b32 v160, v164
    v_permlane16_swap_b32 v161, v165
    v_permlane16_swap_b32 v162, v166
    s_add_u32 m0, m0, 4096
    s_add_u32 s98, s98, 4096
    buffer_load_dwordx4 v218, s[4:7], s98 offen offset:0 sc1 lds
    v_permlane16_swap_b32 v163, v167
    v_permlane16_swap_b32 v168, v172
    v_permlane16_swap_b32 v169, v173
    v_permlane16_swap_b32 v170, v174
    v_permlane16_swap_b32 v171, v175
    v_permlane16_swap_b32 v176, v180
    v_permlane16_swap_b32 v177, v181
    v_permlane16_swap_b32 v178, v182
    v_permlane16_swap_b32 v179, v183
    v_permlane16_swap_b32 v184, v188
    v_permlane16_swap_b32 v185, v189
    v_permlane16_swap_b32 v186, v190
    v_permlane16_swap_b32 v187, v191
    v_permlane16_swap_b32 v192, v196
    v_permlane16_swap_b32 v193, v197
    v_permlane16_swap_b32 v194, v198
    v_permlane16_swap_b32 v195, v199
    s_waitcnt lgkmcnt(0)
    v_add_u32 v204, s35, v204
    v_add_u32 v205, s35, v205
    v_pk_mul_f32 v[184:185], v[184:185], v[228:229] op_sel_hi:[1,0]
    v_pk_mul_f32 v[186:187], v[186:187], v[228:229] op_sel_hi:[1,0]
    v_pk_mul_f32 v[188:189], v[188:189], v[228:229] op_sel_hi:[1,0]
    v_pk_mul_f32 v[190:191], v[190:191], v[228:229] op_sel_hi:[1,0]
    buffer_load_dwordx4 v218, s[4:7], s98 offen offset:1024 sc1 lds
    v_pk_mul_f32 v[192:193], v[192:193], v[228:229] op_sel_hi:[1,0]
    v_pk_mul_f32 v[194:195], v[194:195], v[228:229] op_sel_hi:[1,0]
    v_pk_mul_f32 v[196:197], v[196:197], v[228:229] op_sel_hi:[1,0]
    v_pk_mul_f32 v[198:199], v[198:199], v[228:229] op_sel_hi:[1,0]
    v_pk_mul_f32 v[178:179], v[178:179], v[228:229] op_sel_hi:[1,0]
    v_pk_mul_f32 v[182:183], v[182:183], v[228:229] op_sel_hi:[1,0]
    v_cvt_pk_bf16_f32 v184, v184, v185
    v_cvt_pk_bf16_f32 v185, v186, v187
    v_cvt_pk_bf16_f32 v186, v188, v189
    v_cvt_pk_bf16_f32 v187, v190, v191
    v_cvt_pk_bf16_f32 v188, v192, v193
    v_cvt_pk_bf16_f32 v189, v194, v195
    v_cvt_pk_bf16_f32 v190, v196, v197
    v_cvt_pk_bf16_f32 v191, v198, v199
    v_cvt_pk_bf16_f32 v192, v178, v179
    v_cvt_pk_bf16_f32 v193, v182, v183
    v_mov_b32 v194, 0x3f80
    v_mov_b32 v195, 0
    ds_write_b128 v205, v[184:187] offset:63648
    v_max3_f32 v200, v160, v161, v162
    v_min3_f32 v201, v160, v161, v162
    v_max3_f32 v200, v200, v163, v164
    v_min3_f32 v201, v201, v163, v164
    v_max3_f32 v200, v200, v165, v166
    v_min3_f32 v201, v201, v165, v166
    v_max3_f32 v200, v200, v167, v168
    s_add_u32 s64, s68, 49152
    buffer_load_dword v220, v218, s[4:7], s68 offen offset:0 sc1
    buffer_load_dword v220, v218, s[4:7], s64 offen offset:0 sc1
    v_min3_f32 v201, v201, v167, v168
    v_max3_f32 v200, v200, v169, v170
    v_min3_f32 v201, v201, v169, v170
    v_max3_f32 v200, v200, v171, v172
    v_min3_f32 v201, v201, v171, v172
    v_max3_f32 v200, v200, v173, v174
    v_min3_f32 v201, v201, v173, v174
    ds_write_b128 v205, v[188:191] offset:63664
    v_max3_f32 v200, v200, v175, v176
    v_min3_f32 v201, v201, v175, v176
    s_add_u32 s64, s69, 49152
    s_mov_b64 exec, 0xffff
    buffer_load_dword v220, v218, s[4:7], s69 offen offset:0 sc1
    buffer_load_dword v220, v218, s[4:7], s64 offen offset:0 sc1
    s_mov_b64 exec, -1
    v_max3_f32 v200, v200, v177, v180
    v_min3_f32 v201, v201, v177, v180
    v_mul_f32 v202, 0x3fb8aa3b, v228
    v_max_f32 v200, v200, v181
    v_min_f32 v201, v201, v181
    v_pk_mul_f32 v[200:201], v[200:201], v[202:203] op_sel_hi:[1,0]
    v_pk_fma_f32 v[230:231], v[160:161], v[202:203], v[200:201] op_sel:[0,0,1] op_sel_hi:[1,0,1] neg_lo:[1,0,0] neg_hi:[1,0,0]
    v_pk_fma_f32 v[160:161], v[160:161], v[202:203], v[200:201] op_sel:[0,0,0] op_sel_hi:[1,0,0] neg_lo:[0,0,1] neg_hi:[0,0,1]
    s_add_u32 s64, s80, 4096
    buffer_load_dword v220, off, s[4:7], s64 offset:1024 sc1
    buffer_load_dword v220, off, s[4:7], s64 offset:3072 sc1
    v_pk_fma_f32 v[232:233], v[162:163], v[202:203], v[200:201] op_sel:[0,0,1] op_sel_hi:[1,0,1] neg_lo:[1,0,0] neg_hi:[1,0,0]
    v_pk_fma_f32 v[162:163], v[162:163], v[202:203], v[200:201] op_sel:[0,0,0] op_sel_hi:[1,0,0] neg_lo:[0,0,1] neg_hi:[0,0,1]
    v_pk_fma_f32 v[234:235], v[164:165], v[202:203], v[200:201] op_sel:[0,0,1] op_sel_hi:[1,0,1] neg_lo:[1,0,0] neg_hi:[1,0,0]
    v_pk_fma_f32 v[164:165], v[164:165], v[202:203], v[200:201] op_sel:[0,0,0] op_sel_hi:[1,0,0] neg_lo:[0,0,1] neg_hi:[0,0,1]
    ds_write_b128 v205, v[192:195] offset:63680
    v_pk_fma_f32 v[236:237], v[166:167], v[202:203], v[200:201] op_sel:[0,0,1] op_sel_hi:[1,0,1] neg_lo:[1,0,0] neg_hi:[1,0,0]
    v_pk_fma_f32 v[166:167], v[166:167], v[202:203], v[200:201] op_sel:[0,0,0] op_sel_hi:[1,0,0] neg_lo:[0,0,1] neg_hi:[0,0,1]
    v_pk_fma_f32 v[238:239], v[168:169], v[202:203], v[200:201] op_sel:[0,0,1] op_sel_hi:[1,0,1] neg_lo:[1,0,0] neg_hi:[1,0,0]
    v_pk_fma_f32 v[168:169], v[168:169], v[202:203], v[200:201] op_sel:[0,0,0] op_sel_hi:[1,0,0] neg_lo:[0,0,1] neg_hi:[0,0,1]
    v_pk_fma_f32 v[240:241], v[170:171], v[202:203], v[200:201] op_sel:[0,0,1] op_sel_hi:[1,0,1] neg_lo:[1,0,0] neg_hi:[1,0,0]
    buffer_load_dword v220, v218, s[4:7], s75 offen offset:0 sc1
    v_pk_fma_f32 v[170:171], v[170:171], v[202:203], v[200:201] op_sel:[0,0,0] op_sel_hi:[1,0,0] neg_lo:[0,0,1] neg_hi:[0,0,1]
    v_pk_fma_f32 v[242:243], v[172:173], v[202:203], v[200:201] op_sel:[0,0,1] op_sel_hi:[1,0,1] neg_lo:[1,0,0] neg_hi:[1,0,0]
    v_pk_fma_f32 v[172:173], v[172:173], v[202:203], v[200:201] op_sel:[0,0,0] op_sel_hi:[1,0,0] neg_lo:[0,0,1] neg_hi:[0,0,1]
    v_pk_fma_f32 v[244:245], v[174:175], v[202:203], v[200:201] op_sel:[0,0,1] op_sel_hi:[1,0,1] neg_lo:[1,0,0] neg_hi:[1,0,0]
    v_pk_fma_f32 v[174:175], v[174:175], v[202:203], v[200:201] op_sel:[0,0,0] op_sel_hi:[1,0,0] neg_lo:[0,0,1] neg_hi:[0,0,1]
    v_pk_fma_f32 v[246:247], v[176:177], v[202:203], v[200:201] op_sel:[0,0,1] op_sel_hi:[1,0,1] neg_lo:[1,0,0] neg_hi:[1,0,0]
    v_pk_fma_f32 v[176:177], v[176:177], v[202:203], v[200:201] op_sel:[0,0,0] op_sel_hi:[1,0,0] neg_lo:[0,0,1] neg_hi:[0,0,1]
    v_pk_fma_f32 v[248:249], v[180:181], v[202:203], v[200:201] op_sel:[0,0,1] op_sel_hi:[1,0,1] neg_lo:[1,0,0] neg_hi:[1,0,0]
    v_pk_fma_f32 v[180:181], v[180:181], v[202:203], v[200:201] op_sel:[0,0,0] op_sel_hi:[1,0,0] neg_lo:[0,0,1] neg_hi:[0,0,1]
    v_exp_f32 v160, v160
    v_exp_f32 v230, v230
    buffer_load_dword v220, v218, s[4:7], s75 offen offset:1024 sc1
    v_exp_f32 v161, v161
    v_exp_f32 v231, v231
    v_exp_f32 v162, v162
    v_exp_f32 v232, v232
    v_exp_f32 v163, v163
    v_exp_f32 v233, v233
    v_exp_f32 v164, v164
    buffer_load_dword v220, v218, s[4:7], s76 offen offset:0 sc1
    v_exp_f32 v234, v234
    v_exp_f32 v165, v165
    v_exp_f32 v235, v235
    v_exp_f32 v166, v166
    v_exp_f32 v236, v236
    v_exp_f32 v167, v167
    v_exp_f32 v237, v237
    buffer_load_dword v220, v218, s[4:7], s77 offen offset:0 sc1
    v_exp_f32 v168, v168
    v_exp_f32 v238, v238
    v_exp_f32 v169, v169
    v_exp_f32 v239, v239
    v_exp_f32 v170, v170
    v_exp_f32 v240, v240
    v_exp_f32 v171, v171
    s_add_u32 s64, s78, 4096
    buffer_load_dword v220, off, s[4:7], s64 offset:2048 sc1
    v_exp_f32 v241, v241
    v_exp_f32 v172, v172
    v_exp_f32 v242, v242
    v_exp_f32 v173, v173
    v_exp_f32 v243, v243
    v_exp_f32 v174, v174
    s_mul_i32 s98, s24, 15360
    s_add_u32 m0, s98, 0
    s_add_u32 s98, m0, s83
    buffer_load_dwordx4 v218, s[4:7], s98 offen offset:0 sc1 lds
    v_exp_f32 v244, v244
    v_exp_f32 v175, v175
    v_exp_f32 v245, v245
    v_exp_f32 v176, v176
    v_exp_f32 v246, v246
    v_exp_f32 v177, v177
    v_exp_f32 v247, v247
    v_exp_f32 v180, v180
    v_exp_f32 v248, v248
    v_exp_f32 v181, v181
    v_exp_f32 v249, v249
    v_pk_add_f32 v[200:201], v[160:161], v[162:163]
    buffer_load_dwordx4 v218, s[4:7], s98 offen offset:1024 sc1 lds
    v_pk_add_f32 v[202:203], v[230:231], v[232:233]
    v_pk_add_f32 v[200:201], v[200:201], v[164:165]
    v_pk_add_f32 v[202:203], v[202:203], v[234:235]
    v_pk_add_f32 v[200:201], v[200:201], v[166:167]
    v_pk_add_f32 v[202:203], v[202:203], v[236:237]
    v_pk_add_f32 v[200:201], v[200:201], v[168:169]
    v_pk_add_f32 v[202:203], v[202:203], v[238:239]
    v_pk_add_f32 v[200:201], v[200:201], v[170:171]
    v_pk_add_f32 v[202:203], v[202:203], v[240:241]
    v_pk_add_f32 v[200:201], v[200:201], v[172:173]
    v_pk_add_f32 v[202:203], v[202:203], v[242:243]
    v_pk_add_f32 v[200:201], v[200:201], v[174:175]
    v_pk_add_f32 v[202:203], v[202:203], v[244:245]
    v_pk_add_f32 v[200:201], v[200:201], v[176:177]
    v_pk_add_f32 v[202:203], v[202:203], v[246:247]
    v_pk_add_f32 v[200:201], v[200:201], v[180:181]
    v_pk_add_f32 v[202:203], v[202:203], v[248:249]
    v_add_f32 v200, v200, v201
    v_add_f32 v202, v202, v203
    v_rcp_f32 v200, v200
    v_rcp_f32 v202, v202
    s_nop 0
    v_pk_mul_f32 v[230:231], v[230:231], v[202:203] op_sel_hi:[1,0]
    v_pk_mul_f32 v[232:233], v[232:233], v[202:203] op_sel_hi:[1,0]
    buffer_load_dwordx4 v218, s[4:7], s98 offen offset:2048 sc1 lds
    v_pk_mul_f32 v[234:235], v[234:235], v[202:203] op_sel_hi:[1,0]
    v_pk_mul_f32 v[236:237], v[236:237], v[202:203] op_sel_hi:[1,0]
    v_pk_mul_f32 v[238:239], v[238:239], v[202:203] op_sel_hi:[1,0]
    v_pk_mul_f32 v[240:241], v[240:241], v[202:203] op_sel_hi:[1,0]
    v_pk_mul_f32 v[242:243], v[242:243], v[202:203] op_sel_hi:[1,0]
    v_pk_mul_f32 v[244:245], v[244:245], v[202:203] op_sel_hi:[1,0]
    v_pk_mul_f32 v[246:247], v[246:247], v[202:203] op_sel_hi:[1,0]
    v_pk_mul_f32 v[248:249], v[248:249], v[202:203] op_sel_hi:[1,0]
    v_cvt_pk_bf16_f32 v249, v248, v249
    v_cvt_pk_bf16_f32 v248, v246, v247
    v_cvt_pk_bf16_f32 v247, v244, v245
    v_cvt_pk_bf16_f32 v246, v242, v243
    ds_write_b128 v204, v[246:249] offset:63552
    v_cvt_pk_bf16_f32 v245, v240, v241
    v_cvt_pk_bf16_f32 v244, v238, v239
    v_cvt_pk_bf16_f32 v243, v236, v237
    v_cvt_pk_bf16_f32 v242, v234, v235
    v_cvt_pk_bf16_f32 v241, v232, v233
    v_cvt_pk_bf16_f32 v240, v230, v231
    v_pk_mul_f32 v[160:161], v[160:161], v[200:201] op_sel_hi:[1,0]
    v_pk_mul_f32 v[162:163], v[162:163], v[200:201] op_sel_hi:[1,0]
    v_pk_mul_f32 v[164:165], v[164:165], v[200:201] op_sel_hi:[1,0]
    v_pk_mul_f32 v[166:167], v[166:167], v[200:201] op_sel_hi:[1,0]
    v_pk_mul_f32 v[168:169], v[168:169], v[200:201] op_sel_hi:[1,0]
    v_pk_mul_f32 v[170:171], v[170:171], v[200:201] op_sel_hi:[1,0]
    ds_write_b128 v204, v[242:245] offset:63536
    buffer_load_dwordx4 v218, s[4:7], s98 offen offset:3072 sc1 lds
    v_pk_mul_f32 v[172:173], v[172:173], v[200:201] op_sel_hi:[1,0]
    v_pk_mul_f32 v[174:175], v[174:175], v[200:201] op_sel_hi:[1,0]
    v_pk_mul_f32 v[176:177], v[176:177], v[200:201] op_sel_hi:[1,0]
    v_pk_mul_f32 v[180:181], v[180:181], v[200:201] op_sel_hi:[1,0]
    v_cvt_pk_bf16_f32 v238, v176, v177
    v_cvt_pk_bf16_f32 v239, v180, v181
    ds_write_b128 v204, v[238:241] offset:63520
    v_cvt_pk_bf16_f32 v230, v160, v161
    v_cvt_pk_bf16_f32 v231, v162, v163
    v_cvt_pk_bf16_f32 v232, v164, v165
    v_cvt_pk_bf16_f32 v233, v166, v167
    ds_write_b128 v204, v[230:233] offset:63488
    v_cvt_pk_bf16_f32 v234, v168, v169
    v_cvt_pk_bf16_f32 v235, v170, v171
    v_cvt_pk_bf16_f32 v236, v172, v173
    v_cvt_pk_bf16_f32 v237, v174, v175
    ds_write_b128 v204, v[234:237] offset:63504
    s_mul_i32 s35, s24, 40
    s_add_u32 s35, s35, 63488
    s_lshr_b32 s60, s24, 1
    s_mul_i32 s60, s60, 48
    s_add_u32 s60, s60, 63648
    v_add_u32 v223, s35, v206
    v_add_u32 v219, s60, v207
    s_waitcnt lgkmcnt(0)
    s_barrier
    ds_read_b64_tr_b16 v[176:177], v223 offset:0
    s_add_u32 m0, m0, 4096
    s_add_u32 s98, s98, 4096
    buffer_load_dwordx4 v218, s[4:7], s98 offen offset:0 sc1 lds
    ds_read_b64_tr_b16 v[178:179], v223 offset:1216
    ds_read_b64_tr_b16 v[180:181], v219 offset:0
    ds_read_b64_tr_b16 v[182:183], v219 offset:1216
    ds_read_b64_tr_b16 v[184:185], v223 offset:4864
    ds_read_b64_tr_b16 v[186:187], v223 offset:6080
    ds_read_b64_tr_b16 v[188:189], v219 offset:4864
    ds_read_b64_tr_b16 v[190:191], v219 offset:6080
    ds_read_b64_tr_b16 v[192:193], v223 offset:9728
    ds_read_b64_tr_b16 v[194:195], v223 offset:10944
    ds_read_b64_tr_b16 v[196:197], v219 offset:9728
    ds_read_b64_tr_b16 v[198:199], v219 offset:10944
    s_waitcnt lgkmcnt(8)
    v_mfma_f32_32x32x16_bf16 v[160:175], v[176:179], v[180:183], 0
    ds_read_b64_tr_b16 v[200:201], v223 offset:14592
    ds_read_b64_tr_b16 v[202:203], v223 offset:15808
    ds_read_b64_tr_b16 v[204:205], v219 offset:14592
    ds_read_b64_tr_b16 v[206:207], v219 offset:15808
    s_waitcnt lgkmcnt(8)
    v_mfma_f32_32x32x16_bf16 v[160:175], v[184:187], v[188:191], v[160:175]
    ds_read_b64_tr_b16 v[176:177], v223 offset:19456
    ds_read_b64_tr_b16 v[178:179], v223 offset:20672
    buffer_load_dwordx4 v218, s[4:7], s98 offen offset:1024 sc1 lds
    ds_read_b64_tr_b16 v[180:181], v219 offset:19456
    ds_read_b64_tr_b16 v[182:183], v219 offset:20672
    s_waitcnt lgkmcnt(8)
    v_mfma_f32_32x32x16_bf16 v[160:175], v[192:195], v[196:199], v[160:175]
    ds_read_b64_tr_b16 v[184:185], v223 offset:24320
    ds_read_b64_tr_b16 v[186:187], v223 offset:25536
    ds_read_b64_tr_b16 v[188:189], v219 offset:24320
    ds_read_b64_tr_b16 v[190:191], v219 offset:25536
    s_waitcnt lgkmcnt(8)
    v_mfma_f32_32x32x16_bf16 v[160:175], v[200:203], v[204:207], v[160:175]
    ds_read_b64_tr_b16 v[192:193], v223 offset:29184
    ds_read_b64_tr_b16 v[194:195], v223 offset:30400
    ds_read_b64_tr_b16 v[196:197], v219 offset:29184
    ds_read_b64_tr_b16 v[198:199], v219 offset:30400
    s_waitcnt lgkmcnt(8)
    v_mfma_f32_32x32x16_bf16 v[160:175], v[176:179], v[180:183], v[160:175]
    ds_read_b64_tr_b16 v[200:201], v223 offset:34048
    ds_read_b64_tr_b16 v[202:203], v223 offset:35264
    ds_read_b64_tr_b16 v[204:205], v219 offset:34048
    ds_read_b64_tr_b16 v[206:207], v219 offset:35264
    s_waitcnt lgkmcnt(8)
    v_mfma_f32_32x32x16_bf16 v[160:175], v[184:187], v[188:191], v[160:175]
    buffer_load_dwordx4 v218, s[4:7], s98 offen offset:2048 sc1 lds
    ds_read_b128 v[236:239], v224 offset:1024
    s_waitcnt lgkmcnt(5)
    v_mfma_f32_32x32x16_bf16 v[160:175], v[192:195], v[196:199], v[160:175]
    s_waitcnt lgkmcnt(1)
    v_mfma_f32_32x32x16_bf16 v[160:175], v[200:203], v[204:207], v[160:175]
    s_mul_i32 s60, s24, 880
    s_add_u32 s60, s60, 155648
    s_add_u32 s35, s86, 1048576
    v_add_u32 v223, 102400, v218
    s_waitcnt lgkmcnt(0)
    v_mov_b32 v219, v237
    v_add_u32 v236, s60, v236
    v_add_u32 v237, s60, v237
    s_mov_b32 exec_lo, 0x3fffff
    s_mov_b32 exec_hi, 0x3fffff
    s_nop 1
    v_cvt_pk_bf16_f32 v230, v160, v161
    v_cvt_pk_bf16_f32 v231, v162, v163
    v_cvt_pk_bf16_f32 v232, v164, v165
    v_cvt_pk_bf16_f32 v233, v166, v167
    ds_write2_b64 v236, v[230:231], v[232:233] offset0:0 offset1:2
    v_cvt_pk_bf16_f32 v234, v168, v169
    v_cvt_pk_bf16_f32 v235, v170, v171
    s_mov_b32 exec_hi, 0
    ds_write_b64 v236, v[234:235] offset:32
    s_mov_b32 exec_lo, 0xffffffff
    s_mov_b32 exec_hi, 0xffffff
    ds_read_b128 v[230:233], v237
    s_waitcnt lgkmcnt(0)
    v_min_u32 v230, -2, v230
    v_min_u32 v231, -2, v231
    v_min_u32 v232, -2, v232
    v_min_u32 v233, -2, v233
    buffer_store_dwordx4 v[230:233], v218, s[4:7], s35 offen sc1
    s_mov_b64 exec, -1
    s_waitcnt vmcnt(19)
    s_barrier
    ds_read_b128 a[240:243], v223 offset:0
    buffer_load_dwordx4 v218, s[4:7], s98 offen offset:3072 sc1 lds
    ds_read_b128 a[244:247], v223 offset:1024
    ds_read_b128 a[248:251], v238 offset:2048
    ds_read_b128 a[252:255], v223 offset:2560
    s_waitcnt lgkmcnt(3)
    v_mfma_f32_16x16x32_bf16 v[164:167], a[240:243], v[0:3], 0
    ds_read_b128 v[240:243], v223 offset:3584
    v_mfma_f32_16x16x32_bf16 v[168:171], a[240:243], v[4:7], 0
    s_waitcnt lgkmcnt(3)
    v_mfma_f32_16x16x32_bf16 v[172:175], a[244:247], v[0:3], 0
    ds_read_b128 v[244:247], v238 offset:4608
    v_mfma_f32_16x16x32_bf16 v[176:179], a[244:247], v[4:7], 0
    s_waitcnt lgkmcnt(3)
    v_mfma_f32_16x16x32_bf16 v[180:183], a[248:251], v[0:3], 0
    ds_read_b128 a[240:243], v223 offset:5120
    v_mfma_f32_16x16x32_bf16 v[184:187], a[248:251], v[4:7], 0
    s_waitcnt lgkmcnt(3)
    s_add_u32 m0, m0, 4096
    s_add_u32 s98, s98, 4096
    v_mfma_f32_16x16x32_bf16 v[164:167], a[252:255], v[8:11], v[164:167]
    ds_read_b128 a[244:247], v223 offset:6144
    v_mfma_f32_16x16x32_bf16 v[168:171], a[252:255], v[12:15], v[168:171]
    s_waitcnt lgkmcnt(3)
    buffer_load_dwordx4 v218, s[4:7], s98 offen offset:0 sc1 lds
    v_mfma_f32_16x16x32_bf16 v[172:175], v[240:243], v[8:11], v[172:175]
    ds_read_b128 a[248:251], v238 offset:7168
    v_mfma_f32_16x16x32_bf16 v[176:179], v[240:243], v[12:15], v[176:179]
    s_waitcnt lgkmcnt(3)
    v_mfma_f32_16x16x32_bf16 v[180:183], v[244:247], v[8:11], v[180:183]
    ds_read_b128 a[252:255], v223 offset:7680
    v_mfma_f32_16x16x32_bf16 v[184:187], v[244:247], v[12:15], v[184:187]
    s_waitcnt lgkmcnt(3)
    v_mfma_f32_16x16x32_bf16 v[164:167], a[240:243], v[16:19], v[164:167]
    ds_read_b128 v[240:243], v223 offset:8704
    v_mfma_f32_16x16x32_bf16 v[168:171], a[240:243], v[20:23], v[168:171]
    s_waitcnt lgkmcnt(3)
    buffer_load_dwordx4 v218, s[4:7], s98 offen offset:1024 sc1 lds
    v_mfma_f32_16x16x32_bf16 v[172:175], a[244:247], v[16:19], v[172:175]
    ds_read_b128 v[244:247], v238 offset:9728
    v_mfma_f32_16x16x32_bf16 v[176:179], a[244:247], v[20:23], v[176:179]
    s_waitcnt lgkmcnt(3)
    v_mfma_f32_16x16x32_bf16 v[180:183], a[248:251], v[16:19], v[180:183]
    ds_read_b128 a[240:243], v223 offset:10240
    v_mfma_f32_16x16x32_bf16 v[184:187], a[248:251], v[20:23], v[184:187]
    s_waitcnt lgkmcnt(3)
    v_mfma_f32_16x16x32_bf16 v[164:167], a[252:255], v[24:27], v[164:167]
    ds_read_b128 a[244:247], v223 offset:11264
    v_mfma_f32_16x16x32_bf16 v[168:171], a[252:255], v[28:31], v[168:171]
    s_waitcnt lgkmcnt(3)
    buffer_load_dwordx4 v218, s[4:7], s98 offen offset:2048 sc1 lds
    v_mfma_f32_16x16x32_bf16 v[172:175], v[240:243], v[24:27], v[172:175]
    ds_read_b128 a[248:251], v238 offset:12288
    v_mfma_f32_16x16x32_bf16 v[176:179], v[240:243], v[28:31], v[176:179]
    s_waitcnt lgkmcnt(3)
    v_mfma_f32_16x16x32_bf16 v[180:183], v[244:247], v[24:27], v[180:183]
    ds_read_b128 a[252:255], v223 offset:12800
    v_mfma_f32_16x16x32_bf16 v[184:187], v[244:247], v[28:31], v[184:187]
    s_waitcnt lgkmcnt(3)
    v_mfma_f32_16x16x32_bf16 v[164:167], a[240:243], v[32:35], v[164:167]
    ds_read_b128 v[240:243], v223 offset:13824
    v_mfma_f32_16x16x32_bf16 v[168:171], a[240:243], v[36:39], v[168:171]
    s_waitcnt lgkmcnt(3)
    v_mfma_f32_16x16x32_bf16 v[172:175], a[244:247], v[32:35], v[172:175]
    ds_read_b128 v[244:247], v238 offset:14848
    v_mfma_f32_16x16x32_bf16 v[176:179], a[244:247], v[36:39], v[176:179]
    s_waitcnt lgkmcnt(3)
    buffer_load_dwordx4 v218, s[4:7], s98 offen offset:3072 sc1 lds
    v_mfma_f32_16x16x32_bf16 v[180:183], a[248:251], v[32:35], v[180:183]
    ds_read_b128 a[240:243], v223 offset:15360
    v_mfma_f32_16x16x32_bf16 v[184:187], a[248:251], v[36:39], v[184:187]
    s_waitcnt lgkmcnt(3)
    v_mfma_f32_16x16x32_bf16 v[164:167], a[252:255], v[40:43], v[164:167]
    ds_read_b128 a[244:247], v223 offset:16384
    v_mfma_f32_16x16x32_bf16 v[168:171], a[252:255], v[44:47], v[168:171]
    s_waitcnt lgkmcnt(3)
    v_mfma_f32_16x16x32_bf16 v[172:175], v[240:243], v[40:43], v[172:175]
    ds_read_b128 a[248:251], v238 offset:17408
    v_mfma_f32_16x16x32_bf16 v[176:179], v[240:243], v[44:47], v[176:179]
    s_waitcnt lgkmcnt(3)
    s_add_u32 m0, m0, 4096
    s_add_u32 s98, s98, 4096
    v_mfma_f32_16x16x32_bf16 v[180:183], v[244:247], v[40:43], v[180:183]
    ds_read_b128 a[252:255], v223 offset:17920
    v_mfma_f32_16x16x32_bf16 v[184:187], v[244:247], v[44:47], v[184:187]
    s_waitcnt lgkmcnt(3)
    buffer_load_dwordx4 v218, s[4:7], s98 offen offset:0 sc1 lds
    v_mfma_f32_16x16x32_bf16 v[164:167], a[240:243], v[48:51], v[164:167]
    ds_read_b128 v[240:243], v223 offset:18944
    v_mfma_f32_16x16x32_bf16 v[168:171], a[240:243], v[52:55], v[168:171]
    s_waitcnt lgkmcnt(3)
    v_mfma_f32_16x16x32_bf16 v[172:175], a[244:247], v[48:51], v[172:175]
    ds_read_b128 v[244:247], v238 offset:19968
    v_mfma_f32_16x16x32_bf16 v[176:179], a[244:247], v[52:55], v[176:179]
    s_waitcnt lgkmcnt(3)
    v_mfma_f32_16x16x32_bf16 v[180:183], a[248:251], v[48:51], v[180:183]
    ds_read_b128 a[240:243], v223 offset:20480
    v_mfma_f32_16x16x32_bf16 v[184:187], a[248:251], v[52:55], v[184:187]
    s_waitcnt lgkmcnt(3)
    buffer_load_dwordx4 v218, s[4:7], s98 offen offset:1024 sc1 lds
    v_mfma_f32_16x16x32_bf16 v[164:167], a[252:255], v[56:59], v[164:167]
    ds_read_b128 a[244:247], v223 offset:21504
    v_mfma_f32_16x16x32_bf16 v[168:171], a[252:255], v[60:63], v[168:171]
    s_waitcnt lgkmcnt(3)
    v_mfma_f32_16x16x32_bf16 v[172:175], v[240:243], v[56:59], v[172:175]
    ds_read_b128 a[248:251], v238 offset:22528
    v_mfma_f32_16x16x32_bf16 v[176:179], v[240:243], v[60:63], v[176:179]
    s_waitcnt lgkmcnt(3)
    v_mfma_f32_16x16x32_bf16 v[180:183], v[244:247], v[56:59], v[180:183]
    ds_read_b128 a[252:255], v223 offset:23040
    v_mfma_f32_16x16x32_bf16 v[184:187], v[244:247], v[60:63], v[184:187]
    s_waitcnt lgkmcnt(3)
    buffer_load_dwordx4 v218, s[4:7], s98 offen offset:2048 sc1 lds
    v_mfma_f32_16x16x32_bf16 v[164:167], a[240:243], v[64:67], v[164:167]
    ds_read_b128 v[240:243], v223 offset:24064
    v_mfma_f32_16x16x32_bf16 v[168:171], a[240:243], v[68:71], v[168:171]
    s_waitcnt lgkmcnt(3)
    v_mfma_f32_16x16x32_bf16 v[172:175], a[244:247], v[64:67], v[172:175]
    ds_read_b128 v[244:247], v238 offset:25088
    v_mfma_f32_16x16x32_bf16 v[176:179], a[244:247], v[68:71], v[176:179]
    s_waitcnt lgkmcnt(3)
    v_mfma_f32_16x16x32_bf16 v[180:183], a[248:251], v[64:67], v[180:183]
    ds_read_b128 a[240:243], v223 offset:25600
    v_mfma_f32_16x16x32_bf16 v[184:187], a[248:251], v[68:71], v[184:187]
    s_waitcnt lgkmcnt(3)
    v_mfma_f32_16x16x32_bf16 v[164:167], a[252:255], v[72:75], v[164:167]
    s_mul_i32 s98, s24, 10240
    ds_read_b128 a[244:247], v223 offset:26624
    s_add_u32 m0, s98, 61440
    v_mfma_f32_16x16x32_bf16 v[168:171], a[252:255], v[76:79], v[168:171]
    s_waitcnt lgkmcnt(3)
    s_add_u32 s98, m0, s83
    v_mfma_f32_16x16x32_bf16 v[172:175], v[240:243], v[72:75], v[172:175]
    ds_read_b128 a[248:251], v238 offset:27648
    v_mfma_f32_16x16x32_bf16 v[176:179], v[240:243], v[76:79], v[176:179]
    s_waitcnt lgkmcnt(3)
    buffer_load_dwordx4 v218, s[4:7], s98 offen offset:0 sc1 lds
    v_mfma_f32_16x16x32_bf16 v[180:183], v[244:247], v[72:75], v[180:183]
    ds_read_b128 a[252:255], v223 offset:28160
    v_mfma_f32_16x16x32_bf16 v[184:187], v[244:247], v[76:79], v[184:187]
    s_waitcnt lgkmcnt(3)
    v_mfma_f32_16x16x32_bf16 v[164:167], a[240:243], v[80:83], v[164:167]
    ds_read_b128 v[240:243], v223 offset:29184
    v_mfma_f32_16x16x32_bf16 v[168:171], a[240:243], v[84:87], v[168:171]
    s_waitcnt lgkmcnt(3)
    buffer_load_dwordx4 v218, s[4:7], s98 offen offset:1024 sc1 lds
    v_mfma_f32_16x16x32_bf16 v[172:175], a[244:247], v[80:83], v[172:175]
    ds_read_b128 v[244:247], v238 offset:30208
    v_mfma_f32_16x16x32_bf16 v[176:179], a[244:247], v[84:87], v[176:179]
    s_waitcnt lgkmcnt(3)
    v_mfma_f32_16x16x32_bf16 v[180:183], a[248:251], v[80:83], v[180:183]
    s_add_u32 s99, s87, 1048576
    ds_read_b128 a[240:243], v223 offset:30720
    v_mfma_f32_16x16x32_bf16 v[184:187], a[248:251], v[84:87], v[184:187]
    s_waitcnt lgkmcnt(3)
    buffer_load_dwordx4 v[0:3], v219, s[4:7], s99 offen offset:0 sc1
    v_mfma_f32_16x16x32_bf16 v[164:167], a[252:255], v[88:91], v[164:167]
    ds_read_b128 a[244:247], v223 offset:31744
    v_mfma_f32_16x16x32_bf16 v[168:171], a[252:255], v[92:95], v[168:171]
    s_waitcnt lgkmcnt(3)
    v_mfma_f32_16x16x32_bf16 v[172:175], v[240:243], v[88:91], v[172:175]
    ds_read_b128 a[248:251], v238 offset:32768
    v_mfma_f32_16x16x32_bf16 v[176:179], v[240:243], v[92:95], v[176:179]
    s_waitcnt lgkmcnt(3)
    buffer_load_dwordx4 v[4:7], v219, s[4:7], s99 offen offset:1024 sc1
    v_mfma_f32_16x16x32_bf16 v[180:183], v[244:247], v[88:91], v[180:183]
    ds_read_b128 a[252:255], v223 offset:33280
    v_mfma_f32_16x16x32_bf16 v[184:187], v[244:247], v[92:95], v[184:187]
    s_waitcnt lgkmcnt(3)
    v_mfma_f32_16x16x32_bf16 v[164:167], a[240:243], v[96:99], v[164:167]
    ds_read_b128 v[240:243], v223 offset:34304
    v_mfma_f32_16x16x32_bf16 v[168:171], a[240:243], v[100:103], v[168:171]
    s_waitcnt lgkmcnt(3)
    v_mfma_f32_16x16x32_bf16 v[172:175], a[244:247], v[96:99], v[172:175]
    ds_read_b128 v[244:247], v238 offset:35328
    v_mfma_f32_16x16x32_bf16 v[176:179], a[244:247], v[100:103], v[176:179]
    s_waitcnt lgkmcnt(3)
    buffer_load_dwordx4 v[8:11], v219, s[4:7], s99 offen offset:2048 sc1
    v_mfma_f32_16x16x32_bf16 v[180:183], a[248:251], v[96:99], v[180:183]
    ds_read_b128 a[240:243], v223 offset:35840
    v_mfma_f32_16x16x32_bf16 v[184:187], a[248:251], v[100:103], v[184:187]
    s_waitcnt lgkmcnt(3)
    v_mfma_f32_16x16x32_bf16 v[164:167], a[252:255], v[104:107], v[164:167]
    ds_read_b128 a[244:247], v223 offset:36864
    v_mfma_f32_16x16x32_bf16 v[168:171], a[252:255], v[108:111], v[168:171]
    s_waitcnt lgkmcnt(3)
    buffer_load_dwordx4 v[12:15], v219, s[4:7], s99 offen offset:3072 sc1
    v_mfma_f32_16x16x32_bf16 v[172:175], v[240:243], v[104:107], v[172:175]
    ds_read_b128 a[248:251], v238 offset:37888
    v_mfma_f32_16x16x32_bf16 v[176:179], v[240:243], v[108:111], v[176:179]
    s_waitcnt lgkmcnt(3)
    v_mfma_f32_16x16x32_bf16 v[180:183], v[244:247], v[104:107], v[180:183]
    ds_read_b128 a[252:255], v223 offset:38400
    v_mfma_f32_16x16x32_bf16 v[184:187], v[244:247], v[108:111], v[184:187]
    s_waitcnt lgkmcnt(3)
    v_mfma_f32_16x16x32_bf16 v[164:167], a[240:243], v[112:115], v[164:167]
    s_add_u32 s99, s87, 1052672
    ds_read_b128 v[240:243], v223 offset:39424
    v_mfma_f32_16x16x32_bf16 v[168:171], a[240:243], v[116:119], v[168:171]
    s_waitcnt lgkmcnt(3)
    buffer_load_dwordx4 v[16:19], v219, s[4:7], s99 offen offset:0 sc1
    v_mfma_f32_16x16x32_bf16 v[172:175], a[244:247], v[112:115], v[172:175]
    ds_read_b128 v[244:247], v238 offset:40448
    v_mfma_f32_16x16x32_bf16 v[176:179], a[244:247], v[116:119], v[176:179]
    s_waitcnt lgkmcnt(3)
    v_mfma_f32_16x16x32_bf16 v[180:183], a[248:251], v[112:115], v[180:183]
    ds_read_b128 a[240:243], v223 offset:40960
    v_mfma_f32_16x16x32_bf16 v[184:187], a[248:251], v[116:119], v[184:187]
    s_waitcnt lgkmcnt(3)
    buffer_load_dwordx4 v[20:23], v219, s[4:7], s99 offen offset:1024 sc1
    v_mfma_f32_16x16x32_bf16 v[164:167], a[252:255], v[120:123], v[164:167]
    ds_read_b128 a[244:247], v223 offset:41984
    v_mfma_f32_16x16x32_bf16 v[168:171], a[252:255], v[124:127], v[168:171]
    s_waitcnt lgkmcnt(3)
    v_mfma_f32_16x16x32_bf16 v[172:175], v[240:243], v[120:123], v[172:175]
    ds_read_b128 a[248:251], v238 offset:43008
    v_mfma_f32_16x16x32_bf16 v[176:179], v[240:243], v[124:127], v[176:179]
    s_waitcnt lgkmcnt(3)
    v_mfma_f32_16x16x32_bf16 v[180:183], v[244:247], v[120:123], v[180:183]
    ds_read_b128 a[252:255], v223 offset:43520
    v_mfma_f32_16x16x32_bf16 v[184:187], v[244:247], v[124:127], v[184:187]
    s_waitcnt lgkmcnt(3)
    buffer_load_dwordx4 v[24:27], v219, s[4:7], s99 offen offset:2048 sc1
    v_mfma_f32_16x16x32_bf16 v[164:167], a[240:243], v[128:131], v[164:167]
    ds_read_b128 v[240:243], v223 offset:44544
    v_mfma_f32_16x16x32_bf16 v[168:171], a[240:243], v[132:135], v[168:171]
    s_waitcnt lgkmcnt(3)
    v_mfma_f32_16x16x32_bf16 v[172:175], a[244:247], v[128:131], v[172:175]
    ds_read_b128 v[244:247], v238 offset:45568
    v_mfma_f32_16x16x32_bf16 v[176:179], a[244:247], v[132:135], v[176:179]
    s_waitcnt lgkmcnt(3)
    buffer_load_dwordx4 v[28:31], v219, s[4:7], s99 offen offset:3072 sc1
    v_mfma_f32_16x16x32_bf16 v[180:183], a[248:251], v[128:131], v[180:183]
    ds_read_b128 a[240:243], v223 offset:46080
    v_mfma_f32_16x16x32_bf16 v[184:187], a[248:251], v[132:135], v[184:187]
    s_waitcnt lgkmcnt(3)
    v_mfma_f32_16x16x32_bf16 v[164:167], a[252:255], v[136:139], v[164:167]
    ds_read_b128 a[244:247], v223 offset:47104
    v_mfma_f32_16x16x32_bf16 v[168:171], a[252:255], v[140:143], v[168:171]
    s_waitcnt lgkmcnt(3)
    ds_read_b128 v[188:191], v225 offset:320
    v_mfma_f32_16x16x32_bf16 v[172:175], v[240:243], v[136:139], v[172:175]
    s_add_u32 s99, s87, 1056768
    ds_read_b128 a[248:251], v238 offset:48128
    v_mfma_f32_16x16x32_bf16 v[176:179], v[240:243], v[140:143], v[176:179]
    s_waitcnt lgkmcnt(4)
    ds_read_b128 v[192:195], v225 offset:384
    v_mfma_f32_16x16x32_bf16 v[180:183], v[244:247], v[136:139], v[180:183]
    ds_read_b128 a[252:255], v223 offset:48640
    v_mfma_f32_16x16x32_bf16 v[184:187], v[244:247], v[140:143], v[184:187]
    s_waitcnt lgkmcnt(5)
    ds_read_b128 v[196:199], v225 offset:448
    buffer_load_dwordx4 v[32:35], v219, s[4:7], s99 offen offset:0 sc1
    v_mfma_f32_16x16x32_bf16 v[164:167], a[240:243], v[144:147], v[164:167]
    ds_read_b128 v[240:243], v223 offset:49664
    v_mfma_f32_16x16x32_bf16 v[168:171], a[240:243], v[148:151], v[168:171]
    s_waitcnt lgkmcnt(6)
    buffer_load_dwordx4 v[36:39], v219, s[4:7], s99 offen offset:1024 sc1
    v_mfma_f32_16x16x32_bf16 v[172:175], a[244:247], v[144:147], v[172:175]
    ds_read_b128 v[244:247], v238 offset:50688
    v_mfma_f32_16x16x32_bf16 v[176:179], a[244:247], v[148:151], v[176:179]
    s_waitcnt lgkmcnt(5)
    ds_read_b64 v[250:251], v224 offset:3072
    v_mfma_f32_16x16x32_bf16 v[180:183], a[248:251], v[144:147], v[180:183]
    v_mfma_f32_16x16x32_bf16 v[184:187], a[248:251], v[148:151], v[184:187]
    s_waitcnt lgkmcnt(4)
    ds_read_b64 v[254:255], v224 offset:3072
    v_mfma_f32_16x16x32_bf16 v[164:167], a[252:255], v[152:155], v[164:167]
    buffer_load_dwordx4 v[40:43], v219, s[4:7], s99 offen offset:2048 sc1
    v_mfma_f32_16x16x32_bf16 v[168:171], a[252:255], v[156:159], v[168:171]
    s_waitcnt lgkmcnt(3)
    v_mov_b32 v252, 0
    v_mfma_f32_16x16x32_bf16 v[172:175], v[240:243], v[152:155], v[172:175]
    v_mfma_f32_16x16x32_bf16 v[176:179], v[240:243], v[156:159], v[176:179]
    s_waitcnt lgkmcnt(2)
    v_mov_b32 v253, 0
    v_mfma_f32_16x16x32_bf16 v[180:183], v[244:247], v[152:155], v[180:183]
    buffer_load_dwordx4 v[44:47], v219, s[4:7], s99 offen offset:3072 sc1
    v_mfma_f32_16x16x32_bf16 v[184:187], v[244:247], v[156:159], v[184:187]
    v_pk_fma_f32 v[164:165], v[226:227], v[188:189], v[164:165] op_sel:[0,0,0] op_sel_hi:[0,1,1]
    v_pk_fma_f32 v[168:169], v[226:227], v[188:189], v[168:169] op_sel:[1,0,0] op_sel_hi:[1,1,1]
    v_pk_fma_f32 v[166:167], v[226:227], v[190:191], v[166:167] op_sel:[0,0,0] op_sel_hi:[0,1,1]
    v_pk_fma_f32 v[170:171], v[226:227], v[190:191], v[170:171] op_sel:[1,0,0] op_sel_hi:[1,1,1]
    v_pk_fma_f32 v[172:173], v[226:227], v[192:193], v[172:173] op_sel:[0,0,0] op_sel_hi:[0,1,1]
    v_pk_fma_f32 v[176:177], v[226:227], v[192:193], v[176:177] op_sel:[1,0,0] op_sel_hi:[1,1,1]
    v_pk_fma_f32 v[174:175], v[226:227], v[194:195], v[174:175] op_sel:[0,0,0] op_sel_hi:[0,1,1]
    v_pk_fma_f32 v[178:179], v[226:227], v[194:195], v[178:179] op_sel:[1,0,0] op_sel_hi:[1,1,1]
    v_pk_fma_f32 v[180:181], v[226:227], v[196:197], v[180:181] op_sel:[0,0,0] op_sel_hi:[0,1,1]
    v_pk_fma_f32 v[184:185], v[226:227], v[196:197], v[184:185] op_sel:[1,0,0] op_sel_hi:[1,1,1]
    v_permlane16_swap_b32 v164, v168
    v_permlane16_swap_b32 v165, v169
    v_permlane16_swap_b32 v166, v170
    v_permlane16_swap_b32 v167, v171
    s_add_u32 s99, s87, 1060864
    buffer_load_dwordx4 v[48:51], v219, s[4:7], s99 offen offset:0 sc1
    v_permlane16_swap_b32 v172, v176
    v_permlane16_swap_b32 v173, v177
    v_permlane16_swap_b32 v174, v178
    v_permlane16_swap_b32 v175, v179
    v_permlane16_swap_b32 v180, v184
    v_permlane16_swap_b32 v181, v185
    ds_read_b128 v[188:191], v224 offset:2048
    v_max3_f32 v182, v164, v165, v166
    v_min3_f32 v183, v164, v165, v166
    v_max3_f32 v182, v182, v167, v168
    v_min3_f32 v183, v183, v167, v168
    v_max3_f32 v182, v182, v169, v170
    v_min3_f32 v183, v183, v169, v170
    v_max3_f32 v182, v182, v171, v172
    v_min3_f32 v183, v183, v171, v172
    buffer_load_dwordx4 v[52:55], v219, s[4:7], s99 offen offset:1024 sc1
    v_max3_f32 v182, v182, v173, v174
    v_min3_f32 v183, v183, v173, v174
    v_max3_f32 v182, v182, v175, v176
    v_min3_f32 v183, v183, v175, v176
    v_max3_f32 v182, v182, v177, v178
    v_min3_f32 v183, v183, v177, v178
    v_max3_f32 v182, v182, v179, v180
    v_min3_f32 v183, v183, v179, v180
    v_max3_f32 v182, v182, v181, v184
    v_min3_f32 v183, v183, v181, v184
    v_mul_f32 v186, 0x3fb8aa3b, v228
    v_max_f32 v182, v182, v185
    v_min_f32 v183, v183, v185
    v_pk_mul_f32 v[182:183], v[182:183], v[186:187] op_sel_hi:[1,0]
    v_pk_fma_f32 v[230:231], v[164:165], v[186:187], v[182:183] op_sel:[0,0,1] op_sel_hi:[1,0,1] neg_lo:[1,0,0] neg_hi:[1,0,0]
    v_pk_fma_f32 v[164:165], v[164:165], v[186:187], v[182:183] op_sel:[0,0,0] op_sel_hi:[1,0,0] neg_lo:[0,0,1] neg_hi:[0,0,1]
    buffer_load_dwordx4 v[56:59], v219, s[4:7], s99 offen offset:2048 sc1
    v_pk_fma_f32 v[232:233], v[166:167], v[186:187], v[182:183] op_sel:[0,0,1] op_sel_hi:[1,0,1] neg_lo:[1,0,0] neg_hi:[1,0,0]
    v_pk_fma_f32 v[166:167], v[166:167], v[186:187], v[182:183] op_sel:[0,0,0] op_sel_hi:[1,0,0] neg_lo:[0,0,1] neg_hi:[0,0,1]
    v_pk_fma_f32 v[234:235], v[168:169], v[186:187], v[182:183] op_sel:[0,0,1] op_sel_hi:[1,0,1] neg_lo:[1,0,0] neg_hi:[1,0,0]
    v_pk_fma_f32 v[168:169], v[168:169], v[186:187], v[182:183] op_sel:[0,0,0] op_sel_hi:[1,0,0] neg_lo:[0,0,1] neg_hi:[0,0,1]
    v_pk_fma_f32 v[236:237], v[170:171], v[186:187], v[182:183] op_sel:[0,0,1] op_sel_hi:[1,0,1] neg_lo:[1,0,0] neg_hi:[1,0,0]
    v_pk_fma_f32 v[170:171], v[170:171], v[186:187], v[182:183] op_sel:[0,0,0] op_sel_hi:[1,0,0] neg_lo:[0,0,1] neg_hi:[0,0,1]
    v_pk_fma_f32 v[238:239], v[172:173], v[186:187], v[182:183] op_sel:[0,0,1] op_sel_hi:[1,0,1] neg_lo:[1,0,0] neg_hi:[1,0,0]
    v_pk_fma_f32 v[172:173], v[172:173], v[186:187], v[182:183] op_sel:[0,0,0] op_sel_hi:[1,0,0] neg_lo:[0,0,1] neg_hi:[0,0,1]
    v_pk_fma_f32 v[240:241], v[174:175], v[186:187], v[182:183] op_sel:[0,0,1] op_sel_hi:[1,0,1] neg_lo:[1,0,0] neg_hi:[1,0,0]
    v_pk_fma_f32 v[174:175], v[174:175], v[186:187], v[182:183] op_sel:[0,0,0] op_sel_hi:[1,0,0] neg_lo:[0,0,1] neg_hi:[0,0,1]
    v_pk_fma_f32 v[242:243], v[176:177], v[186:187], v[182:183] op_sel:[0,0,1] op_sel_hi:[1,0,1] neg_lo:[1,0,0] neg_hi:[1,0,0]
    v_pk_fma_f32 v[176:177], v[176:177], v[186:187], v[182:183] op_sel:[0,0,0] op_sel_hi:[1,0,0] neg_lo:[0,0,1] neg_hi:[0,0,1]
    v_pk_fma_f32 v[244:245], v[178:179], v[186:187], v[182:183] op_sel:[0,0,1] op_sel_hi:[1,0,1] neg_lo:[1,0,0] neg_hi:[1,0,0]
    v_pk_fma_f32 v[178:179], v[178:179], v[186:187], v[182:183] op_sel:[0,0,0] op_sel_hi:[1,0,0] neg_lo:[0,0,1] neg_hi:[0,0,1]
    v_pk_fma_f32 v[246:247], v[180:181], v[186:187], v[182:183] op_sel:[0,0,1] op_sel_hi:[1,0,1] neg_lo:[1,0,0] neg_hi:[1,0,0]
    v_pk_fma_f32 v[180:181], v[180:181], v[186:187], v[182:183] op_sel:[0,0,0] op_sel_hi:[1,0,0] neg_lo:[0,0,1] neg_hi:[0,0,1]
    buffer_load_dwordx4 v[60:63], v219, s[4:7], s99 offen offset:3072 sc1
    v_pk_fma_f32 v[248:249], v[184:185], v[186:187], v[182:183] op_sel:[0,0,1] op_sel_hi:[1,0,1] neg_lo:[1,0,0] neg_hi:[1,0,0]
    v_pk_fma_f32 v[184:185], v[184:185], v[186:187], v[182:183] op_sel:[0,0,0] op_sel_hi:[1,0,0] neg_lo:[0,0,1] neg_hi:[0,0,1]
    v_exp_f32 v164, v164
    v_exp_f32 v230, v230
    v_exp_f32 v165, v165
    v_exp_f32 v231, v231
    v_exp_f32 v166, v166
    v_exp_f32 v232, v232
    v_exp_f32 v167, v167
    buffer_load_dwordx4 v218, s[4:7], s98 offen offset:2048 sc1 lds
    v_exp_f32 v233, v233
    v_exp_f32 v168, v168
    v_exp_f32 v234, v234
    v_exp_f32 v169, v169
    v_exp_f32 v235, v235
    v_exp_f32 v170, v170
    v_exp_f32 v236, v236
    v_exp_f32 v171, v171
    v_exp_f32 v237, v237
    v_exp_f32 v172, v172
    v_exp_f32 v238, v238
    v_exp_f32 v173, v173
    v_exp_f32 v239, v239
    buffer_load_dwordx4 v218, s[4:7], s98 offen offset:3072 sc1 lds
    v_exp_f32 v174, v174
    v_exp_f32 v240, v240
    v_exp_f32 v175, v175
    v_exp_f32 v241, v241
    v_exp_f32 v176, v176
    v_exp_f32 v242, v242
    v_exp_f32 v177, v177
    v_exp_f32 v243, v243
    s_mov_b32 s65, 262144
    s_waitcnt vmcnt(12)
L_kvagain_35:
    v_max_u32 v192, v0, v20
    v_max3_u32 v192, v192, v4, v8
    v_max3_u32 v192, v192, v12, v16
    v_cmp_eq_u32 vcc, -1, v192
    s_cbranch_vccz L_kvhave_36
    s_add_u32 s61, s87, 1048576
    v_cmp_eq_u32 vcc, -1, v0
    s_mov_b64 exec, vcc
    buffer_load_dwordx4 v[0:3], v219, s[4:7], s61 offen offset:0 sc1
    s_mov_b64 exec, -1
    v_cmp_eq_u32 vcc, -1, v4
    s_mov_b64 exec, vcc
    buffer_load_dwordx4 v[4:7], v219, s[4:7], s61 offen offset:1024 sc1
    s_mov_b64 exec, -1
    v_cmp_eq_u32 vcc, -1, v8
    s_mov_b64 exec, vcc
    buffer_load_dwordx4 v[8:11], v219, s[4:7], s61 offen offset:2048 sc1
    s_mov_b64 exec, -1
    v_cmp_eq_u32 vcc, -1, v12
    s_mov_b64 exec, vcc
    buffer_load_dwordx4 v[12:15], v219, s[4:7], s61 offen offset:3072 sc1
    s_mov_b64 exec, -1
    s_add_u32 s61, s87, 1052672
    v_cmp_eq_u32 vcc, -1, v16
    s_mov_b64 exec, vcc
    buffer_load_dwordx4 v[16:19], v219, s[4:7], s61 offen offset:0 sc1
    s_mov_b64 exec, -1
    v_cmp_eq_u32 vcc, -1, v20
    s_mov_b64 exec, vcc
    buffer_load_dwordx4 v[20:23], v219, s[4:7], s61 offen offset:1024 sc1
    s_mov_b64 exec, -1
    s_sub_u32 s65, s65, 1
    s_waitcnt vmcnt(0)
    s_cbranch_scc0 L_kvagain_35
L_kvhave_36:
    s_waitcnt lgkmcnt(2)
    v_mfma_f32_16x16x32_bf16 v[200:203], v[250:253], v[0:3], 0
    s_add_u32 m0, m0, 4096
    s_add_u32 s98, s98, 4096
    buffer_load_dwordx4 v218, s[4:7], s98 offen offset:0 sc1 lds
    v_exp_f32 v178, v178
    s_waitcnt lgkmcnt(1)
    v_mfma_f32_16x16x32_bf16 v[204:207], v[252:255], v[0:3], 0
    v_exp_f32 v244, v244
    v_mfma_f32_16x16x32_bf16 v[200:203], v[250:253], v[4:7], v[200:203]
    v_exp_f32 v179, v179
    v_mfma_f32_16x16x32_bf16 v[204:207], v[252:255], v[4:7], v[204:207]
    v_exp_f32 v245, v245
    v_mfma_f32_16x16x32_bf16 v[200:203], v[250:253], v[8:11], v[200:203]
    v_exp_f32 v180, v180
    v_mfma_f32_16x16x32_bf16 v[204:207], v[252:255], v[8:11], v[204:207]
    v_exp_f32 v246, v246
    v_mfma_f32_16x16x32_bf16 v[200:203], v[250:253], v[12:15], v[200:203]
    buffer_load_dwordx4 v218, s[4:7], s98 offen offset:1024 sc1 lds
    v_exp_f32 v181, v181
    v_mfma_f32_16x16x32_bf16 v[204:207], v[252:255], v[12:15], v[204:207]
    v_exp_f32 v247, v247
    v_mfma_f32_16x16x32_bf16 v[200:203], v[250:253], v[16:19], v[200:203]
    v_exp_f32 v184, v184
    v_mfma_f32_16x16x32_bf16 v[204:207], v[252:255], v[16:19], v[204:207]
    v_exp_f32 v248, v248
    v_mfma_f32_16x16x32_bf16 v[200:203], v[250:253], v[20:23], v[200:203]
    v_exp_f32 v185, v185
    v_mfma_f32_16x16x32_bf16 v[204:207], v[252:255], v[20:23], v[204:207]
    v_exp_f32 v249, v249
    v_pk_add_f32 v[182:183], v[164:165], v[166:167]
    v_pk_add_f32 v[186:187], v[230:231], v[232:233]
    v_pk_add_f32 v[182:183], v[182:183], v[168:169]
    v_pk_add_f32 v[186:187], v[186:187], v[234:235]
    buffer_load_dwordx4 v218, s[4:7], s98 offen offset:2048 sc1 lds
    v_pk_add_f32 v[182:183], v[182:183], v[170:171]
    v_pk_add_f32 v[186:187], v[186:187], v[236:237]
    v_pk_add_f32 v[182:183], v[182:183], v[172:173]
    v_pk_add_f32 v[186:187], v[186:187], v[238:239]
    v_pk_add_f32 v[182:183], v[182:183], v[174:175]
    v_pk_add_f32 v[186:187], v[186:187], v[240:241]
    v_pk_add_f32 v[182:183], v[182:183], v[176:177]
    v_pk_add_f32 v[186:187], v[186:187], v[242:243]
    v_pk_add_f32 v[182:183], v[182:183], v[178:179]
    v_pk_add_f32 v[186:187], v[186:187], v[244:245]
    v_pk_add_f32 v[182:183], v[182:183], v[180:181]
    v_pk_add_f32 v[186:187], v[186:187], v[246:247]
    v_pk_add_f32 v[182:183], v[182:183], v[184:185]
    v_pk_add_f32 v[186:187], v[186:187], v[248:249]
    v_add_f32 v182, v182, v183
    v_add_f32 v186, v186, v187
    v_rcp_f32 v182, v182
    v_rcp_f32 v186, v186
    v_pk_mul_f32 v[164:165], v[164:165], v[182:183] op_sel_hi:[1,0]
    v_pk_mul_f32 v[230:231], v[230:231], v[186:187] op_sel_hi:[1,0]
    v_pk_mul_f32 v[166:167], v[166:167], v[182:183] op_sel_hi:[1,0]
    v_pk_mul_f32 v[232:233], v[232:233], v[186:187] op_sel_hi:[1,0]
    v_pk_mul_f32 v[168:169], v[168:169], v[182:183] op_sel_hi:[1,0]
    v_pk_mul_f32 v[234:235], v[234:235], v[186:187] op_sel_hi:[1,0]
    buffer_load_dwordx4 v218, s[4:7], s98 offen offset:3072 sc1 lds
    v_pk_mul_f32 v[170:171], v[170:171], v[182:183] op_sel_hi:[1,0]
    v_pk_mul_f32 v[236:237], v[236:237], v[186:187] op_sel_hi:[1,0]
    v_pk_mul_f32 v[172:173], v[172:173], v[182:183] op_sel_hi:[1,0]
    v_pk_mul_f32 v[238:239], v[238:239], v[186:187] op_sel_hi:[1,0]
    v_pk_mul_f32 v[174:175], v[174:175], v[182:183] op_sel_hi:[1,0]
    v_pk_mul_f32 v[240:241], v[240:241], v[186:187] op_sel_hi:[1,0]
    v_pk_mul_f32 v[176:177], v[176:177], v[182:183] op_sel_hi:[1,0]
    v_pk_mul_f32 v[242:243], v[242:243], v[186:187] op_sel_hi:[1,0]
    v_pk_mul_f32 v[178:179], v[178:179], v[182:183] op_sel_hi:[1,0]
    v_pk_mul_f32 v[244:245], v[244:245], v[186:187] op_sel_hi:[1,0]
    v_pk_mul_f32 v[180:181], v[180:181], v[182:183] op_sel_hi:[1,0]
    v_pk_mul_f32 v[246:247], v[246:247], v[186:187] op_sel_hi:[1,0]
    v_pk_mul_f32 v[184:185], v[184:185], v[182:183] op_sel_hi:[1,0]
    v_pk_mul_f32 v[248:249], v[248:249], v[186:187] op_sel_hi:[1,0]
    v_cvt_pk_bf16_f32 v164, v164, v165
    v_cvt_pk_bf16_f32 v165, v166, v167
    v_cvt_pk_bf16_f32 v166, v168, v169
    v_cvt_pk_bf16_f32 v167, v170, v171
    v_cvt_pk_bf16_f32 v168, v172, v173
    v_cvt_pk_bf16_f32 v169, v174, v175
    v_cvt_pk_bf16_f32 v170, v176, v177
    v_cvt_pk_bf16_f32 v171, v178, v179
    v_cvt_pk_bf16_f32 v172, v180, v181
    v_cvt_pk_bf16_f32 v173, v184, v185
    v_cvt_pk_bf16_f32 v174, v230, v231
    v_cvt_pk_bf16_f32 v175, v232, v233
    s_add_u32 m0, m0, 4096
    s_add_u32 s98, s98, 4096
    buffer_load_dwordx4 v218, s[4:7], s98 offen offset:0 sc1 lds
    v_cvt_pk_bf16_f32 v176, v234, v235
    v_cvt_pk_bf16_f32 v177, v236, v237
    v_cvt_pk_bf16_f32 v178, v238, v239
    v_cvt_pk_bf16_f32 v179, v240, v241
    v_cvt_pk_bf16_f32 v180, v242, v243
    v_cvt_pk_bf16_f32 v181, v244, v245
    v_cvt_pk_bf16_f32 v182, v246, v247
    v_cvt_pk_bf16_f32 v183, v248, v249
    s_mov_b32 s65, 262144
    s_waitcnt vmcnt(11)
L_kvagain_37:
    v_max_u32 v192, v24, v44
    v_max3_u32 v192, v192, v28, v32
    v_max3_u32 v192, v192, v36, v40
    v_cmp_eq_u32 vcc, -1, v192
    s_cbranch_vccz L_kvhave_38
    s_add_u32 s61, s87, 1052672
    v_cmp_eq_u32 vcc, -1, v24
    s_mov_b64 exec, vcc
    buffer_load_dwordx4 v[24:27], v219, s[4:7], s61 offen offset:2048 sc1
    s_mov_b64 exec, -1
    v_cmp_eq_u32 vcc, -1, v28
    s_mov_b64 exec, vcc
    buffer_load_dwordx4 v[28:31], v219, s[4:7], s61 offen offset:3072 sc1
    s_mov_b64 exec, -1
    s_add_u32 s61, s87, 1056768
    v_cmp_eq_u32 vcc, -1, v32
    s_mov_b64 exec, vcc
    buffer_load_dwordx4 v[32:35], v219, s[4:7], s61 offen offset:0 sc1
    s_mov_b64 exec, -1
    v_cmp_eq_u32 vcc, -1, v36
    s_mov_b64 exec, vcc
    buffer_load_dwordx4 v[36:39], v219, s[4:7], s61 offen offset:1024 sc1
    s_mov_b64 exec, -1
    v_cmp_eq_u32 vcc, -1, v40
    s_mov_b64 exec, vcc
    buffer_load_dwordx4 v[40:43], v219, s[4:7], s61 offen offset:2048 sc1
    s_mov_b64 exec, -1
    v_cmp_eq_u32 vcc, -1, v44
    s_mov_b64 exec, vcc
    buffer_load_dwordx4 v[44:47], v219, s[4:7], s61 offen offset:3072 sc1
    s_mov_b64 exec, -1
    s_sub_u32 s65, s65, 1
    s_waitcnt vmcnt(0)
    s_cbranch_scc0 L_kvagain_37
L_kvhave_38:
    v_mfma_f32_16x16x32_bf16 v[200:203], v[250:253], v[24:27], v[200:203]
    buffer_load_dwordx4 v218, s[4:7], s98 offen offset:1024 sc1 lds
    v_mfma_f32_16x16x32_bf16 v[204:207], v[252:255], v[24:27], v[204:207]
    v_mfma_f32_16x16x32_bf16 v[200:203], v[250:253], v[28:31], v[200:203]
    v_mfma_f32_16x16x32_bf16 v[204:207], v[252:255], v[28:31], v[204:207]
    v_mfma_f32_16x16x32_bf16 v[200:203], v[250:253], v[32:35], v[200:203]
    v_mfma_f32_16x16x32_bf16 v[204:207], v[252:255], v[32:35], v[204:207]
    v_mfma_f32_16x16x32_bf16 v[200:203], v[250:253], v[36:39], v[200:203]
    v_mfma_f32_16x16x32_bf16 v[204:207], v[252:255], v[36:39], v[204:207]
    v_mfma_f32_16x16x32_bf16 v[200:203], v[250:253], v[40:43], v[200:203]
    v_mfma_f32_16x16x32_bf16 v[204:207], v[252:255], v[40:43], v[204:207]
    v_mfma_f32_16x16x32_bf16 v[200:203], v[250:253], v[44:47], v[200:203]
    v_mfma_f32_16x16x32_bf16 v[204:207], v[252:255], v[44:47], v[204:207]
    s_mov_b32 s65, 262144
    s_waitcnt vmcnt(8)
L_kvagain_39:
    v_max_u32 v192, v48, v60
    v_max3_u32 v192, v192, v52, v56
    v_cmp_eq_u32 vcc, -1, v192
    s_cbranch_vccz L_kvhave_40
    s_add_u32 s61, s87, 1060864
    v_cmp_eq_u32 vcc, -1, v48
    s_mov_b64 exec, vcc
    buffer_load_dwordx4 v[48:51], v219, s[4:7], s61 offen offset:0 sc1
    s_mov_b64 exec, -1
    v_cmp_eq_u32 vcc, -1, v52
    s_mov_b64 exec, vcc
    buffer_load_dwordx4 v[52:55], v219, s[4:7], s61 offen offset:1024 sc1
    s_mov_b64 exec, -1
    v_cmp_eq_u32 vcc, -1, v56
    s_mov_b64 exec, vcc
    buffer_load_dwordx4 v[56:59], v219, s[4:7], s61 offen offset:2048 sc1
    s_mov_b64 exec, -1
    v_cmp_eq_u32 vcc, -1, v60
    s_mov_b64 exec, vcc
    buffer_load_dwordx4 v[60:63], v219, s[4:7], s61 offen offset:3072 sc1
    s_mov_b64 exec, -1
    s_sub_u32 s65, s65, 1
    s_waitcnt vmcnt(0)
    s_cbranch_scc0 L_kvagain_39
L_kvhave_40:
    v_mfma_f32_16x16x32_bf16 v[200:203], v[250:253], v[48:51], v[200:203]
    v_mfma_f32_16x16x32_bf16 v[204:207], v[252:255], v[48:51], v[204:207]
    v_mfma_f32_16x16x32_bf16 v[200:203], v[250:253], v[52:55], v[200:203]
    v_mfma_f32_16x16x32_bf16 v[204:207], v[252:255], v[52:55], v[204:207]
    v_mfma_f32_16x16x32_bf16 v[200:203], v[250:253], v[56:59], v[200:203]
    v_mfma_f32_16x16x32_bf16 v[204:207], v[252:255], v[56:59], v[204:207]
    v_mfma_f32_16x16x32_bf16 v[200:203], v[250:253], v[60:63], v[200:203]
    v_mfma_f32_16x16x32_bf16 v[204:207], v[252:255], v[60:63], v[204:207]
    s_mul_i32 s35, s24, 880
    s_add_u32 s35, s35, 155648
    v_add_u32 v223, s35, v219
    s_nop 4
    v_cmp_u_f32 vcc, v204, v204
    s_cbranch_vccnz L_kvretry_41
L_kvok_42:
    v_cvt_pk_bf16_f32 v192, v200, v201
    v_cvt_pk_bf16_f32 v193, v202, v203
    v_cvt_pk_bf16_f32 v194, v204, v205
    v_cvt_pk_bf16_f32 v195, v206, v207
    ds_write_b128 v223, v[192:195]
    s_waitcnt lgkmcnt(0)
    s_barrier
    ds_read2_b64 v[4:7], v189 offset0:0 offset1:1
    ds_read2_b64 v[0:3], v188 offset0:0 offset1:1
    ds_read2_b64 v[12:15], v189 offset0:2 offset1:3
    ds_read2_b64 v[8:11], v188 offset0:2 offset1:3
    ds_read2_b64 v[20:23], v189 offset0:4 offset1:110
    ds_read2_b64 v[16:19], v188 offset0:4 offset1:110
    ds_read2_b64 v[28:31], v189 offset0:111 offset1:112
    ds_read2_b64 v[24:27], v188 offset0:111 offset1:112
    ds_read2_b64 v[36:39], v189 offset0:113 offset1:114
    ds_read2_b64 v[32:35], v188 offset0:113 offset1:114
    s_waitcnt lgkmcnt(9)
    v_mfma_f32_32x32x16_bf16 v[230:245], v[4:7], v[164:167], 0
    s_waitcnt lgkmcnt(8)
    v_mfma_f32_32x32x16_bf16 v[40:55], v[0:3], v[164:167], 0
    s_waitcnt lgkmcnt(7)
    v_mfma_f32_32x32x16_bf16 v[230:245], v[12:15], v[168:171], v[230:245]
    s_waitcnt lgkmcnt(6)
    v_mfma_f32_32x32x16_bf16 v[40:55], v[8:11], v[168:171], v[40:55]
    s_waitcnt lgkmcnt(5)
    v_mfma_f32_32x32x16_bf16 v[230:245], v[20:23], v[172:175], v[230:245]
    s_waitcnt lgkmcnt(4)
    v_mfma_f32_32x32x16_bf16 v[40:55], v[16:19], v[172:175], v[40:55]
    s_waitcnt lgkmcnt(3)
    v_mfma_f32_32x32x16_bf16 v[230:245], v[28:31], v[176:179], v[230:245]
    s_waitcnt lgkmcnt(2)
    v_mfma_f32_32x32x16_bf16 v[40:55], v[24:27], v[176:179], v[40:55]
    s_waitcnt lgkmcnt(1)
    v_mfma_f32_32x32x16_bf16 v[230:245], v[36:39], v[180:183], v[230:245]
    s_waitcnt lgkmcnt(0)
    v_mfma_f32_32x32x16_bf16 v[40:55], v[32:35], v[180:183], v[40:55]
    s_add_u32 s35, s80, 4096
    s_nop 8
    v_add_f32 v234, 0x358637bd, v234
    v_rcp_f32 v234, v234
    s_nop 0
    v_pk_mul_f32 v[230:231], v[230:231], v[234:235] op_sel_hi:[1,0]
    v_cvt_pk_bf16_f32 v200, v230, v231
    v_pk_mul_f32 v[232:233], v[232:233], v[234:235] op_sel_hi:[1,0]
    v_cvt_pk_bf16_f32 v201, v232, v233
    buffer_store_dwordx2 v[200:201], v191, s[4:7], s69 offen
    v_pk_mul_f32 v[40:41], v[40:41], v[234:235] op_sel_hi:[1,0]
    v_cvt_pk_bf16_f32 v192, v40, v41
    v_pk_mul_f32 v[42:43], v[42:43], v[234:235] op_sel_hi:[1,0]
    v_cvt_pk_bf16_f32 v193, v42, v43
    v_pk_mul_f32 v[44:45], v[44:45], v[234:235] op_sel_hi:[1,0]
    v_cvt_pk_bf16_f32 v194, v44, v45
    v_pk_mul_f32 v[46:47], v[46:47], v[234:235] op_sel_hi:[1,0]
    v_cvt_pk_bf16_f32 v195, v46, v47
    buffer_store_dwordx4 v[192:195], v190, s[4:7], s68 offen
    v_pk_mul_f32 v[48:49], v[48:49], v[234:235] op_sel_hi:[1,0]
    v_cvt_pk_bf16_f32 v196, v48, v49
    v_pk_mul_f32 v[50:51], v[50:51], v[234:235] op_sel_hi:[1,0]
    v_cvt_pk_bf16_f32 v197, v50, v51
    v_pk_mul_f32 v[52:53], v[52:53], v[234:235] op_sel_hi:[1,0]
    v_cvt_pk_bf16_f32 v198, v52, v53
    v_pk_mul_f32 v[54:55], v[54:55], v[234:235] op_sel_hi:[1,0]
    v_cvt_pk_bf16_f32 v199, v54, v55
    buffer_store_dwordx4 v[196:199], v190, s[4:7], s68 offen offset:256
    s_mov_b64 exec, 1
    v_mov_b32 v202, s28
    v_mov_b32 v203, s29
    s_cmp_lg_u32 s27, 0
    s_cbranch_scc1 L_slowpub_43
    s_waitcnt vmcnt(0)
    buffer_store_dwordx2 v[202:203], off, s[4:7], s35 offset:1024
L_pubdone_44:
    s_mov_b64 exec, -1
    s_mul_i32 s35, s24, 5120
    s_add_u32 s35, s35, s94
    s_mul_i32 s90, s71, 49152
    s_add_u32 s90, s90, s35
    s_mul_i32 s91, s72, 49152
    s_add_u32 s91, s91, s35
    s_mul_i32 s92, s73, 49152
    s_add_u32 s92, s92, s35
    s_mul_i32 s93, s74, 49152
    s_add_u32 s93, s93, s35
    v_lshrrev_b32 v206, 1, v218
    s_add_u32 s35, s81, 4096
    s_mov_b32 exec_lo, 0xff
    s_mov_b32 exec_hi, 0x0
    s_mov_b32 s65, 262144
L_poll_45:
    buffer_load_dwordx2 v[204:205], v206, s[4:7], s35 offen offset:1024 sc1
    s_sub_u32 s65, s65, 1
    s_cbranch_scc1 L_polled_46
    s_waitcnt vmcnt(0)
    v_cmp_ne_u64 vcc, s[28:29], v[204:205]
    s_cbranch_vccnz L_poll_45
L_polled_46:
    s_mov_b64 exec, -1
    s_cmp_lg_u32 s27, 0
    s_cbranch_scc1 L_slowacq_47
L_acqdone_48:
    s_add_u32 s62, s90, 0
    buffer_load_dwordx4 v[0:3], v218, s[4:7], s62 offen offset:0 sc1
    buffer_load_dwordx4 v[4:7], v218, s[4:7], s62 offen offset:1024 sc1
    buffer_load_dwordx4 v[8:11], v218, s[4:7], s62 offen offset:2048 sc1
    buffer_load_dwordx4 v[12:15], v218, s[4:7], s62 offen offset:3072 sc1
    s_add_u32 s62, s90, 4096
    buffer_load_dwordx4 v[16:19], v218, s[4:7], s62 offen offset:0 sc1
    s_add_u32 s62, s91, 0
    buffer_load_dwordx4 v[20:23], v218, s[4:7], s62 offen offset:0 sc1
    s_waitcnt vmcnt(5)
    v_mfma_f32_16x16x32_bf16 v[164:167], a[0:3], v[0:3], 0
    buffer_load_dwordx4 v[24:27], v218, s[4:7], s62 offen offset:1024 sc1
    v_mfma_f32_16x16x32_bf16 v[168:171], a[4:7], v[0:3], 0
    v_mfma_f32_16x16x32_bf16 v[172:175], a[8:11], v[0:3], 0
    v_mfma_f32_16x16x32_bf16 v[176:179], a[12:15], v[0:3], 0
    v_mfma_f32_16x16x32_bf16 v[180:183], a[16:19], v[0:3], 0
    s_waitcnt vmcnt(5)
    buffer_load_dwordx4 v[28:31], v218, s[4:7], s62 offen offset:2048 sc1
    v_mfma_f32_16x16x32_bf16 v[164:167], a[20:23], v[4:7], v[164:167]
    s_mul_i32 s35, s24, 10240
    s_add_u32 s35, s35, 112640
    v_mfma_f32_16x16x32_bf16 v[168:171], a[24:27], v[4:7], v[168:171]
    v_add_u32 v219, s35, v218
    v_mfma_f32_16x16x32_bf16 v[172:175], a[28:31], v[4:7], v[172:175]
    v_lshlrev_b32 v230, 16, v208
    v_and_b32 v231, 0xffff0000, v208
    v_mfma_f32_16x16x32_bf16 v[176:179], a[32:35], v[4:7], v[176:179]
    buffer_load_dwordx4 v[32:35], v218, s[4:7], s62 offen offset:3072 sc1
    v_mfma_f32_16x16x32_bf16 v[180:183], a[36:39], v[4:7], v[180:183]
    s_waitcnt vmcnt(6)
    v_lshlrev_b32 v232, 16, v209
    v_and_b32 v233, 0xffff0000, v209
    v_mfma_f32_16x16x32_bf16 v[164:167], a[40:43], v[8:11], v[164:167]
    v_lshlrev_b32 v234, 16, v210
    v_mfma_f32_16x16x32_bf16 v[168:171], a[44:47], v[8:11], v[168:171]
    v_and_b32 v235, 0xffff0000, v210
    v_lshlrev_b32 v236, 16, v211
    v_mfma_f32_16x16x32_bf16 v[172:175], a[48:51], v[8:11], v[172:175]
    v_and_b32 v237, 0xffff0000, v211
    v_mfma_f32_16x16x32_bf16 v[176:179], a[52:55], v[8:11], v[176:179]
    s_add_u32 s62, s91, 4096
    buffer_load_dwordx4 v[36:39], v218, s[4:7], s62 offen offset:0 sc1
    v_mfma_f32_16x16x32_bf16 v[180:183], a[56:59], v[8:11], v[180:183]
    s_waitcnt vmcnt(6)
    v_lshlrev_b32 v238, 16, v212
    v_and_b32 v239, 0xffff0000, v212
    v_mfma_f32_16x16x32_bf16 v[164:167], a[60:63], v[12:15], v[164:167]
    v_lshlrev_b32 v240, 16, v213
    v_and_b32 v241, 0xffff0000, v213
    v_mfma_f32_16x16x32_bf16 v[168:171], a[64:67], v[12:15], v[168:171]
    v_lshlrev_b32 v242, 16, v214
    v_mfma_f32_16x16x32_bf16 v[172:175], a[68:71], v[12:15], v[172:175]
    s_add_u32 s62, s92, 0
    buffer_load_dwordx4 v[40:43], v218, s[4:7], s62 offen offset:0 sc1
    v_mfma_f32_16x16x32_bf16 v[176:179], a[72:75], v[12:15], v[176:179]
    v_and_b32 v243, 0xffff0000, v214
    v_lshlrev_b32 v244, 16, v215
    v_mfma_f32_16x16x32_bf16 v[180:183], a[76:79], v[12:15], v[180:183]
    s_waitcnt vmcnt(6)
    s_and_b32 s35, s71, 3
    v_and_b32 v245, 0xffff0000, v215
    v_mfma_f32_16x16x32_bf16 v[164:167], a[80:83], v[16:19], v[164:167]
    v_lshlrev_b32 v246, 16, v216
    s_mul_i32 s35, s35, 10240
    v_mfma_f32_16x16x32_bf16 v[168:171], a[84:87], v[16:19], v[168:171]
    v_and_b32 v247, 0xffff0000, v216
    s_add_u32 s35, s35, 112640
    v_mfma_f32_16x16x32_bf16 v[172:175], a[88:91], v[16:19], v[172:175]
    buffer_load_dwordx4 v[44:47], v218, s[4:7], s62 offen offset:1024 sc1
    v_mfma_f32_16x16x32_bf16 v[176:179], a[92:95], v[16:19], v[176:179]
    v_lshlrev_b32 v248, 16, v217
    v_add_u32 v223, s35, v218
    v_mfma_f32_16x16x32_bf16 v[180:183], a[96:99], v[16:19], v[180:183]
    s_waitcnt vmcnt(6)
    v_and_b32 v249, 0xffff0000, v217
    v_mfma_f32_16x16x32_bf16 v[184:187], a[0:3], v[20:23], 0
    v_mfma_f32_16x16x32_bf16 v[188:191], a[4:7], v[20:23], 0
    buffer_load_dwordx4 v[48:51], v218, s[4:7], s62 offen offset:2048 sc1
    v_mfma_f32_16x16x32_bf16 v[192:195], a[8:11], v[20:23], 0
    ds_write_b128 v223, v[164:167] offset:0
    v_mfma_f32_16x16x32_bf16 v[196:199], a[12:15], v[20:23], 0
    v_mfma_f32_16x16x32_bf16 v[200:203], a[16:19], v[20:23], 0
    s_waitcnt vmcnt(6)
    ds_write_b128 v223, v[168:171] offset:1024
    v_mfma_f32_16x16x32_bf16 v[184:187], a[20:23], v[24:27], v[184:187]
    buffer_load_dwordx4 v[52:55], v218, s[4:7], s62 offen offset:3072 sc1
    v_mfma_f32_16x16x32_bf16 v[188:191], a[24:27], v[24:27], v[188:191]
    v_mfma_f32_16x16x32_bf16 v[192:195], a[28:31], v[24:27], v[192:195]
    ds_write_b128 v223, v[172:175] offset:2048
    v_mfma_f32_16x16x32_bf16 v[196:199], a[32:35], v[24:27], v[196:199]
    v_mfma_f32_16x16x32_bf16 v[200:203], a[36:39], v[24:27], v[200:203]
    s_waitcnt vmcnt(6)
    v_mfma_f32_16x16x32_bf16 v[184:187], a[40:43], v[28:31], v[184:187]
    s_add_u32 s62, s92, 4096
    buffer_load_dwordx4 v[56:59], v218, s[4:7], s62 offen offset:0 sc1
    v_mfma_f32_16x16x32_bf16 v[188:191], a[44:47], v[28:31], v[188:191]
    ds_write_b128 v223, v[176:179] offset:3072
    v_mfma_f32_16x16x32_bf16 v[192:195], a[48:51], v[28:31], v[192:195]
    v_mfma_f32_16x16x32_bf16 v[196:199], a[52:55], v[28:31], v[196:199]
    ds_write_b128 v223, v[180:183] offset:4096
    v_mfma_f32_16x16x32_bf16 v[200:203], a[56:59], v[28:31], v[200:203]
    s_waitcnt vmcnt(6)
    s_add_u32 s62, s93, 0
    v_mfma_f32_16x16x32_bf16 v[184:187], a[60:63], v[32:35], v[184:187]
    buffer_load_dwordx4 v[60:63], v218, s[4:7], s62 offen offset:0 sc1
    v_mfma_f32_16x16x32_bf16 v[188:191], a[64:67], v[32:35], v[188:191]
    v_mfma_f32_16x16x32_bf16 v[192:195], a[68:71], v[32:35], v[192:195]
    v_mfma_f32_16x16x32_bf16 v[196:199], a[72:75], v[32:35], v[196:199]
    buffer_load_dwordx4 v[64:67], v218, s[4:7], s62 offen offset:1024 sc1
    v_mfma_f32_16x16x32_bf16 v[200:203], a[76:79], v[32:35], v[200:203]
    s_waitcnt vmcnt(7)
    s_and_b32 s35, s72, 3
    v_mfma_f32_16x16x32_bf16 v[184:187], a[80:83], v[36:39], v[184:187]
    s_mul_i32 s35, s35, 10240
    v_mfma_f32_16x16x32_bf16 v[188:191], a[84:87], v[36:39], v[188:191]
    s_add_u32 s35, s35, 117760
    v_mfma_f32_16x16x32_bf16 v[192:195], a[88:91], v[36:39], v[192:195]
    v_add_u32 v223, s35, v218
    v_mfma_f32_16x16x32_bf16 v[196:199], a[92:95], v[36:39], v[196:199]
    buffer_load_dwordx4 v[68:71], v218, s[4:7], s62 offen offset:2048 sc1
    v_mfma_f32_16x16x32_bf16 v[200:203], a[96:99], v[36:39], v[200:203]
    s_waitcnt vmcnt(7)
    s_waitcnt lgkmcnt(0)
    s_barrier
    ds_read_b128 v[80:83], v219 offset:0
    v_mfma_f32_16x16x32_bf16 v[164:167], a[0:3], v[40:43], 0
    ds_read_b128 v[84:87], v219 offset:1024
    ds_read_b128 v[88:91], v219 offset:2048
    v_mfma_f32_16x16x32_bf16 v[168:171], a[4:7], v[40:43], 0
    ds_read_b128 v[92:95], v219 offset:3072
    v_mfma_f32_16x16x32_bf16 v[172:175], a[8:11], v[40:43], 0
    buffer_load_dwordx4 v[72:75], v218, s[4:7], s62 offen offset:3072 sc1
    v_mfma_f32_16x16x32_bf16 v[176:179], a[12:15], v[40:43], 0
    ds_write_b128 v223, v[184:187] offset:0
    ds_read_b128 v[96:99], v219 offset:4096
    v_mfma_f32_16x16x32_bf16 v[180:183], a[16:19], v[40:43], 0
    s_waitcnt vmcnt(7)
    ds_write_b128 v223, v[188:191] offset:1024
    v_mfma_f32_16x16x32_bf16 v[164:167], a[20:23], v[44:47], v[164:167]
    v_mfma_f32_16x16x32_bf16 v[168:171], a[24:27], v[44:47], v[168:171]
    v_mfma_f32_16x16x32_bf16 v[172:175], a[28:31], v[44:47], v[172:175]
    s_add_u32 s62, s93, 4096
    buffer_load_dwordx4 v[76:79], v218, s[4:7], s62 offen offset:0 sc1
    v_mfma_f32_16x16x32_bf16 v[176:179], a[32:35], v[44:47], v[176:179]
    ds_write_b128 v223, v[192:195] offset:2048
    v_mfma_f32_16x16x32_bf16 v[180:183], a[36:39], v[44:47], v[180:183]
    s_waitcnt vmcnt(7)
    s_waitcnt lgkmcnt(7)
    v_add_f32 v230, v230, v80
    v_add_f32 v231, v231, v81
    v_mfma_f32_16x16x32_bf16 v[164:167], a[40:43], v[48:51], v[164:167]
    v_add_f32 v232, v232, v82
    v_add_f32 v233, v233, v83
    v_mfma_f32_16x16x32_bf16 v[168:171], a[44:47], v[48:51], v[168:171]
    s_waitcnt lgkmcnt(6)
    v_add_f32 v234, v234, v84
    v_mfma_f32_16x16x32_bf16 v[172:175], a[48:51], v[48:51], v[172:175]
    s_mul_i32 s98, s24, 3072
    ds_write_b128 v223, v[196:199] offset:3072
    v_add_f32 v235, v235, v85
    v_add_f32 v236, v236, v86
    v_mfma_f32_16x16x32_bf16 v[176:179], a[52:55], v[48:51], v[176:179]
    s_min_u32 s98, s98, 7168
    v_add_f32 v237, v237, v87
    s_add_u32 m0, s98, 102400
    v_mfma_f32_16x16x32_bf16 v[180:183], a[56:59], v[48:51], v[180:183]
    s_waitcnt vmcnt(6)
    s_waitcnt lgkmcnt(6)
    v_add_f32 v238, v238, v88
    buffer_load_dword v220, v221, s[16:19], 0 offen sc1
    v_add_f32 v239, v239, v89
    v_mfma_f32_16x16x32_bf16 v[164:167], a[60:63], v[52:55], v[164:167]
    s_add_u32 s98, m0, s83
    ds_write_b128 v223, v[200:203] offset:4096
    buffer_load_dwordx4 v218, s[4:7], s98 offen offset:0 sc1 lds
    v_add_f32 v240, v240, v90
    v_mfma_f32_16x16x32_bf16 v[168:171], a[64:67], v[52:55], v[168:171]
    v_add_f32 v241, v241, v91
    s_waitcnt lgkmcnt(6)
    v_add_f32 v242, v242, v92
    v_mfma_f32_16x16x32_bf16 v[172:175], a[68:71], v[52:55], v[172:175]
    v_add_f32 v243, v243, v93
    v_add_f32 v244, v244, v94
    v_mfma_f32_16x16x32_bf16 v[176:179], a[72:75], v[52:55], v[176:179]
    v_add_f32 v245, v245, v95
    v_mfma_f32_16x16x32_bf16 v[180:183], a[76:79], v[52:55], v[180:183]
    s_waitcnt vmcnt(7)
    s_waitcnt lgkmcnt(4)
    v_add_f32 v246, v246, v96
    v_mfma_f32_16x16x32_bf16 v[164:167], a[80:83], v[56:59], v[164:167]
    v_add_f32 v247, v247, v97
    buffer_load_dwordx4 v218, s[4:7], s98 offen offset:1024 sc1 lds
    v_add_f32 v248, v248, v98
    v_mfma_f32_16x16x32_bf16 v[168:171], a[84:87], v[56:59], v[168:171]
    s_and_b32 s35, s73, 3
    v_add_f32 v249, v249, v99
    s_mul_i32 s35, s35, 10240
    v_mfma_f32_16x16x32_bf16 v[172:175], a[88:91], v[56:59], v[172:175]
    s_add_u32 s35, s35, 112640
    v_add_u32 v223, s35, v218
    v_mfma_f32_16x16x32_bf16 v[176:179], a[92:95], v[56:59], v[176:179]
    buffer_load_dwordx4 v218, s[4:7], s98 offen offset:2048 sc1 lds
    v_mfma_f32_16x16x32_bf16 v[180:183], a[96:99], v[56:59], v[180:183]
    s_waitcnt vmcnt(8)
    s_waitcnt lgkmcnt(0)
    s_barrier
    ds_read_b128 v[100:103], v219 offset:5120
    v_mfma_f32_16x16x32_bf16 v[230:233], a[0:3], v[60:63], v[230:233]
    ds_read_b128 v[104:107], v219 offset:6144
    ds_read_b128 v[108:111], v219 offset:7168
    v_mfma_f32_16x16x32_bf16 v[234:237], a[4:7], v[60:63], v[234:237]
    ds_read_b128 v[112:115], v219 offset:8192
    v_mfma_f32_16x16x32_bf16 v[238:241], a[8:11], v[60:63], v[238:241]
    ds_write_b128 v223, v[164:167] offset:0
    v_mfma_f32_16x16x32_bf16 v[242:245], a[12:15], v[60:63], v[242:245]
    ds_read_b128 v[116:119], v219 offset:9216
    v_mfma_f32_16x16x32_bf16 v[246:249], a[16:19], v[60:63], v[246:249]
    s_waitcnt vmcnt(7)
    ds_write_b128 v223, v[168:171] offset:1024
    v_mfma_f32_16x16x32_bf16 v[230:233], a[20:23], v[64:67], v[230:233]
    v_mfma_f32_16x16x32_bf16 v[234:237], a[24:27], v[64:67], v[234:237]
    v_mfma_f32_16x16x32_bf16 v[238:241], a[28:31], v[64:67], v[238:241]
    ds_write_b128 v223, v[172:175] offset:2048
    v_mfma_f32_16x16x32_bf16 v[242:245], a[32:35], v[64:67], v[242:245]
    v_mfma_f32_16x16x32_bf16 v[246:249], a[36:39], v[64:67], v[246:249]
    s_waitcnt vmcnt(6)
    v_mfma_f32_16x16x32_bf16 v[230:233], a[40:43], v[68:71], v[230:233]
    ds_write_b128 v223, v[176:179] offset:3072
    v_mfma_f32_16x16x32_bf16 v[234:237], a[44:47], v[68:71], v[234:237]
    v_mfma_f32_16x16x32_bf16 v[238:241], a[48:51], v[68:71], v[238:241]
    v_mfma_f32_16x16x32_bf16 v[242:245], a[52:55], v[68:71], v[242:245]
    ds_write_b128 v223, v[180:183] offset:4096
    v_mfma_f32_16x16x32_bf16 v[246:249], a[56:59], v[68:71], v[246:249]
    s_waitcnt vmcnt(5)
    v_mfma_f32_16x16x32_bf16 v[230:233], a[60:63], v[72:75], v[230:233]
    v_mfma_f32_16x16x32_bf16 v[234:237], a[64:67], v[72:75], v[234:237]
    s_waitcnt lgkmcnt(0)
    s_barrier
    ds_read_b128 v[120:123], v219 offset:0
    v_mfma_f32_16x16x32_bf16 v[238:241], a[68:71], v[72:75], v[238:241]
    ds_read_b128 v[124:127], v219 offset:1024
    ds_read_b128 v[128:131], v219 offset:2048
    v_mfma_f32_16x16x32_bf16 v[242:245], a[72:75], v[72:75], v[242:245]
    ds_read_b128 v[132:135], v219 offset:3072
    ds_read_b128 v[136:139], v219 offset:4096
    v_mfma_f32_16x16x32_bf16 v[246:249], a[76:79], v[72:75], v[246:249]
    s_waitcnt vmcnt(4)
    ds_read_b32 v223, v224 offset:3080
    v_mfma_f32_16x16x32_bf16 v[230:233], a[80:83], v[76:79], v[230:233]
    v_mfma_f32_16x16x32_bf16 v[234:237], a[84:87], v[76:79], v[234:237]
    v_mfma_f32_16x16x32_bf16 v[238:241], a[88:91], v[76:79], v[238:241]
    v_mfma_f32_16x16x32_bf16 v[242:245], a[92:95], v[76:79], v[242:245]
    v_mfma_f32_16x16x32_bf16 v[246:249], a[96:99], v[76:79], v[246:249]
    s_waitcnt lgkmcnt(5)
    v_pk_add_f32 v[100:101], v[100:101], v[120:121]
    v_pk_add_f32 v[102:103], v[102:103], v[122:123]
    s_waitcnt lgkmcnt(4)
    v_pk_add_f32 v[104:105], v[104:105], v[124:125]
    v_pk_add_f32 v[106:107], v[106:107], v[126:127]
    s_waitcnt lgkmcnt(3)
    v_pk_add_f32 v[108:109], v[108:109], v[128:129]
    v_pk_add_f32 v[110:111], v[110:111], v[130:131]
    s_waitcnt lgkmcnt(2)
    v_pk_add_f32 v[112:113], v[112:113], v[132:133]
    v_pk_add_f32 v[114:115], v[114:115], v[134:135]
    s_waitcnt lgkmcnt(1)
    v_pk_add_f32 v[116:117], v[116:117], v[136:137]
    v_pk_add_f32 v[118:119], v[118:119], v[138:139]
    v_pk_add_f32 v[230:231], v[230:231], v[100:101]
    v_cvt_pk_bf16_f32 v208, v230, v231
    v_pk_add_f32 v[232:233], v[232:233], v[102:103]
    v_cvt_pk_bf16_f32 v209, v232, v233
    v_pk_add_f32 v[234:235], v[234:235], v[104:105]
    v_cvt_pk_bf16_f32 v210, v234, v235
    v_pk_add_f32 v[236:237], v[236:237], v[106:107]
    v_cvt_pk_bf16_f32 v211, v236, v237
    buffer_store_dwordx4 v[208:211], v218, s[4:7], s75 offen
    v_pk_add_f32 v[238:239], v[238:239], v[108:109]
    v_cvt_pk_bf16_f32 v212, v238, v239
    v_pk_add_f32 v[240:241], v[240:241], v[110:111]
    v_cvt_pk_bf16_f32 v213, v240, v241
    v_pk_add_f32 v[242:243], v[242:243], v[112:113]
    v_cvt_pk_bf16_f32 v214, v242, v243
    v_pk_add_f32 v[244:245], v[244:245], v[114:115]
    v_cvt_pk_bf16_f32 v215, v244, v245
    buffer_store_dwordx4 v[212:215], v218, s[4:7], s75 offen offset:1024
    v_pk_add_f32 v[246:247], v[246:247], v[116:117]
    v_cvt_pk_bf16_f32 v216, v246, v247
    v_pk_add_f32 v[248:249], v[248:249], v[118:119]
    v_cvt_pk_bf16_f32 v217, v248, v249
    s_waitcnt lgkmcnt(0)
    buffer_store_dwordx2 v[216:217], v223, s[4:7], s76 offen
    s_mov_b32 s60, 0x3f803f80
    v_dot2_f32_bf16 v204, v208, s60, 0
    v_dot2_f32_bf16 v205, v208, v208, 0
    v_dot2_f32_bf16 v206, v209, s60, 0
    v_dot2_f32_bf16 v207, v209, v209, 0
    v_dot2c_f32_bf16 v204, s60, v210
    v_dot2c_f32_bf16 v205, v210, v210
    v_dot2c_f32_bf16 v206, s60, v211
    v_dot2c_f32_bf16 v207, v211, v211
    v_dot2c_f32_bf16 v204, s60, v212
    v_dot2c_f32_bf16 v205, v212, v212
    v_dot2c_f32_bf16 v206, s60, v213
    v_dot2c_f32_bf16 v207, v213, v213
    v_dot2c_f32_bf16 v204, s60, v214
    v_dot2c_f32_bf16 v205, v214, v214
    v_dot2c_f32_bf16 v206, s60, v215
    v_dot2c_f32_bf16 v207, v215, v215
    v_dot2c_f32_bf16 v204, s60, v216
    v_dot2c_f32_bf16 v205, v216, v216
    v_dot2c_f32_bf16 v206, s60, v217
    v_dot2c_f32_bf16 v207, v217, v217
    s_add_u32 s35, s78, 4096
    s_nop 1
    v_pk_add_f32 v[204:205], v[204:205], v[206:207]
    v_mov_b32 v206, v204
    v_mov_b32 v207, v205
    s_nop 0
    v_permlane16_swap_b32 v204, v206
    v_permlane16_swap_b32 v205, v207
    v_add_f32 v204, v204, v206
    v_add_f32 v205, v205, v207
    v_mov_b32 v206, v204
    v_mov_b32 v207, v205
    s_nop 0
    v_permlane32_swap_b32 v204, v206
    v_permlane32_swap_b32 v205, v207
    v_add_f32 v204, v204, v206
    v_add_f32 v205, v205, v207
    s_mov_b64 exec, 0xffff
    buffer_store_dwordx2 v[204:205], v218, s[4:7], s77 offen
    s_mov_b64 exec, 1
    v_mov_b32 v206, s28
    v_mov_b32 v207, s29
    s_cmp_lg_u32 s27, 0
    s_cbranch_scc1 L_slowpub_49
    s_waitcnt vmcnt(0)
    buffer_store_dwordx2 v[206:207], off, s[4:7], s35 offset:2048
L_pubdone_50:
    s_mov_b64 exec, -1
    s_barrier
    s_mul_i32 s98, s24, 3072
    s_min_u32 s98, s98, 7168
    s_add_u32 m0, s98, 112640
    s_add_u32 s98, m0, s83
    buffer_load_dwordx4 v218, s[4:7], s98 offen offset:0 sc1 lds
    buffer_load_dwordx4 v218, s[4:7], s98 offen offset:1024 sc1 lds
    buffer_load_dwordx4 v218, s[4:7], s98 offen offset:2048 sc1 lds
    v_lshrrev_b32 v232, 1, v218
    s_add_u32 s35, s79, 4096
    s_mov_b32 exec_lo, 0xffff
    s_mov_b32 exec_hi, 0x0
    s_mov_b32 s65, 262144
L_poll_51:
    buffer_load_dwordx2 v[230:231], v232, s[4:7], s35 offen offset:2048 sc1
    s_sub_u32 s65, s65, 1
    s_cbranch_scc1 L_polled_52
    s_waitcnt vmcnt(0)
    v_cmp_ne_u64 vcc, s[28:29], v[230:231]
    s_cbranch_vccnz L_poll_51
L_polled_52:
    s_mov_b64 exec, -1
    s_cmp_lg_u32 s27, 0
    s_cbranch_scc1 L_slowacq_53
L_acqdone_54:
    s_add_u32 s62, s66, 0
    buffer_load_dwordx4 v[0:3], v218, s[4:7], s62 offen offset:0 sc1
    s_add_u32 s63, s66, 20480
    buffer_load_dwordx4 v[4:7], v218, s[4:7], s63 offen offset:0 sc1
    buffer_load_dwordx4 v[8:11], v218, s[4:7], s62 offen offset:1024 sc1
    buffer_load_dwordx4 v[12:15], v218, s[4:7], s63 offen offset:1024 sc1
    buffer_load_dwordx4 v[16:19], v218, s[4:7], s62 offen offset:2048 sc1
    buffer_load_dwordx4 v[20:23], v218, s[4:7], s63 offen offset:2048 sc1
    buffer_load_dwordx4 v[230:233], v218, s[4:7], s67 offen sc1
    buffer_load_dwordx4 v[234:237], v218, s[4:7], s67 offen offset:1024 sc1
    v_add_u32 v223, 0x10000, v218
    s_barrier
    s_add_u32 s60, s70, 49152
    ds_read_b128 a[240:243], v218 offset:0
    ds_read_b128 a[244:247], v218 offset:1024
    ds_read_b128 a[248:251], v218 offset:2048
    ds_read_b128 a[252:255], v218 offset:3072
    s_waitcnt vmcnt(7) lgkmcnt(3)
    buffer_load_dwordx4 v[24:27], v218, s[4:7], s62 offen offset:3072 sc1
    v_mfma_f32_16x16x32_bf16 v[160:163], a[240:243], v[0:3], 0
    s_waitcnt vmcnt(7)
    ds_read_b128 v[240:243], v218 offset:4096
    v_mfma_f32_16x16x32_bf16 v[164:167], a[240:243], v[4:7], 0
    s_waitcnt lgkmcnt(3)
    v_mfma_f32_16x16x32_bf16 v[168:171], a[244:247], v[0:3], 0
    ds_read_b128 v[244:247], v218 offset:5120
    v_mfma_f32_16x16x32_bf16 v[172:175], a[244:247], v[4:7], 0
    s_waitcnt lgkmcnt(3)
    buffer_load_dwordx4 v[28:31], v218, s[4:7], s63 offen offset:3072 sc1
    v_mfma_f32_16x16x32_bf16 v[176:179], a[248:251], v[0:3], 0
    ds_read_b128 a[240:243], v218 offset:6144
    v_mfma_f32_16x16x32_bf16 v[180:183], a[248:251], v[4:7], 0
    s_waitcnt lgkmcnt(3)
    v_mfma_f32_16x16x32_bf16 v[184:187], a[252:255], v[0:3], 0
    ds_read_b128 a[244:247], v218 offset:7168
    v_mfma_f32_16x16x32_bf16 v[188:191], a[252:255], v[4:7], 0
    s_waitcnt lgkmcnt(3)
    s_add_u32 s62, s66, 4096
    v_mfma_f32_16x16x32_bf16 v[192:195], v[240:243], v[0:3], 0
    ds_read_b128 a[248:251], v218 offset:8192
    v_mfma_f32_16x16x32_bf16 v[196:199], v[240:243], v[4:7], 0
    s_waitcnt lgkmcnt(3)
    buffer_load_dwordx4 v[32:35], v218, s[4:7], s62 offen offset:0 sc1
    v_mfma_f32_16x16x32_bf16 v[200:203], v[244:247], v[0:3], 0
    ds_read_b128 a[252:255], v218 offset:9216
    v_mfma_f32_16x16x32_bf16 v[204:207], v[244:247], v[4:7], 0
    s_waitcnt vmcnt(8) lgkmcnt(3)
    v_mfma_f32_16x16x32_bf16 v[160:163], a[240:243], v[8:11], v[160:163]
    s_waitcnt vmcnt(7)
    ds_read_b128 v[240:243], v218 offset:10240
    s_add_u32 s63, s66, 24576
    v_mfma_f32_16x16x32_bf16 v[164:167], a[240:243], v[12:15], v[164:167]
    s_waitcnt lgkmcnt(3)
    buffer_load_dwordx4 v[36:39], v218, s[4:7], s63 offen offset:0 sc1
    v_mfma_f32_16x16x32_bf16 v[168:171], a[244:247], v[8:11], v[168:171]
    ds_read_b128 v[244:247], v218 offset:11264
    v_mfma_f32_16x16x32_bf16 v[172:175], a[244:247], v[12:15], v[172:175]
    s_waitcnt lgkmcnt(3)
    v_mfma_f32_16x16x32_bf16 v[176:179], a[248:251], v[8:11], v[176:179]
    ds_read_b128 a[240:243], v218 offset:12288
    v_mfma_f32_16x16x32_bf16 v[180:183], a[248:251], v[12:15], v[180:183]
    s_waitcnt lgkmcnt(3)
    buffer_load_dwordx4 v[40:43], v218, s[4:7], s62 offen offset:1024 sc1
    v_mfma_f32_16x16x32_bf16 v[184:187], a[252:255], v[8:11], v[184:187]
    ds_read_b128 a[244:247], v218 offset:13312
    v_mfma_f32_16x16x32_bf16 v[188:191], a[252:255], v[12:15], v[188:191]
    s_waitcnt lgkmcnt(3)
    v_mfma_f32_16x16x32_bf16 v[192:195], v[240:243], v[8:11], v[192:195]
    ds_read_b128 a[248:251], v218 offset:14336
    v_mfma_f32_16x16x32_bf16 v[196:199], v[240:243], v[12:15], v[196:199]
    s_waitcnt lgkmcnt(3)
    buffer_load_dwordx4 v[44:47], v218, s[4:7], s63 offen offset:1024 sc1
    v_mfma_f32_16x16x32_bf16 v[200:203], v[244:247], v[8:11], v[200:203]
    ds_read_b128 a[252:255], v218 offset:15360
    v_mfma_f32_16x16x32_bf16 v[204:207], v[244:247], v[12:15], v[204:207]
    s_waitcnt vmcnt(9) lgkmcnt(3)
    v_mfma_f32_16x16x32_bf16 v[160:163], a[240:243], v[16:19], v[160:163]
    s_waitcnt vmcnt(8)
    ds_read_b128 v[240:243], v218 offset:16384
    v_mfma_f32_16x16x32_bf16 v[164:167], a[240:243], v[20:23], v[164:167]
    s_waitcnt lgkmcnt(3)
    buffer_load_dwordx4 v[48:51], v218, s[4:7], s62 offen offset:2048 sc1
    v_mfma_f32_16x16x32_bf16 v[168:171], a[244:247], v[16:19], v[168:171]
    ds_read_b128 v[244:247], v218 offset:17408
    v_mfma_f32_16x16x32_bf16 v[172:175], a[244:247], v[20:23], v[172:175]
    s_waitcnt lgkmcnt(3)
    v_mfma_f32_16x16x32_bf16 v[176:179], a[248:251], v[16:19], v[176:179]
    ds_read_b128 a[240:243], v218 offset:18432
    v_mfma_f32_16x16x32_bf16 v[180:183], a[248:251], v[20:23], v[180:183]
    s_waitcnt lgkmcnt(3)
    buffer_load_dwordx4 v[52:55], v218, s[4:7], s63 offen offset:2048 sc1
    v_mfma_f32_16x16x32_bf16 v[184:187], a[252:255], v[16:19], v[184:187]
    s_waitcnt vmcnt(9)
    v_add_f32 v226, v230, v232
    ds_read_b128 a[244:247], v218 offset:19456
    v_mfma_f32_16x16x32_bf16 v[188:191], a[252:255], v[20:23], v[188:191]
    s_waitcnt lgkmcnt(3)
    v_add_f32 v228, v231, v233
    v_mfma_f32_16x16x32_bf16 v[192:195], v[240:243], v[16:19], v[192:195]
    ds_read_b128 a[248:251], v218 offset:20480
    v_mfma_f32_16x16x32_bf16 v[196:199], v[240:243], v[20:23], v[196:199]
    s_waitcnt lgkmcnt(3)
    s_waitcnt vmcnt(8)
    v_add_f32 v227, v234, v236
    v_mfma_f32_16x16x32_bf16 v[200:203], v[244:247], v[16:19], v[200:203]
    ds_read_b128 a[252:255], v218 offset:21504
    v_mfma_f32_16x16x32_bf16 v[204:207], v[244:247], v[20:23], v[204:207]
    s_waitcnt vmcnt(7) lgkmcnt(3)
    buffer_load_dwordx4 v[56:59], v218, s[4:7], s62 offen offset:3072 sc1
    v_mfma_f32_16x16x32_bf16 v[160:163], a[240:243], v[24:27], v[160:163]
    s_waitcnt vmcnt(7)
    ds_read_b128 v[240:243], v218 offset:22528
    v_add_f32 v229, v235, v237
    v_mfma_f32_16x16x32_bf16 v[164:167], a[240:243], v[28:31], v[164:167]
    s_waitcnt lgkmcnt(3)
    v_mov_b32 v230, v226
    v_mfma_f32_16x16x32_bf16 v[168:171], a[244:247], v[24:27], v[168:171]
    ds_read_b128 v[244:247], v218 offset:23552
    v_mfma_f32_16x16x32_bf16 v[172:175], a[244:247], v[28:31], v[172:175]
    s_waitcnt lgkmcnt(3)
    buffer_load_dwordx4 v[60:63], v218, s[4:7], s63 offen offset:3072 sc1
    v_mfma_f32_16x16x32_bf16 v[176:179], a[248:251], v[24:27], v[176:179]
    ds_read_b128 a[240:243], v218 offset:24576
    v_mov_b32 v231, v227
    v_mfma_f32_16x16x32_bf16 v[180:183], a[248:251], v[28:31], v[180:183]
    s_waitcnt lgkmcnt(3)
    v_mov_b32 v232, v228
    v_mfma_f32_16x16x32_bf16 v[184:187], a[252:255], v[24:27], v[184:187]
    s_add_u32 s62, s66, 8192
    ds_read_b128 a[244:247], v218 offset:25600
    v_mfma_f32_16x16x32_bf16 v[188:191], a[252:255], v[28:31], v[188:191]
    s_waitcnt lgkmcnt(3)
    buffer_load_dwordx4 v[64:67], v218, s[4:7], s62 offen offset:0 sc1
    v_mfma_f32_16x16x32_bf16 v[192:195], v[240:243], v[24:27], v[192:195]
    ds_read_b128 a[248:251], v218 offset:26624
    v_mov_b32 v233, v229
    v_mfma_f32_16x16x32_bf16 v[196:199], v[240:243], v[28:31], v[196:199]
    s_waitcnt lgkmcnt(3)
    v_permlane16_swap_b32 v226, v230
    v_mfma_f32_16x16x32_bf16 v[200:203], v[244:247], v[24:27], v[200:203]
    ds_read_b128 a[252:255], v218 offset:27648
    v_mfma_f32_16x16x32_bf16 v[204:207], v[244:247], v[28:31], v[204:207]
    s_waitcnt vmcnt(8) lgkmcnt(3)
    s_add_u32 s63, s66, 28672
    v_mfma_f32_16x16x32_bf16 v[160:163], a[240:243], v[32:35], v[160:163]
    s_waitcnt vmcnt(7)
    ds_read_b128 v[240:243], v218 offset:28672
    v_mfma_f32_16x16x32_bf16 v[164:167], a[240:243], v[36:39], v[164:167]
    s_waitcnt lgkmcnt(3)
    buffer_load_dwordx4 v[68:71], v218, s[4:7], s63 offen offset:0 sc1
    v_mfma_f32_16x16x32_bf16 v[168:171], a[244:247], v[32:35], v[168:171]
    ds_read_b128 v[244:247], v218 offset:29696
    v_permlane16_swap_b32 v227, v231
    v_mfma_f32_16x16x32_bf16 v[172:175], a[244:247], v[36:39], v[172:175]
    s_waitcnt lgkmcnt(3)
    buffer_load_dwordx4 v[72:75], v218, s[4:7], s62 offen offset:1024 sc1
    v_mfma_f32_16x16x32_bf16 v[176:179], a[248:251], v[32:35], v[176:179]
    ds_read_b128 a[240:243], v218 offset:30720
    v_permlane16_swap_b32 v228, v232
    v_mfma_f32_16x16x32_bf16 v[180:183], a[248:251], v[36:39], v[180:183]
    s_waitcnt lgkmcnt(3)
    v_permlane16_swap_b32 v229, v233
    v_mfma_f32_16x16x32_bf16 v[184:187], a[252:255], v[32:35], v[184:187]
    ds_read_b128 a[244:247], v218 offset:31744
    v_add_f32 v226, v226, v230
    v_mfma_f32_16x16x32_bf16 v[188:191], a[252:255], v[36:39], v[188:191]
    s_waitcnt lgkmcnt(3)
    v_add_f32 v227, v227, v231
    v_mfma_f32_16x16x32_bf16 v[192:195], v[240:243], v[32:35], v[192:195]
    ds_read_b128 a[248:251], v218 offset:32768
    v_mfma_f32_16x16x32_bf16 v[196:199], v[240:243], v[36:39], v[196:199]
    s_waitcnt lgkmcnt(3)
    buffer_load_dwordx4 v[76:79], v218, s[4:7], s63 offen offset:1024 sc1
    v_mfma_f32_16x16x32_bf16 v[200:203], v[244:247], v[32:35], v[200:203]
    ds_read_b128 a[252:255], v218 offset:33792
    v_add_f32 v228, v228, v232
    v_mfma_f32_16x16x32_bf16 v[204:207], v[244:247], v[36:39], v[204:207]
    s_waitcnt vmcnt(9) lgkmcnt(3)
    v_add_f32 v229, v229, v233
    v_mfma_f32_16x16x32_bf16 v[160:163], a[240:243], v[40:43], v[160:163]
    s_waitcnt vmcnt(8)
    ds_read_b128 v[240:243], v218 offset:34816
    v_mfma_f32_16x16x32_bf16 v[164:167], a[240:243], v[44:47], v[164:167]
    s_waitcnt lgkmcnt(3)
    buffer_load_dwordx4 v[80:83], v218, s[4:7], s62 offen offset:2048 sc1
    v_mfma_f32_16x16x32_bf16 v[168:171], a[244:247], v[40:43], v[168:171]
    ds_read_b128 v[244:247], v218 offset:35840
    v_mov_b32 v230, v226
    v_mfma_f32_16x16x32_bf16 v[172:175], a[244:247], v[44:47], v[172:175]
    s_waitcnt lgkmcnt(3)
    v_mov_b32 v231, v227
    v_mfma_f32_16x16x32_bf16 v[176:179], a[248:251], v[40:43], v[176:179]
    ds_read_b128 a[240:243], v218 offset:36864
    v_mfma_f32_16x16x32_bf16 v[180:183], a[248:251], v[44:47], v[180:183]
    s_waitcnt lgkmcnt(3)
    buffer_load_dwordx4 v[84:87], v218, s[4:7], s63 offen offset:2048 sc1
    v_mfma_f32_16x16x32_bf16 v[184:187], a[252:255], v[40:43], v[184:187]
    ds_read_b128 a[244:247], v218 offset:37888
    v_mov_b32 v232, v228
    v_mfma_f32_16x16x32_bf16 v[188:191], a[252:255], v[44:47], v[188:191]
    s_waitcnt lgkmcnt(3)
    v_mov_b32 v233, v229
    v_mfma_f32_16x16x32_bf16 v[192:195], v[240:243], v[40:43], v[192:195]
    ds_read_b128 a[248:251], v218 offset:38912
    v_mfma_f32_16x16x32_bf16 v[196:199], v[240:243], v[44:47], v[196:199]
    s_waitcnt lgkmcnt(3)
    buffer_load_dwordx4 v[88:91], v218, s[4:7], s62 offen offset:3072 sc1
    v_mfma_f32_16x16x32_bf16 v[200:203], v[244:247], v[40:43], v[200:203]
    ds_read_b128 a[252:255], v218 offset:39936
    v_mfma_f32_16x16x32_bf16 v[204:207], v[244:247], v[44:47], v[204:207]
    s_waitcnt vmcnt(10) lgkmcnt(3)
    v_permlane32_swap_b32 v226, v230
    v_mfma_f32_16x16x32_bf16 v[160:163], a[240:243], v[48:51], v[160:163]
    s_waitcnt vmcnt(9)
    ds_read_b128 v[240:243], v218 offset:40960
    v_mfma_f32_16x16x32_bf16 v[164:167], a[240:243], v[52:55], v[164:167]
    s_waitcnt lgkmcnt(3)
    buffer_load_dwordx4 v[92:95], v218, s[4:7], s63 offen offset:3072 sc1
    v_mfma_f32_16x16x32_bf16 v[168:171], a[244:247], v[48:51], v[168:171]
    ds_read_b128 v[244:247], v218 offset:41984
    v_permlane32_swap_b32 v227, v231
    v_mfma_f32_16x16x32_bf16 v[172:175], a[244:247], v[52:55], v[172:175]
    s_waitcnt lgkmcnt(3)
    v_permlane32_swap_b32 v228, v232
    v_mfma_f32_16x16x32_bf16 v[176:179], a[248:251], v[48:51], v[176:179]
    ds_read_b128 a[240:243], v218 offset:43008
    v_mfma_f32_16x16x32_bf16 v[180:183], a[248:251], v[52:55], v[180:183]
    s_waitcnt lgkmcnt(3)
    v_permlane32_swap_b32 v229, v233
    v_mfma_f32_16x16x32_bf16 v[184:187], a[252:255], v[48:51], v[184:187]
    s_add_u32 s62, s66, 12288
    ds_read_b128 a[244:247], v218 offset:44032
    v_add_f32 v226, v226, v230
    v_mfma_f32_16x16x32_bf16 v[188:191], a[252:255], v[52:55], v[188:191]
    s_waitcnt lgkmcnt(3)
    buffer_load_dwordx4 v[96:99], v218, s[4:7], s62 offen offset:0 sc1
    v_mfma_f32_16x16x32_bf16 v[192:195], v[240:243], v[48:51], v[192:195]
    ds_read_b128 a[248:251], v218 offset:45056
    v_add_f32 v227, v227, v231
    v_mfma_f32_16x16x32_bf16 v[196:199], v[240:243], v[52:55], v[196:199]
    s_waitcnt lgkmcnt(3)
    v_add_f32 v228, v228, v232
    v_mfma_f32_16x16x32_bf16 v[200:203], v[244:247], v[48:51], v[200:203]
    s_add_u32 s63, s66, 32768
    ds_read_b128 a[252:255], v218 offset:46080
    v_mfma_f32_16x16x32_bf16 v[204:207], v[244:247], v[52:55], v[204:207]
    s_waitcnt vmcnt(10) lgkmcnt(3)
    buffer_load_dwordx4 v[100:103], v218, s[4:7], s63 offen offset:0 sc1
    v_mfma_f32_16x16x32_bf16 v[160:163], a[240:243], v[56:59], v[160:163]
    s_waitcnt vmcnt(10)
    ds_read_b128 v[240:243], v218 offset:47104
    v_add_f32 v229, v229, v233
    v_mfma_f32_16x16x32_bf16 v[164:167], a[240:243], v[60:63], v[164:167]
    s_waitcnt lgkmcnt(3)
    v_mul_f32 v226, 0xbacccccd, v226
    v_mfma_f32_16x16x32_bf16 v[168:171], a[244:247], v[56:59], v[168:171]
    ds_read_b128 v[244:247], v218 offset:48128
    v_mfma_f32_16x16x32_bf16 v[172:175], a[244:247], v[60:63], v[172:175]
    s_waitcnt lgkmcnt(3)
    buffer_load_dwordx4 v[104:107], v218, s[4:7], s62 offen offset:1024 sc1
    v_mfma_f32_16x16x32_bf16 v[176:179], a[248:251], v[56:59], v[176:179]
    ds_read_b128 a[240:243], v218 offset:49152
    v_mul_f32 v228, 0x3acccccd, v228
    v_mfma_f32_16x16x32_bf16 v[180:183], a[248:251], v[60:63], v[180:183]
    s_waitcnt lgkmcnt(3)
    v_mul_f32 v227, 0xbacccccd, v227
    v_mfma_f32_16x16x32_bf16 v[184:187], a[252:255], v[56:59], v[184:187]
    ds_read_b128 a[244:247], v218 offset:50176
    v_mfma_f32_16x16x32_bf16 v[188:191], a[252:255], v[60:63], v[188:191]
    s_waitcnt lgkmcnt(3)
    buffer_load_dwordx4 v[108:111], v218, s[4:7], s63 offen offset:1024 sc1
    v_mfma_f32_16x16x32_bf16 v[192:195], v[240:243], v[56:59], v[192:195]
    ds_read_b128 a[248:251], v218 offset:51200
    v_mul_f32 v229, 0x3acccccd, v229
    v_mfma_f32_16x16x32_bf16 v[196:199], v[240:243], v[60:63], v[196:199]
    s_waitcnt lgkmcnt(3)
    v_fma_f32 v228, -v226, v226, v228
    v_mfma_f32_16x16x32_bf16 v[200:203], v[244:247], v[56:59], v[200:203]
    ds_read_b128 a[252:255], v218 offset:52224
    v_mfma_f32_16x16x32_bf16 v[204:207], v[244:247], v[60:63], v[204:207]
    s_waitcnt vmcnt(11) lgkmcnt(3)
    buffer_load_dwordx4 v[112:115], v218, s[4:7], s62 offen offset:2048 sc1
    v_mfma_f32_16x16x32_bf16 v[160:163], a[240:243], v[64:67], v[160:163]
    s_waitcnt vmcnt(11)
    ds_read_b128 v[240:243], v218 offset:53248
    v_fma_f32 v229, -v227, v227, v229
    v_mfma_f32_16x16x32_bf16 v[164:167], a[240:243], v[68:71], v[164:167]
    s_waitcnt lgkmcnt(3)
    v_max_f32 v228, 0, v228
    v_mfma_f32_16x16x32_bf16 v[168:171], a[244:247], v[64:67], v[168:171]
    ds_read_b128 v[244:247], v218 offset:54272
    v_mfma_f32_16x16x32_bf16 v[172:175], a[244:247], v[68:71], v[172:175]
    s_waitcnt lgkmcnt(3)
    v_max_f32 v229, 0, v229
    v_mfma_f32_16x16x32_bf16 v[176:179], a[248:251], v[64:67], v[176:179]
    ds_read_b128 a[240:243], v218 offset:55296
    v_mfma_f32_16x16x32_bf16 v[180:183], a[248:251], v[68:71], v[180:183]
    s_waitcnt lgkmcnt(3)
    buffer_load_dwordx4 v[116:119], v218, s[4:7], s63 offen offset:2048 sc1
    v_mfma_f32_16x16x32_bf16 v[184:187], a[252:255], v[64:67], v[184:187]
    ds_read_b128 a[244:247], v218 offset:56320
    v_add_f32 v228, 0x3727c5ac, v228
    v_mfma_f32_16x16x32_bf16 v[188:191], a[252:255], v[68:71], v[188:191]
    s_waitcnt lgkmcnt(3)
    v_add_f32 v229, 0x3727c5ac, v229
    v_mfma_f32_16x16x32_bf16 v[192:195], v[240:243], v[64:67], v[192:195]
    ds_read_b128 a[248:251], v218 offset:57344
    v_mfma_f32_16x16x32_bf16 v[196:199], v[240:243], v[68:71], v[196:199]
    s_waitcnt lgkmcnt(3)
    buffer_load_dwordx4 v[120:123], v218, s[4:7], s62 offen offset:3072 sc1
    v_mfma_f32_16x16x32_bf16 v[200:203], v[244:247], v[64:67], v[200:203]
    ds_read_b128 a[252:255], v218 offset:58368
    v_mfma_f32_16x16x32_bf16 v[204:207], v[244:247], v[68:71], v[204:207]
    s_waitcnt vmcnt(12) lgkmcnt(3)
    v_rsq_f32 v228, v228
    v_mfma_f32_16x16x32_bf16 v[160:163], a[240:243], v[72:75], v[160:163]
    s_waitcnt vmcnt(11)
    ds_read_b128 v[240:243], v218 offset:59392
    v_mfma_f32_16x16x32_bf16 v[164:167], a[240:243], v[76:79], v[164:167]
    s_waitcnt lgkmcnt(3)
    buffer_load_dwordx4 v[124:127], v218, s[4:7], s63 offen offset:3072 sc1
    v_mfma_f32_16x16x32_bf16 v[168:171], a[244:247], v[72:75], v[168:171]
    ds_read_b128 v[244:247], v218 offset:60416
    v_rsq_f32 v229, v229
    v_mfma_f32_16x16x32_bf16 v[172:175], a[244:247], v[76:79], v[172:175]
    s_waitcnt lgkmcnt(3)
    v_mfma_f32_16x16x32_bf16 v[176:179], a[248:251], v[72:75], v[176:179]
    ds_read_b128 a[240:243], v218 offset:61440
    v_mfma_f32_16x16x32_bf16 v[180:183], a[248:251], v[76:79], v[180:183]
    s_waitcnt lgkmcnt(3)
    s_add_u32 s62, s66, 16384
    v_mfma_f32_16x16x32_bf16 v[184:187], a[252:255], v[72:75], v[184:187]
    ds_read_b128 a[244:247], v218 offset:62464
    v_mfma_f32_16x16x32_bf16 v[188:191], a[252:255], v[76:79], v[188:191]
    s_waitcnt lgkmcnt(3)
    buffer_load_dwordx4 v[128:131], v218, s[4:7], s62 offen offset:0 sc1
    v_mfma_f32_16x16x32_bf16 v[192:195], v[240:243], v[72:75], v[192:195]
    ds_read_b128 a[248:251], v218 offset:63488
    v_mfma_f32_16x16x32_bf16 v[196:199], v[240:243], v[76:79], v[196:199]
    s_waitcnt lgkmcnt(3)
    s_add_u32 s63, s66, 36864
    v_mfma_f32_16x16x32_bf16 v[200:203], v[244:247], v[72:75], v[200:203]
    ds_read_b128 a[252:255], v218 offset:64512
    v_mfma_f32_16x16x32_bf16 v[204:207], v[244:247], v[76:79], v[204:207]
    s_waitcnt vmcnt(12) lgkmcnt(3)
    buffer_load_dwordx4 v[132:135], v218, s[4:7], s63 offen offset:0 sc1
    v_mfma_f32_16x16x32_bf16 v[160:163], a[240:243], v[80:83], v[160:163]
    s_waitcnt vmcnt(12)
    ds_read_b128 v[240:243], v223 offset:0
    v_mfma_f32_16x16x32_bf16 v[164:167], a[240:243], v[84:87], v[164:167]
    s_waitcnt lgkmcnt(3)
    v_mfma_f32_16x16x32_bf16 v[168:171], a[244:247], v[80:83], v[168:171]
    ds_read_b128 v[244:247], v223 offset:1024
    v_mfma_f32_16x16x32_bf16 v[172:175], a[244:247], v[84:87], v[172:175]
    s_waitcnt lgkmcnt(3)
    buffer_load_dwordx4 v[136:139], v218, s[4:7], s62 offen offset:1024 sc1
    v_mfma_f32_16x16x32_bf16 v[176:179], a[248:251], v[80:83], v[176:179]
    ds_read_b128 a[240:243], v223 offset:2048
    v_mfma_f32_16x16x32_bf16 v[180:183], a[248:251], v[84:87], v[180:183]
    s_waitcnt lgkmcnt(3)
    v_mfma_f32_16x16x32_bf16 v[184:187], a[252:255], v[80:83], v[184:187]
    ds_read_b128 a[244:247], v223 offset:3072
    v_mfma_f32_16x16x32_bf16 v[188:191], a[252:255], v[84:87], v[188:191]
    s_waitcnt lgkmcnt(3)
    buffer_load_dwordx4 v[140:143], v218, s[4:7], s63 offen offset:1024 sc1
    v_mfma_f32_16x16x32_bf16 v[192:195], v[240:243], v[80:83], v[192:195]
    ds_read_b128 a[248:251], v223 offset:4096
    v_mfma_f32_16x16x32_bf16 v[196:199], v[240:243], v[84:87], v[196:199]
    s_waitcnt lgkmcnt(3)
    v_mfma_f32_16x16x32_bf16 v[200:203], v[244:247], v[80:83], v[200:203]
    ds_read_b128 a[252:255], v223 offset:5120
    v_mfma_f32_16x16x32_bf16 v[204:207], v[244:247], v[84:87], v[204:207]
    s_waitcnt vmcnt(13) lgkmcnt(3)
    buffer_load_dwordx4 v[144:147], v218, s[4:7], s62 offen offset:2048 sc1
    v_mfma_f32_16x16x32_bf16 v[160:163], a[240:243], v[88:91], v[160:163]
    s_waitcnt vmcnt(13)
    ds_read_b128 v[240:243], v223 offset:6144
    v_mfma_f32_16x16x32_bf16 v[164:167], a[240:243], v[92:95], v[164:167]
    s_waitcnt lgkmcnt(3)
    v_mfma_f32_16x16x32_bf16 v[168:171], a[244:247], v[88:91], v[168:171]
    ds_read_b128 v[244:247], v223 offset:7168
    v_mfma_f32_16x16x32_bf16 v[172:175], a[244:247], v[92:95], v[172:175]
    s_waitcnt lgkmcnt(3)
    buffer_load_dwordx4 v[148:151], v218, s[4:7], s63 offen offset:2048 sc1
    v_mfma_f32_16x16x32_bf16 v[176:179], a[248:251], v[88:91], v[176:179]
    ds_read_b128 a[240:243], v223 offset:8192
    v_mfma_f32_16x16x32_bf16 v[180:183], a[248:251], v[92:95], v[180:183]
    s_waitcnt lgkmcnt(3)
    v_mfma_f32_16x16x32_bf16 v[184:187], a[252:255], v[88:91], v[184:187]
    ds_read_b128 a[244:247], v223 offset:9216
    v_mfma_f32_16x16x32_bf16 v[188:191], a[252:255], v[92:95], v[188:191]
    s_waitcnt lgkmcnt(3)
    buffer_load_dwordx4 v[152:155], v218, s[4:7], s62 offen offset:3072 sc1
    v_mfma_f32_16x16x32_bf16 v[192:195], v[240:243], v[88:91], v[192:195]
    ds_read_b128 a[248:251], v223 offset:10240
    v_mfma_f32_16x16x32_bf16 v[196:199], v[240:243], v[92:95], v[196:199]
    s_waitcnt lgkmcnt(3)
    v_mfma_f32_16x16x32_bf16 v[200:203], v[244:247], v[88:91], v[200:203]
    ds_read_b128 a[252:255], v223 offset:11264
    v_mfma_f32_16x16x32_bf16 v[204:207], v[244:247], v[92:95], v[204:207]
    s_waitcnt vmcnt(14) lgkmcnt(3)
    v_mfma_f32_16x16x32_bf16 v[160:163], a[240:243], v[96:99], v[160:163]
    s_waitcnt vmcnt(13)
    ds_read_b128 v[240:243], v223 offset:12288
    v_mfma_f32_16x16x32_bf16 v[164:167], a[240:243], v[100:103], v[164:167]
    s_waitcnt lgkmcnt(3)
    buffer_load_dwordx4 v[156:159], v218, s[4:7], s63 offen offset:3072 sc1
    v_mfma_f32_16x16x32_bf16 v[168:171], a[244:247], v[96:99], v[168:171]
    ds_read_b128 v[244:247], v223 offset:13312
    v_mfma_f32_16x16x32_bf16 v[172:175], a[244:247], v[100:103], v[172:175]
    s_waitcnt lgkmcnt(3)
    v_mfma_f32_16x16x32_bf16 v[176:179], a[248:251], v[96:99], v[176:179]
    ds_read_b128 a[240:243], v223 offset:14336
    v_lshlrev_b32 v219, 2, v218
    v_mfma_f32_16x16x32_bf16 v[180:183], a[248:251], v[100:103], v[180:183]
    s_waitcnt lgkmcnt(3)
    v_min_u32 v219, 3008, v219
    s_add_u32 s60, s70, 49152
    v_mfma_f32_16x16x32_bf16 v[184:187], a[252:255], v[96:99], v[184:187]
    ds_read_b128 a[244:247], v223 offset:15360
    v_mfma_f32_16x16x32_bf16 v[188:191], a[252:255], v[100:103], v[188:191]
    s_waitcnt lgkmcnt(3)
    buffer_load_dword v220, v219, s[4:7], s70 offen offset:0 sc1
    v_mfma_f32_16x16x32_bf16 v[192:195], v[240:243], v[96:99], v[192:195]
    ds_read_b128 a[248:251], v223 offset:16384
    v_mfma_f32_16x16x32_bf16 v[196:199], v[240:243], v[100:103], v[196:199]
    s_waitcnt lgkmcnt(3)
    buffer_load_dword v220, v219, s[4:7], s60 offen offset:0 sc1
    v_mfma_f32_16x16x32_bf16 v[200:203], v[244:247], v[96:99], v[200:203]
    ds_read_b128 a[252:255], v223 offset:17408
    v_mfma_f32_16x16x32_bf16 v[204:207], v[244:247], v[100:103], v[204:207]
    s_waitcnt vmcnt(15) lgkmcnt(3)
    buffer_load_dword v220, v221, s[16:19], 0 offen sc1
    v_mfma_f32_16x16x32_bf16 v[160:163], a[240:243], v[104:107], v[160:163]
    s_waitcnt vmcnt(15)
    ds_read_b128 v[240:243], v223 offset:18432
    s_add_u32 s100, s85, 35840
    v_mfma_f32_16x16x32_bf16 v[164:167], a[240:243], v[108:111], v[164:167]
    s_waitcnt lgkmcnt(3)
    buffer_load_dwordx4 v[0:3], v218, s[4:7], s100 offen offset:0 sc1
    v_mfma_f32_16x16x32_bf16 v[168:171], a[244:247], v[104:107], v[168:171]
    ds_read_b128 v[244:247], v223 offset:19456
    v_mfma_f32_16x16x32_bf16 v[172:175], a[244:247], v[108:111], v[172:175]
    s_waitcnt lgkmcnt(3)
    v_mfma_f32_16x16x32_bf16 v[176:179], a[248:251], v[104:107], v[176:179]
    ds_read_b128 a[240:243], v223 offset:20480
    v_mfma_f32_16x16x32_bf16 v[180:183], a[248:251], v[108:111], v[180:183]
    s_waitcnt lgkmcnt(3)
    buffer_load_dwordx4 v[4:7], v218, s[4:7], s100 offen offset:1024 sc1
    v_mfma_f32_16x16x32_bf16 v[184:187], a[252:255], v[104:107], v[184:187]
    ds_read_b128 a[244:247], v223 offset:21504
    v_mfma_f32_16x16x32_bf16 v[188:191], a[252:255], v[108:111], v[188:191]
    s_waitcnt lgkmcnt(3)
    v_mfma_f32_16x16x32_bf16 v[192:195], v[240:243], v[104:107], v[192:195]
    ds_read_b128 a[248:251], v223 offset:22528
    v_mfma_f32_16x16x32_bf16 v[196:199], v[240:243], v[108:111], v[196:199]
    s_waitcnt lgkmcnt(3)
    v_mfma_f32_16x16x32_bf16 v[200:203], v[244:247], v[104:107], v[200:203]
    ds_read_b128 a[252:255], v223 offset:23552
    v_mfma_f32_16x16x32_bf16 v[204:207], v[244:247], v[108:111], v[204:207]
    s_waitcnt vmcnt(16) lgkmcnt(3)
    buffer_load_dwordx4 v[8:11], v218, s[4:7], s100 offen offset:2048 sc1
    v_mfma_f32_16x16x32_bf16 v[160:163], a[240:243], v[112:115], v[160:163]
    s_waitcnt vmcnt(16)
    ds_read_b128 v[240:243], v223 offset:24576
    v_mfma_f32_16x16x32_bf16 v[164:167], a[240:243], v[116:119], v[164:167]
    s_waitcnt lgkmcnt(3)
    v_mfma_f32_16x16x32_bf16 v[168:171], a[244:247], v[112:115], v[168:171]
    ds_read_b128 v[244:247], v223 offset:25600
    v_mfma_f32_16x16x32_bf16 v[172:175], a[244:247], v[116:119], v[172:175]
    s_waitcnt lgkmcnt(3)
    buffer_load_dwordx4 v[12:15], v218, s[4:7], s100 offen offset:3072 sc1
    v_mfma_f32_16x16x32_bf16 v[176:179], a[248:251], v[112:115], v[176:179]
    ds_read_b128 a[240:243], v223 offset:26624
    v_mfma_f32_16x16x32_bf16 v[180:183], a[248:251], v[116:119], v[180:183]
    s_waitcnt lgkmcnt(3)
    v_mfma_f32_16x16x32_bf16 v[184:187], a[252:255], v[112:115], v[184:187]
    ds_read_b128 a[244:247], v223 offset:27648
    v_mfma_f32_16x16x32_bf16 v[188:191], a[252:255], v[116:119], v[188:191]
    s_waitcnt lgkmcnt(3)
    v_mfma_f32_16x16x32_bf16 v[192:195], v[240:243], v[112:115], v[192:195]
    s_add_u32 s100, s85, 39936
    ds_read_b128 a[248:251], v223 offset:28672
    v_mfma_f32_16x16x32_bf16 v[196:199], v[240:243], v[116:119], v[196:199]
    s_waitcnt lgkmcnt(3)
    buffer_load_dwordx4 v[16:19], v218, s[4:7], s100 offen offset:0 sc1
    v_mfma_f32_16x16x32_bf16 v[200:203], v[244:247], v[112:115], v[200:203]
    ds_read_b128 a[252:255], v223 offset:29696
    v_mfma_f32_16x16x32_bf16 v[204:207], v[244:247], v[116:119], v[204:207]
    s_waitcnt vmcnt(17) lgkmcnt(3)
    v_mfma_f32_16x16x32_bf16 v[160:163], a[240:243], v[120:123], v[160:163]
    s_waitcnt vmcnt(16)
    ds_read_b128 v[240:243], v223 offset:30720
    v_mfma_f32_16x16x32_bf16 v[164:167], a[240:243], v[124:127], v[164:167]
    s_waitcnt lgkmcnt(3)
    buffer_load_dwordx4 v[20:23], v218, s[4:7], s100 offen offset:1024 sc1
    v_mfma_f32_16x16x32_bf16 v[168:171], a[244:247], v[120:123], v[168:171]
    ds_read_b128 v[244:247], v223 offset:31744
    v_mfma_f32_16x16x32_bf16 v[172:175], a[244:247], v[124:127], v[172:175]
    s_waitcnt lgkmcnt(3)
    v_mfma_f32_16x16x32_bf16 v[176:179], a[248:251], v[120:123], v[176:179]
    ds_read_b128 a[240:243], v223 offset:32768
    v_mfma_f32_16x16x32_bf16 v[180:183], a[248:251], v[124:127], v[180:183]
    s_waitcnt lgkmcnt(3)
    v_mfma_f32_16x16x32_bf16 v[184:187], a[252:255], v[120:123], v[184:187]
    ds_read_b128 a[244:247], v223 offset:33792
    v_mfma_f32_16x16x32_bf16 v[188:191], a[252:255], v[124:127], v[188:191]
    s_waitcnt lgkmcnt(3)
    buffer_load_dwordx4 v[24:27], v218, s[4:7], s100 offen offset:2048 sc1
    v_mfma_f32_16x16x32_bf16 v[192:195], v[240:243], v[120:123], v[192:195]
    ds_read_b128 a[248:251], v223 offset:34816
    v_mfma_f32_16x16x32_bf16 v[196:199], v[240:243], v[124:127], v[196:199]
    s_waitcnt lgkmcnt(3)
    v_mfma_f32_16x16x32_bf16 v[200:203], v[244:247], v[120:123], v[200:203]
    ds_read_b128 a[252:255], v223 offset:35840
    v_mfma_f32_16x16x32_bf16 v[204:207], v[244:247], v[124:127], v[204:207]
    s_waitcnt vmcnt(17) lgkmcnt(3)
    buffer_load_dwordx4 v[28:31], v218, s[4:7], s100 offen offset:3072 sc1
    v_mfma_f32_16x16x32_bf16 v[160:163], a[240:243], v[128:131], v[160:163]
    s_waitcnt vmcnt(17)
    ds_read_b128 v[240:243], v223 offset:36864
    v_mfma_f32_16x16x32_bf16 v[164:167], a[240:243], v[132:135], v[164:167]
    s_waitcnt lgkmcnt(3)
    v_mfma_f32_16x16x32_bf16 v[168:171], a[244:247], v[128:131], v[168:171]
    ds_read_b128 v[244:247], v223 offset:37888
    v_mfma_f32_16x16x32_bf16 v[172:175], a[244:247], v[132:135], v[172:175]
    s_waitcnt lgkmcnt(3)
    v_mfma_f32_16x16x32_bf16 v[176:179], a[248:251], v[128:131], v[176:179]
    s_add_u32 s100, s85, 44032
    ds_read_b128 a[240:243], v223 offset:38912
    v_mfma_f32_16x16x32_bf16 v[180:183], a[248:251], v[132:135], v[180:183]
    s_waitcnt lgkmcnt(3)
    buffer_load_dwordx4 v[32:35], v218, s[4:7], s100 offen offset:0 sc1
    v_mfma_f32_16x16x32_bf16 v[184:187], a[252:255], v[128:131], v[184:187]
    ds_read_b128 a[244:247], v223 offset:39936
    v_mfma_f32_16x16x32_bf16 v[188:191], a[252:255], v[132:135], v[188:191]
    s_waitcnt lgkmcnt(3)
    v_mfma_f32_16x16x32_bf16 v[192:195], v[240:243], v[128:131], v[192:195]
    ds_read_b128 a[248:251], v223 offset:40960
    v_mfma_f32_16x16x32_bf16 v[196:199], v[240:243], v[132:135], v[196:199]
    s_waitcnt lgkmcnt(3)
    buffer_load_dwordx4 v[36:39], v218, s[4:7], s100 offen offset:1024 sc1
    v_mfma_f32_16x16x32_bf16 v[200:203], v[244:247], v[128:131], v[200:203]
    ds_read_b128 a[252:255], v223 offset:41984
    v_mfma_f32_16x16x32_bf16 v[204:207], v[244:247], v[132:135], v[204:207]
    s_waitcnt vmcnt(18) lgkmcnt(3)
    v_mfma_f32_16x16x32_bf16 v[160:163], a[240:243], v[136:139], v[160:163]
    s_waitcnt vmcnt(17)
    ds_read_b128 v[240:243], v223 offset:43008
    v_mfma_f32_16x16x32_bf16 v[164:167], a[240:243], v[140:143], v[164:167]
    s_waitcnt lgkmcnt(3)
    v_mfma_f32_16x16x32_bf16 v[168:171], a[244:247], v[136:139], v[168:171]
    ds_read_b128 v[244:247], v223 offset:44032
    v_mfma_f32_16x16x32_bf16 v[172:175], a[244:247], v[140:143], v[172:175]
    s_waitcnt lgkmcnt(3)
    buffer_load_dwordx4 v[40:43], v218, s[4:7], s100 offen offset:2048 sc1
    v_mfma_f32_16x16x32_bf16 v[176:179], a[248:251], v[136:139], v[176:179]
    ds_read_b128 a[240:243], v223 offset:45056
    v_mfma_f32_16x16x32_bf16 v[180:183], a[248:251], v[140:143], v[180:183]
    s_waitcnt lgkmcnt(3)
    v_mfma_f32_16x16x32_bf16 v[184:187], a[252:255], v[136:139], v[184:187]
    ds_read_b128 a[244:247], v223 offset:46080
    v_mfma_f32_16x16x32_bf16 v[188:191], a[252:255], v[140:143], v[188:191]
    s_waitcnt lgkmcnt(3)
    buffer_load_dwordx4 v[44:47], v218, s[4:7], s100 offen offset:3072 sc1
    v_mfma_f32_16x16x32_bf16 v[192:195], v[240:243], v[136:139], v[192:195]
    ds_read_b128 a[248:251], v223 offset:47104
    v_mfma_f32_16x16x32_bf16 v[196:199], v[240:243], v[140:143], v[196:199]
    s_waitcnt lgkmcnt(3)
    v_mfma_f32_16x16x32_bf16 v[200:203], v[244:247], v[136:139], v[200:203]
    ds_read_b128 a[252:255], v223 offset:48128
    v_mfma_f32_16x16x32_bf16 v[204:207], v[244:247], v[140:143], v[204:207]
    s_waitcnt vmcnt(18) lgkmcnt(3)
    v_mfma_f32_16x16x32_bf16 v[160:163], a[240:243], v[144:147], v[160:163]
    s_waitcnt vmcnt(17)
    ds_read_b128 v[240:243], v223 offset:49152
    s_add_u32 s100, s85, 48128
    v_mfma_f32_16x16x32_bf16 v[164:167], a[240:243], v[148:151], v[164:167]
    s_waitcnt lgkmcnt(3)
    buffer_load_dwordx4 v[48:51], v218, s[4:7], s100 offen offset:0 sc1
    v_mfma_f32_16x16x32_bf16 v[168:171], a[244:247], v[144:147], v[168:171]
    ds_read_b128 v[244:247], v223 offset:50176
    v_mfma_f32_16x16x32_bf16 v[172:175], a[244:247], v[148:151], v[172:175]
    s_waitcnt lgkmcnt(3)
    v_mfma_f32_16x16x32_bf16 v[176:179], a[248:251], v[144:147], v[176:179]
    ds_read_b128 a[240:243], v223 offset:51200
    v_mfma_f32_16x16x32_bf16 v[180:183], a[248:251], v[148:151], v[180:183]
    s_waitcnt lgkmcnt(3)
    buffer_load_dwordx4 v[52:55], v218, s[4:7], s100 offen offset:1024 sc1
    v_mfma_f32_16x16x32_bf16 v[184:187], a[252:255], v[144:147], v[184:187]
    ds_read_b128 a[244:247], v223 offset:52224
    v_mfma_f32_16x16x32_bf16 v[188:191], a[252:255], v[148:151], v[188:191]
    s_waitcnt lgkmcnt(3)
    v_mfma_f32_16x16x32_bf16 v[192:195], v[240:243], v[144:147], v[192:195]
    ds_read_b128 a[248:251], v223 offset:53248
    v_mfma_f32_16x16x32_bf16 v[196:199], v[240:243], v[148:151], v[196:199]
    s_waitcnt lgkmcnt(3)
    v_mfma_f32_16x16x32_bf16 v[200:203], v[244:247], v[144:147], v[200:203]
    ds_read_b128 a[252:255], v223 offset:54272
    v_mfma_f32_16x16x32_bf16 v[204:207], v[244:247], v[148:151], v[204:207]
    s_waitcnt vmcnt(18) lgkmcnt(3)
    ds_read_b128 v[100:103], v225 offset:512
    ds_read_b128 v[124:127], v225 offset:1024
    v_mfma_f32_16x16x32_bf16 v[160:163], a[240:243], v[152:155], v[160:163]
    s_waitcnt vmcnt(17)
    ds_read_b128 v[240:243], v223 offset:55296
    ds_read_b128 v[104:107], v225 offset:576
    v_mfma_f32_16x16x32_bf16 v[164:167], a[240:243], v[156:159], v[164:167]
    s_waitcnt lgkmcnt(6)
    ds_read_b128 v[128:131], v225 offset:1088
    buffer_load_dwordx4 v[56:59], v218, s[4:7], s100 offen offset:2048 sc1
    v_mfma_f32_16x16x32_bf16 v[168:171], a[244:247], v[152:155], v[168:171]
    ds_read_b128 v[244:247], v223 offset:56320
    ds_read_b128 v[108:111], v225 offset:640
    v_mfma_f32_16x16x32_bf16 v[172:175], a[244:247], v[156:159], v[172:175]
    s_waitcnt lgkmcnt(8)
    buffer_load_dwordx4 v[60:63], v218, s[4:7], s100 offen offset:3072 sc1
    ds_read_b128 v[132:135], v225 offset:1152
    ds_read_b128 v[112:115], v225 offset:704
    v_mfma_f32_16x16x32_bf16 v[176:179], a[248:251], v[152:155], v[176:179]
    ds_read_b128 v[136:139], v225 offset:1216
    v_mfma_f32_16x16x32_bf16 v[180:183], a[248:251], v[156:159], v[180:183]
    s_waitcnt lgkmcnt(10)
    ds_read_b128 v[116:119], v225 offset:768
    v_mfma_f32_16x16x32_bf16 v[184:187], a[252:255], v[152:155], v[184:187]
    ds_read_b128 v[140:143], v225 offset:1280
    v_mfma_f32_16x16x32_bf16 v[188:191], a[252:255], v[156:159], v[188:191]
    s_waitcnt lgkmcnt(9)
    ds_read_b128 v[120:123], v225 offset:832
    ds_read_b128 v[144:147], v225 offset:1344
    v_mfma_f32_16x16x32_bf16 v[192:195], v[240:243], v[152:155], v[192:195]
    v_mfma_f32_16x16x32_bf16 v[196:199], v[240:243], v[156:159], v[196:199]
    s_waitcnt lgkmcnt(8)
    v_mfma_f32_16x16x32_bf16 v[200:203], v[244:247], v[152:155], v[200:203]
    v_mfma_f32_16x16x32_bf16 v[204:207], v[244:247], v[156:159], v[204:207]
    s_add_u32 s35, s80, 4096
    v_pk_fma_f32 v[160:161], v[226:227], v[100:101], v[160:161] op_sel:[0,0,0] op_sel_hi:[0,1,1]
    v_pk_fma_f32 v[162:163], v[226:227], v[102:103], v[162:163] op_sel:[0,0,0] op_sel_hi:[0,1,1]
    v_pk_fma_f32 v[168:169], v[226:227], v[104:105], v[168:169] op_sel:[0,0,0] op_sel_hi:[0,1,1]
    v_pk_fma_f32 v[170:171], v[226:227], v[106:107], v[170:171] op_sel:[0,0,0] op_sel_hi:[0,1,1]
    v_pk_fma_f32 v[160:161], v[228:229], v[160:161], v[124:125] op_sel:[0,0,0] op_sel_hi:[0,1,1]
    v_pk_fma_f32 v[162:163], v[228:229], v[162:163], v[126:127] op_sel:[0,0,0] op_sel_hi:[0,1,1]
    v_pk_fma_f32 v[168:169], v[228:229], v[168:169], v[128:129] op_sel:[0,0,0] op_sel_hi:[0,1,1]
    v_pk_fma_f32 v[170:171], v[228:229], v[170:171], v[130:131] op_sel:[0,0,0] op_sel_hi:[0,1,1]
    v_max_f32 v160, 0, v160
    v_max_f32 v161, 0, v161
    v_max_f32 v162, 0, v162
    v_max_f32 v163, 0, v163
    v_max_f32 v168, 0, v168
    v_max_f32 v169, 0, v169
    v_max_f32 v170, 0, v170
    v_max_f32 v171, 0, v171
    v_pk_mul_f32 v[160:161], v[160:161], v[160:161]
    v_pk_mul_f32 v[162:163], v[162:163], v[162:163]
    v_pk_mul_f32 v[168:169], v[168:169], v[168:169]
    v_pk_mul_f32 v[170:171], v[170:171], v[170:171]
    v_cvt_pk_bf16_f32 v160, v160, v161
    v_cvt_pk_bf16_f32 v161, v162, v163
    v_cvt_pk_bf16_f32 v162, v168, v169
    v_cvt_pk_bf16_f32 v163, v170, v171
    buffer_store_dwordx4 v[160:163], v218, s[4:7], s70 offen offset:0
    v_pk_fma_f32 v[164:165], v[226:227], v[100:101], v[164:165] op_sel:[1,0,0] op_sel_hi:[1,1,1]
    v_pk_fma_f32 v[166:167], v[226:227], v[102:103], v[166:167] op_sel:[1,0,0] op_sel_hi:[1,1,1]
    v_pk_fma_f32 v[172:173], v[226:227], v[104:105], v[172:173] op_sel:[1,0,0] op_sel_hi:[1,1,1]
    v_pk_fma_f32 v[174:175], v[226:227], v[106:107], v[174:175] op_sel:[1,0,0] op_sel_hi:[1,1,1]
    v_pk_fma_f32 v[164:165], v[228:229], v[164:165], v[124:125] op_sel:[1,0,0] op_sel_hi:[1,1,1]
    v_pk_fma_f32 v[166:167], v[228:229], v[166:167], v[126:127] op_sel:[1,0,0] op_sel_hi:[1,1,1]
    v_pk_fma_f32 v[172:173], v[228:229], v[172:173], v[128:129] op_sel:[1,0,0] op_sel_hi:[1,1,1]
    v_pk_fma_f32 v[174:175], v[228:229], v[174:175], v[130:131] op_sel:[1,0,0] op_sel_hi:[1,1,1]
    v_max_f32 v164, 0, v164
    v_max_f32 v165, 0, v165
    v_max_f32 v166, 0, v166
    v_max_f32 v167, 0, v167
    v_max_f32 v172, 0, v172
    v_max_f32 v173, 0, v173
    v_max_f32 v174, 0, v174
    v_max_f32 v175, 0, v175
    v_pk_mul_f32 v[164:165], v[164:165], v[164:165]
    v_pk_mul_f32 v[166:167], v[166:167], v[166:167]
    v_pk_mul_f32 v[172:173], v[172:173], v[172:173]
    v_pk_mul_f32 v[174:175], v[174:175], v[174:175]
    v_cvt_pk_bf16_f32 v164, v164, v165
    v_cvt_pk_bf16_f32 v165, v166, v167
    v_cvt_pk_bf16_f32 v166, v172, v173
    v_cvt_pk_bf16_f32 v167, v174, v175
    buffer_store_dwordx4 v[164:167], v218, s[4:7], s60 offen offset:0
    s_waitcnt lgkmcnt(7)
    v_pk_fma_f32 v[176:177], v[226:227], v[108:109], v[176:177] op_sel:[0,0,0] op_sel_hi:[0,1,1]
    v_pk_fma_f32 v[178:179], v[226:227], v[110:111], v[178:179] op_sel:[0,0,0] op_sel_hi:[0,1,1]
    s_waitcnt lgkmcnt(5)
    v_pk_fma_f32 v[184:185], v[226:227], v[112:113], v[184:185] op_sel:[0,0,0] op_sel_hi:[0,1,1]
    v_pk_fma_f32 v[186:187], v[226:227], v[114:115], v[186:187] op_sel:[0,0,0] op_sel_hi:[0,1,1]
    v_pk_fma_f32 v[176:177], v[228:229], v[176:177], v[132:133] op_sel:[0,0,0] op_sel_hi:[0,1,1]
    v_pk_fma_f32 v[178:179], v[228:229], v[178:179], v[134:135] op_sel:[0,0,0] op_sel_hi:[0,1,1]
    s_waitcnt lgkmcnt(4)
    v_pk_fma_f32 v[184:185], v[228:229], v[184:185], v[136:137] op_sel:[0,0,0] op_sel_hi:[0,1,1]
    v_pk_fma_f32 v[186:187], v[228:229], v[186:187], v[138:139] op_sel:[0,0,0] op_sel_hi:[0,1,1]
    v_max_f32 v176, 0, v176
    v_max_f32 v177, 0, v177
    v_max_f32 v178, 0, v178
    v_max_f32 v179, 0, v179
    v_max_f32 v184, 0, v184
    v_max_f32 v185, 0, v185
    v_max_f32 v186, 0, v186
    v_max_f32 v187, 0, v187
    v_pk_mul_f32 v[176:177], v[176:177], v[176:177]
    v_pk_mul_f32 v[178:179], v[178:179], v[178:179]
    v_pk_mul_f32 v[184:185], v[184:185], v[184:185]
    v_pk_mul_f32 v[186:187], v[186:187], v[186:187]
    v_cvt_pk_bf16_f32 v176, v176, v177
    v_cvt_pk_bf16_f32 v177, v178, v179
    v_cvt_pk_bf16_f32 v178, v184, v185
    v_cvt_pk_bf16_f32 v179, v186, v187
    buffer_store_dwordx4 v[176:179], v218, s[4:7], s70 offen offset:1024
    v_pk_fma_f32 v[180:181], v[226:227], v[108:109], v[180:181] op_sel:[1,0,0] op_sel_hi:[1,1,1]
    v_pk_fma_f32 v[182:183], v[226:227], v[110:111], v[182:183] op_sel:[1,0,0] op_sel_hi:[1,1,1]
    v_pk_fma_f32 v[188:189], v[226:227], v[112:113], v[188:189] op_sel:[1,0,0] op_sel_hi:[1,1,1]
    v_pk_fma_f32 v[190:191], v[226:227], v[114:115], v[190:191] op_sel:[1,0,0] op_sel_hi:[1,1,1]
    v_pk_fma_f32 v[180:181], v[228:229], v[180:181], v[132:133] op_sel:[1,0,0] op_sel_hi:[1,1,1]
    v_pk_fma_f32 v[182:183], v[228:229], v[182:183], v[134:135] op_sel:[1,0,0] op_sel_hi:[1,1,1]
    v_pk_fma_f32 v[188:189], v[228:229], v[188:189], v[136:137] op_sel:[1,0,0] op_sel_hi:[1,1,1]
    v_pk_fma_f32 v[190:191], v[228:229], v[190:191], v[138:139] op_sel:[1,0,0] op_sel_hi:[1,1,1]
    v_max_f32 v180, 0, v180
    v_max_f32 v181, 0, v181
    v_max_f32 v182, 0, v182
    v_max_f32 v183, 0, v183
    v_max_f32 v188, 0, v188
    v_max_f32 v189, 0, v189
    v_max_f32 v190, 0, v190
    v_max_f32 v191, 0, v191
    v_pk_mul_f32 v[180:181], v[180:181], v[180:181]
    v_pk_mul_f32 v[182:183], v[182:183], v[182:183]
    v_pk_mul_f32 v[188:189], v[188:189], v[188:189]
    v_pk_mul_f32 v[190:191], v[190:191], v[190:191]
    v_cvt_pk_bf16_f32 v180, v180, v181
    v_cvt_pk_bf16_f32 v181, v182, v183
    v_cvt_pk_bf16_f32 v182, v188, v189
    v_cvt_pk_bf16_f32 v183, v190, v191
    buffer_store_dwordx4 v[180:183], v218, s[4:7], s60 offen offset:1024
    s_waitcnt lgkmcnt(3)
    v_pk_fma_f32 v[192:193], v[226:227], v[116:117], v[192:193] op_sel:[0,0,0] op_sel_hi:[0,1,1]
    v_pk_fma_f32 v[194:195], v[226:227], v[118:119], v[194:195] op_sel:[0,0,0] op_sel_hi:[0,1,1]
    s_waitcnt lgkmcnt(1)
    v_pk_fma_f32 v[200:201], v[226:227], v[120:121], v[200:201] op_sel:[0,0,0] op_sel_hi:[0,1,1]
    v_pk_fma_f32 v[202:203], v[226:227], v[122:123], v[202:203] op_sel:[0,0,0] op_sel_hi:[0,1,1]
    v_pk_fma_f32 v[192:193], v[228:229], v[192:193], v[140:141] op_sel:[0,0,0] op_sel_hi:[0,1,1]
    v_pk_fma_f32 v[194:195], v[228:229], v[194:195], v[142:143] op_sel:[0,0,0] op_sel_hi:[0,1,1]
    s_waitcnt lgkmcnt(0)
    v_pk_fma_f32 v[200:201], v[228:229], v[200:201], v[144:145] op_sel:[0,0,0] op_sel_hi:[0,1,1]
    v_pk_fma_f32 v[202:203], v[228:229], v[202:203], v[146:147] op_sel:[0,0,0] op_sel_hi:[0,1,1]
    v_max_f32 v192, 0, v192
    v_max_f32 v193, 0, v193
    v_max_f32 v194, 0, v194
    v_max_f32 v195, 0, v195
    v_max_f32 v200, 0, v200
    v_max_f32 v201, 0, v201
    v_max_f32 v202, 0, v202
    v_max_f32 v203, 0, v203
    v_pk_mul_f32 v[192:193], v[192:193], v[192:193]
    v_pk_mul_f32 v[194:195], v[194:195], v[194:195]
    v_pk_mul_f32 v[200:201], v[200:201], v[200:201]
    v_pk_mul_f32 v[202:203], v[202:203], v[202:203]
    v_cvt_pk_bf16_f32 v192, v192, v193
    v_cvt_pk_bf16_f32 v193, v194, v195
    v_cvt_pk_bf16_f32 v194, v200, v201
    v_cvt_pk_bf16_f32 v195, v202, v203
    buffer_store_dwordx4 v[192:195], v218, s[4:7], s70 offen offset:2048
    v_pk_fma_f32 v[196:197], v[226:227], v[116:117], v[196:197] op_sel:[1,0,0] op_sel_hi:[1,1,1]
    v_pk_fma_f32 v[198:199], v[226:227], v[118:119], v[198:199] op_sel:[1,0,0] op_sel_hi:[1,1,1]
    v_pk_fma_f32 v[204:205], v[226:227], v[120:121], v[204:205] op_sel:[1,0,0] op_sel_hi:[1,1,1]
    v_pk_fma_f32 v[206:207], v[226:227], v[122:123], v[206:207] op_sel:[1,0,0] op_sel_hi:[1,1,1]
    v_pk_fma_f32 v[196:197], v[228:229], v[196:197], v[140:141] op_sel:[1,0,0] op_sel_hi:[1,1,1]
    v_pk_fma_f32 v[198:199], v[228:229], v[198:199], v[142:143] op_sel:[1,0,0] op_sel_hi:[1,1,1]
    v_pk_fma_f32 v[204:205], v[228:229], v[204:205], v[144:145] op_sel:[1,0,0] op_sel_hi:[1,1,1]
    v_pk_fma_f32 v[206:207], v[228:229], v[206:207], v[146:147] op_sel:[1,0,0] op_sel_hi:[1,1,1]
    v_max_f32 v196, 0, v196
    v_max_f32 v197, 0, v197
    v_max_f32 v198, 0, v198
    v_max_f32 v199, 0, v199
    v_max_f32 v204, 0, v204
    v_max_f32 v205, 0, v205
    v_max_f32 v206, 0, v206
    v_max_f32 v207, 0, v207
    v_pk_mul_f32 v[196:197], v[196:197], v[196:197]
    v_pk_mul_f32 v[198:199], v[198:199], v[198:199]
    v_pk_mul_f32 v[204:205], v[204:205], v[204:205]
    v_pk_mul_f32 v[206:207], v[206:207], v[206:207]
    v_cvt_pk_bf16_f32 v196, v196, v197
    v_cvt_pk_bf16_f32 v197, v198, v199
    v_cvt_pk_bf16_f32 v198, v204, v205
    v_cvt_pk_bf16_f32 v199, v206, v207
    buffer_store_dwordx4 v[196:199], v218, s[4:7], s60 offen offset:2048
    s_mov_b64 exec, 1
    v_mov_b32 v230, s28
    v_mov_b32 v231, s29
    s_cmp_lg_u32 s27, 0
    s_cbranch_scc1 L_slowpub_55
    s_waitcnt vmcnt(0)
    buffer_store_dwordx2 v[230:231], off, s[4:7], s35 offset:3072
L_pubdone_56:
    s_mov_b64 exec, -1
    s_barrier
    s_add_u32 s100, s85, 52224
    buffer_load_dwordx4 v[64:67], v218, s[4:7], s100 offen offset:0 sc1
    buffer_load_dwordx4 v[68:71], v218, s[4:7], s100 offen offset:1024 sc1
    buffer_load_dwordx4 v[72:75], v218, s[4:7], s100 offen offset:2048 sc1
    buffer_load_dwordx4 v[76:79], v218, s[4:7], s100 offen offset:3072 sc1
    s_add_u32 s100, s85, 56320
    buffer_load_dwordx4 v[80:83], v218, s[4:7], s100 offen offset:0 sc1
    buffer_load_dwordx4 v[84:87], v218, s[4:7], s100 offen offset:1024 sc1
    buffer_load_dwordx4 v[88:91], v218, s[4:7], s100 offen offset:2048 sc1
    buffer_load_dwordx4 v[92:95], v218, s[4:7], s100 offen offset:3072 sc1
    s_add_u32 s100, s85, 60416
    buffer_load_dwordx4 v[96:99], v218, s[4:7], s100 offen offset:0 sc1
    s_mul_i32 s35, s24, 12288
    s_add_u32 s35, s35, s94
    s_mul_i32 s90, s71, 49152
    s_add_u32 s90, s90, s35
    s_mul_i32 s91, s72, 49152
    s_add_u32 s91, s91, s35
    s_mul_i32 s92, s73, 49152
    s_add_u32 s92, s92, s35
    s_mul_i32 s93, s74, 49152
    s_add_u32 s93, s93, s35
    v_lshrrev_b32 v206, 1, v218
    s_add_u32 s35, s81, 4096
    s_mov_b32 exec_lo, 0xff
    s_mov_b32 exec_hi, 0x0
    s_mov_b32 s65, 262144
L_poll_57:
    buffer_load_dwordx2 v[204:205], v206, s[4:7], s35 offen offset:3072 sc1
    s_sub_u32 s65, s65, 1
    s_cbranch_scc1 L_polled_58
    s_waitcnt vmcnt(0)
    v_cmp_ne_u64 vcc, s[28:29], v[204:205]
    s_cbranch_vccnz L_poll_57
L_polled_58:
    s_mov_b64 exec, -1
    s_cmp_lg_u32 s27, 0
    s_cbranch_scc1 L_slowacq_59
L_acqdone_60:
    s_add_u32 s62, s90, 0
    buffer_load_dwordx4 v[100:103], v218, s[4:7], s62 offen offset:0 sc1
    buffer_load_dwordx4 v[104:107], v218, s[4:7], s62 offen offset:1024 sc1
    buffer_load_dwordx4 v[108:111], v218, s[4:7], s62 offen offset:2048 sc1
    buffer_load_dwordx4 v[112:115], v218, s[4:7], s62 offen offset:3072 sc1
    s_add_u32 s62, s90, 4096
    buffer_load_dwordx4 v[116:119], v218, s[4:7], s62 offen offset:0 sc1
    buffer_load_dwordx4 v[120:123], v218, s[4:7], s62 offen offset:1024 sc1
    s_waitcnt vmcnt(5)
    v_mfma_f32_16x16x32_bf16 v[164:167], a[100:103], v[100:103], 0
    buffer_load_dwordx4 v[124:127], v218, s[4:7], s62 offen offset:2048 sc1
    v_mfma_f32_16x16x32_bf16 v[168:171], a[104:107], v[100:103], 0
    v_mfma_f32_16x16x32_bf16 v[172:175], a[108:111], v[100:103], 0
    v_mfma_f32_16x16x32_bf16 v[176:179], a[112:115], v[100:103], 0
    v_mfma_f32_16x16x32_bf16 v[180:183], a[116:119], v[100:103], 0
    s_waitcnt vmcnt(5)
    buffer_load_dwordx4 v[128:131], v218, s[4:7], s62 offen offset:3072 sc1
    v_mfma_f32_16x16x32_bf16 v[164:167], a[120:123], v[104:107], v[164:167]
    s_mul_i32 s35, s24, 10240
    s_add_u32 s35, s35, 112640
    v_mfma_f32_16x16x32_bf16 v[168:171], a[124:127], v[104:107], v[168:171]
    v_add_u32 v219, s35, v218
    v_mfma_f32_16x16x32_bf16 v[172:175], a[128:131], v[104:107], v[172:175]
    v_lshlrev_b32 v230, 16, v208
    v_and_b32 v231, 0xffff0000, v208
    v_mfma_f32_16x16x32_bf16 v[176:179], a[132:135], v[104:107], v[176:179]
    v_lshlrev_b32 v232, 16, v209
    v_mfma_f32_16x16x32_bf16 v[180:183], a[136:139], v[104:107], v[180:183]
    s_waitcnt vmcnt(5)
    s_add_u32 s62, s90, 8192
    v_and_b32 v233, 0xffff0000, v209
    v_mfma_f32_16x16x32_bf16 v[164:167], a[140:143], v[108:111], v[164:167]
    buffer_load_dwordx4 v[132:135], v218, s[4:7], s62 offen offset:0 sc1
    v_mfma_f32_16x16x32_bf16 v[168:171], a[144:147], v[108:111], v[168:171]
    v_lshlrev_b32 v234, 16, v210
    v_bfe_u32 v204, v218, 4, 4
    v_mfma_f32_16x16x32_bf16 v[172:175], a[148:151], v[108:111], v[172:175]
    v_and_b32 v235, 0xffff0000, v210
    v_lshrrev_b32 v205, 8, v218
    v_mfma_f32_16x16x32_bf16 v[176:179], a[152:155], v[108:111], v[176:179]
    v_lshlrev_b32 v236, 16, v211
    v_mul_u32_u24 v204, 1280, v204
    v_mfma_f32_16x16x32_bf16 v[180:183], a[156:159], v[108:111], v[180:183]
    s_waitcnt vmcnt(5)
    buffer_load_dwordx4 v[136:139], v218, s[4:7], s62 offen offset:1024 sc1
    v_and_b32 v237, 0xffff0000, v211
    v_mfma_f32_16x16x32_bf16 v[164:167], a[160:163], v[112:115], v[164:167]
    v_lshlrev_b32 v238, 16, v212
    v_lshl_add_u32 v206, v205, 3, v204
    v_mfma_f32_16x16x32_bf16 v[168:171], a[164:167], v[112:115], v[168:171]
    v_and_b32 v239, 0xffff0000, v212
    v_lshl_add_u32 v204, v205, 4, v204
    v_mfma_f32_16x16x32_bf16 v[172:175], a[168:171], v[112:115], v[172:175]
    v_lshlrev_b32 v240, 16, v213
    v_and_b32 v241, 0xffff0000, v213
    v_mfma_f32_16x16x32_bf16 v[176:179], a[172:175], v[112:115], v[176:179]
    v_lshlrev_b32 v242, 16, v214
    v_and_b32 v243, 0xffff0000, v214
    v_mfma_f32_16x16x32_bf16 v[180:183], a[176:179], v[112:115], v[180:183]
    s_waitcnt vmcnt(5)
    buffer_load_dwordx4 v[140:143], v218, s[4:7], s62 offen offset:2048 sc1
    v_mfma_f32_16x16x32_bf16 v[164:167], a[180:183], v[116:119], v[164:167]
    v_lshlrev_b32 v244, 16, v215
    v_and_b32 v245, 0xffff0000, v215
    v_mfma_f32_16x16x32_bf16 v[168:171], a[184:187], v[116:119], v[168:171]
    v_lshlrev_b32 v246, 16, v216
    v_and_b32 v247, 0xffff0000, v216
    v_mfma_f32_16x16x32_bf16 v[172:175], a[188:191], v[116:119], v[172:175]
    v_lshlrev_b32 v248, 16, v217
    v_and_b32 v249, 0xffff0000, v217
    v_mfma_f32_16x16x32_bf16 v[176:179], a[192:195], v[116:119], v[176:179]
    v_mfma_f32_16x16x32_bf16 v[180:183], a[196:199], v[116:119], v[180:183]
    s_waitcnt vmcnt(5)
    buffer_load_dwordx4 v[100:103], v218, s[4:7], s62 offen offset:3072 sc1
    v_mfma_f32_16x16x32_bf16 v[164:167], a[200:203], v[120:123], v[164:167]
    v_mfma_f32_16x16x32_bf16 v[168:171], a[204:207], v[120:123], v[168:171]
    v_mfma_f32_16x16x32_bf16 v[172:175], a[208:211], v[120:123], v[172:175]
    v_mfma_f32_16x16x32_bf16 v[176:179], a[212:215], v[120:123], v[176:179]
    s_add_u32 s62, s91, 0
    buffer_load_dwordx4 v[104:107], v218, s[4:7], s62 offen offset:0 sc1
    v_mfma_f32_16x16x32_bf16 v[180:183], a[216:219], v[120:123], v[180:183]
    s_waitcnt vmcnt(6)
    v_mfma_f32_16x16x32_bf16 v[164:167], a[220:223], v[124:127], v[164:167]
    v_mfma_f32_16x16x32_bf16 v[168:171], a[224:227], v[124:127], v[168:171]
    v_mfma_f32_16x16x32_bf16 v[172:175], a[228:231], v[124:127], v[172:175]
    v_mfma_f32_16x16x32_bf16 v[176:179], a[232:235], v[124:127], v[176:179]
    buffer_load_dwordx4 v[108:111], v218, s[4:7], s62 offen offset:1024 sc1
    v_mfma_f32_16x16x32_bf16 v[180:183], a[236:239], v[124:127], v[180:183]
    s_waitcnt vmcnt(6)
    v_mfma_f32_16x16x32_bf16 v[164:167], v[0:3], v[128:131], v[164:167]
    v_mfma_f32_16x16x32_bf16 v[168:171], v[4:7], v[128:131], v[168:171]
    v_mfma_f32_16x16x32_bf16 v[172:175], v[8:11], v[128:131], v[172:175]
    v_mfma_f32_16x16x32_bf16 v[176:179], v[12:15], v[128:131], v[176:179]
    buffer_load_dwordx4 v[112:115], v218, s[4:7], s62 offen offset:2048 sc1
    v_mfma_f32_16x16x32_bf16 v[180:183], v[16:19], v[128:131], v[180:183]
    s_waitcnt vmcnt(6)
    v_mfma_f32_16x16x32_bf16 v[164:167], v[20:23], v[132:135], v[164:167]
    v_mfma_f32_16x16x32_bf16 v[168:171], v[24:27], v[132:135], v[168:171]
    v_mfma_f32_16x16x32_bf16 v[172:175], v[28:31], v[132:135], v[172:175]
    v_mfma_f32_16x16x32_bf16 v[176:179], v[32:35], v[132:135], v[176:179]
    buffer_load_dwordx4 v[116:119], v218, s[4:7], s62 offen offset:3072 sc1
    v_mfma_f32_16x16x32_bf16 v[180:183], v[36:39], v[132:135], v[180:183]
    s_waitcnt vmcnt(6)
    v_mfma_f32_16x16x32_bf16 v[164:167], v[40:43], v[136:139], v[164:167]
    v_mfma_f32_16x16x32_bf16 v[168:171], v[44:47], v[136:139], v[168:171]
    v_mfma_f32_16x16x32_bf16 v[172:175], v[48:51], v[136:139], v[172:175]
    s_add_u32 s62, s91, 4096
    buffer_load_dwordx4 v[120:123], v218, s[4:7], s62 offen offset:0 sc1
    v_mfma_f32_16x16x32_bf16 v[176:179], v[52:55], v[136:139], v[176:179]
    v_mfma_f32_16x16x32_bf16 v[180:183], v[56:59], v[136:139], v[180:183]
    s_waitcnt vmcnt(6)
    v_mfma_f32_16x16x32_bf16 v[164:167], v[60:63], v[140:143], v[164:167]
    v_mfma_f32_16x16x32_bf16 v[168:171], v[64:67], v[140:143], v[168:171]
    v_mfma_f32_16x16x32_bf16 v[172:175], v[68:71], v[140:143], v[172:175]
    buffer_load_dwordx4 v[124:127], v218, s[4:7], s62 offen offset:1024 sc1
    v_mfma_f32_16x16x32_bf16 v[176:179], v[72:75], v[140:143], v[176:179]
    v_mfma_f32_16x16x32_bf16 v[180:183], v[76:79], v[140:143], v[180:183]
    s_waitcnt vmcnt(6)
    s_and_b32 s35, s71, 3
    v_mfma_f32_16x16x32_bf16 v[164:167], v[80:83], v[100:103], v[164:167]
    s_mul_i32 s35, s35, 10240
    v_mfma_f32_16x16x32_bf16 v[168:171], v[84:87], v[100:103], v[168:171]
    s_add_u32 s35, s35, 112640
    v_mfma_f32_16x16x32_bf16 v[172:175], v[88:91], v[100:103], v[172:175]
    buffer_load_dwordx4 v[128:131], v218, s[4:7], s62 offen offset:2048 sc1
    v_mfma_f32_16x16x32_bf16 v[176:179], v[92:95], v[100:103], v[176:179]
    v_add_u32 v223, s35, v218
    v_mfma_f32_16x16x32_bf16 v[180:183], v[96:99], v[100:103], v[180:183]
    s_waitcnt vmcnt(6)
    v_mfma_f32_16x16x32_bf16 v[184:187], a[100:103], v[104:107], 0
    v_mfma_f32_16x16x32_bf16 v[188:191], a[104:107], v[104:107], 0
    ds_write_b128 v223, v[164:167] offset:0
    v_mfma_f32_16x16x32_bf16 v[192:195], a[108:111], v[104:107], 0
    buffer_load_dwordx4 v[132:135], v218, s[4:7], s62 offen offset:3072 sc1
    v_mfma_f32_16x16x32_bf16 v[196:199], a[112:115], v[104:107], 0
    v_mfma_f32_16x16x32_bf16 v[200:203], a[116:119], v[104:107], 0
    s_waitcnt vmcnt(6)
    ds_write_b128 v223, v[168:171] offset:1024
    v_mfma_f32_16x16x32_bf16 v[184:187], a[120:123], v[108:111], v[184:187]
    v_mfma_f32_16x16x32_bf16 v[188:191], a[124:127], v[108:111], v[188:191]
    v_mfma_f32_16x16x32_bf16 v[192:195], a[128:131], v[108:111], v[192:195]
    s_add_u32 s62, s91, 8192
    buffer_load_dwordx4 v[136:139], v218, s[4:7], s62 offen offset:0 sc1
    v_mfma_f32_16x16x32_bf16 v[196:199], a[132:135], v[108:111], v[196:199]
    ds_write_b128 v223, v[172:175] offset:2048
    v_mfma_f32_16x16x32_bf16 v[200:203], a[136:139], v[108:111], v[200:203]
    s_waitcnt vmcnt(6)
    v_mfma_f32_16x16x32_bf16 v[184:187], a[140:143], v[112:115], v[184:187]
    ds_write_b128 v223, v[176:179] offset:3072
    v_mfma_f32_16x16x32_bf16 v[188:191], a[144:147], v[112:115], v[188:191]
    buffer_load_dwordx4 v[140:143], v218, s[4:7], s62 offen offset:1024 sc1
    v_mfma_f32_16x16x32_bf16 v[192:195], a[148:151], v[112:115], v[192:195]
    v_mfma_f32_16x16x32_bf16 v[196:199], a[152:155], v[112:115], v[196:199]
    ds_write_b128 v223, v[180:183] offset:4096
    v_mfma_f32_16x16x32_bf16 v[200:203], a[156:159], v[112:115], v[200:203]
    s_waitcnt vmcnt(6)
    v_mfma_f32_16x16x32_bf16 v[184:187], a[160:163], v[116:119], v[184:187]
    v_mfma_f32_16x16x32_bf16 v[188:191], a[164:167], v[116:119], v[188:191]
    buffer_load_dwordx4 v[100:103], v218, s[4:7], s62 offen offset:2048 sc1
    v_mfma_f32_16x16x32_bf16 v[192:195], a[168:171], v[116:119], v[192:195]
    v_mfma_f32_16x16x32_bf16 v[196:199], a[172:175], v[116:119], v[196:199]
    v_mfma_f32_16x16x32_bf16 v[200:203], a[176:179], v[116:119], v[200:203]
    s_waitcnt vmcnt(6)
    ds_read_b128 v[144:147], v225 offset:1536
    v_mfma_f32_16x16x32_bf16 v[184:187], a[180:183], v[120:123], v[184:187]
    ds_read_b128 v[148:151], v225 offset:1600
    v_mfma_f32_16x16x32_bf16 v[188:191], a[184:187], v[120:123], v[188:191]
    buffer_load_dwordx4 v[104:107], v218, s[4:7], s62 offen offset:3072 sc1
    v_mfma_f32_16x16x32_bf16 v[192:195], a[188:191], v[120:123], v[192:195]
    ds_read_b128 v[152:155], v225 offset:1664
    ds_read_b128 v[156:159], v225 offset:1728
    v_mfma_f32_16x16x32_bf16 v[196:199], a[192:195], v[120:123], v[196:199]
    ds_read_b128 v[160:163], v225 offset:1792
    v_mfma_f32_16x16x32_bf16 v[200:203], a[196:199], v[120:123], v[200:203]
    s_waitcnt vmcnt(6)
    v_mfma_f32_16x16x32_bf16 v[184:187], a[200:203], v[124:127], v[184:187]
    v_mfma_f32_16x16x32_bf16 v[188:191], a[204:207], v[124:127], v[188:191]
    s_add_u32 s62, s92, 0
    buffer_load_dwordx4 v[108:111], v218, s[4:7], s62 offen offset:0 sc1
    v_mfma_f32_16x16x32_bf16 v[192:195], a[208:211], v[124:127], v[192:195]
    v_mfma_f32_16x16x32_bf16 v[196:199], a[212:215], v[124:127], v[196:199]
    v_mfma_f32_16x16x32_bf16 v[200:203], a[216:219], v[124:127], v[200:203]
    s_waitcnt vmcnt(6)
    v_mfma_f32_16x16x32_bf16 v[184:187], a[220:223], v[128:131], v[184:187]
    v_mfma_f32_16x16x32_bf16 v[188:191], a[224:227], v[128:131], v[188:191]
    s_waitcnt lgkmcnt(4)
    v_add_f32 v230, v230, v144
    v_mfma_f32_16x16x32_bf16 v[192:195], a[228:231], v[128:131], v[192:195]
    buffer_load_dwordx4 v[112:115], v218, s[4:7], s62 offen offset:1024 sc1
    v_mfma_f32_16x16x32_bf16 v[196:199], a[232:235], v[128:131], v[196:199]
    v_add_f32 v231, v231, v145
    v_add_f32 v232, v232, v146
    v_mfma_f32_16x16x32_bf16 v[200:203], a[236:239], v[128:131], v[200:203]
    s_waitcnt vmcnt(6)
    v_add_f32 v233, v233, v147
    v_mfma_f32_16x16x32_bf16 v[184:187], v[0:3], v[132:135], v[184:187]
    s_waitcnt lgkmcnt(3)
    v_add_f32 v234, v234, v148
    v_mfma_f32_16x16x32_bf16 v[188:191], v[4:7], v[132:135], v[188:191]
    buffer_load_dwordx4 v[116:119], v218, s[4:7], s62 offen offset:2048 sc1
    v_mfma_f32_16x16x32_bf16 v[192:195], v[8:11], v[132:135], v[192:195]
    v_add_f32 v235, v235, v149
    v_add_f32 v236, v236, v150
    v_mfma_f32_16x16x32_bf16 v[196:199], v[12:15], v[132:135], v[196:199]
    v_add_f32 v237, v237, v151
    v_mfma_f32_16x16x32_bf16 v[200:203], v[16:19], v[132:135], v[200:203]
    s_waitcnt vmcnt(6)
    s_waitcnt lgkmcnt(2)
    v_add_f32 v238, v238, v152
    v_mfma_f32_16x16x32_bf16 v[184:187], v[20:23], v[136:139], v[184:187]
    buffer_load_dwordx4 v[120:123], v218, s[4:7], s62 offen offset:3072 sc1
    v_mfma_f32_16x16x32_bf16 v[188:191], v[24:27], v[136:139], v[188:191]
    v_add_f32 v239, v239, v153
    v_add_f32 v240, v240, v154
    v_mfma_f32_16x16x32_bf16 v[192:195], v[28:31], v[136:139], v[192:195]
    v_add_f32 v241, v241, v155
    v_mfma_f32_16x16x32_bf16 v[196:199], v[32:35], v[136:139], v[196:199]
    s_waitcnt lgkmcnt(1)
    v_add_f32 v242, v242, v156
    v_mfma_f32_16x16x32_bf16 v[200:203], v[36:39], v[136:139], v[200:203]
    s_waitcnt vmcnt(6)
    v_add_f32 v243, v243, v157
    v_mfma_f32_16x16x32_bf16 v[184:187], v[40:43], v[140:143], v[184:187]
    s_add_u32 s62, s92, 4096
    buffer_load_dwordx4 v[124:127], v218, s[4:7], s62 offen offset:0 sc1
    v_mfma_f32_16x16x32_bf16 v[188:191], v[44:47], v[140:143], v[188:191]
    v_add_f32 v244, v244, v158
    v_add_f32 v245, v245, v159
    v_mfma_f32_16x16x32_bf16 v[192:195], v[48:51], v[140:143], v[192:195]
    s_waitcnt lgkmcnt(0)
    v_add_f32 v246, v246, v160
    v_mfma_f32_16x16x32_bf16 v[196:199], v[52:55], v[140:143], v[196:199]
    v_add_f32 v247, v247, v161
    v_mfma_f32_16x16x32_bf16 v[200:203], v[56:59], v[140:143], v[200:203]
    s_waitcnt vmcnt(6)
    v_add_f32 v248, v248, v162
    v_mfma_f32_16x16x32_bf16 v[184:187], v[60:63], v[100:103], v[184:187]
    buffer_load_dwordx4 v[128:131], v218, s[4:7], s62 offen offset:1024 sc1
    v_mfma_f32_16x16x32_bf16 v[188:191], v[64:67], v[100:103], v[188:191]
    v_add_f32 v249, v249, v163
    v_mfma_f32_16x16x32_bf16 v[192:195], v[68:71], v[100:103], v[192:195]
    v_mfma_f32_16x16x32_bf16 v[196:199], v[72:75], v[100:103], v[196:199]
    v_mfma_f32_16x16x32_bf16 v[200:203], v[76:79], v[100:103], v[200:203]
    s_waitcnt vmcnt(6)
    s_and_b32 s35, s72, 3
    v_mfma_f32_16x16x32_bf16 v[184:187], v[80:83], v[104:107], v[184:187]
    s_mul_i32 s35, s35, 10240
    buffer_load_dwordx4 v[132:135], v218, s[4:7], s62 offen offset:2048 sc1
    v_mfma_f32_16x16x32_bf16 v[188:191], v[84:87], v[104:107], v[188:191]
    s_add_u32 s35, s35, 117760
    v_mfma_f32_16x16x32_bf16 v[192:195], v[88:91], v[104:107], v[192:195]
    v_add_u32 v223, s35, v218
    v_mfma_f32_16x16x32_bf16 v[196:199], v[92:95], v[104:107], v[196:199]
    v_mfma_f32_16x16x32_bf16 v[200:203], v[96:99], v[104:107], v[200:203]
    s_waitcnt vmcnt(6)
    buffer_load_dwordx4 v[136:139], v218, s[4:7], s62 offen offset:3072 sc1
    v_mfma_f32_16x16x32_bf16 v[164:167], a[100:103], v[108:111], 0
    s_barrier
    ds_read_b128 v[144:147], v219 offset:0
    ds_read_b128 v[148:151], v219 offset:1024
    v_mfma_f32_16x16x32_bf16 v[168:171], a[104:107], v[108:111], 0
    ds_read_b128 v[152:155], v219 offset:2048
    ds_read_b128 v[156:159], v219 offset:3072
    v_mfma_f32_16x16x32_bf16 v[172:175], a[108:111], v[108:111], 0
    ds_write_b128 v223, v[184:187] offset:0
    v_mfma_f32_16x16x32_bf16 v[176:179], a[112:115], v[108:111], 0
    ds_read_b128 v[160:163], v219 offset:4096
    v_mfma_f32_16x16x32_bf16 v[180:183], a[116:119], v[108:111], 0
    s_waitcnt vmcnt(6)
    s_add_u32 s62, s92, 8192
    v_mfma_f32_16x16x32_bf16 v[164:167], a[120:123], v[112:115], v[164:167]
    buffer_load_dwordx4 v[140:143], v218, s[4:7], s62 offen offset:0 sc1
    v_mfma_f32_16x16x32_bf16 v[168:171], a[124:127], v[112:115], v[168:171]
    ds_write_b128 v223, v[188:191] offset:1024
    v_mfma_f32_16x16x32_bf16 v[172:175], a[128:131], v[112:115], v[172:175]
    ds_write_b128 v223, v[192:195] offset:2048
    v_mfma_f32_16x16x32_bf16 v[176:179], a[132:135], v[112:115], v[176:179]
    s_waitcnt lgkmcnt(7)
    v_add_f32 v230, v230, v144
    v_add_f32 v231, v231, v145
    v_mfma_f32_16x16x32_bf16 v[180:183], a[136:139], v[112:115], v[180:183]
    s_waitcnt vmcnt(6)
    buffer_load_dwordx4 v[100:103], v218, s[4:7], s62 offen offset:1024 sc1
    v_mfma_f32_16x16x32_bf16 v[164:167], a[140:143], v[116:119], v[164:167]
    v_add_f32 v232, v232, v146
    v_mfma_f32_16x16x32_bf16 v[168:171], a[144:147], v[116:119], v[168:171]
    ds_write_b128 v223, v[196:199] offset:3072
    v_mfma_f32_16x16x32_bf16 v[172:175], a[148:151], v[116:119], v[172:175]
    v_add_f32 v233, v233, v147
    v_mfma_f32_16x16x32_bf16 v[176:179], a[152:155], v[116:119], v[176:179]
    s_waitcnt lgkmcnt(7)
    v_add_f32 v234, v234, v148
    v_add_f32 v235, v235, v149
    v_mfma_f32_16x16x32_bf16 v[180:183], a[156:159], v[116:119], v[180:183]
    s_waitcnt vmcnt(6)
    buffer_load_dwordx4 v[104:107], v218, s[4:7], s62 offen offset:2048 sc1
    v_mfma_f32_16x16x32_bf16 v[164:167], a[160:163], v[120:123], v[164:167]
    ds_write_b128 v223, v[200:203] offset:4096
    v_add_f32 v236, v236, v150
    v_mfma_f32_16x16x32_bf16 v[168:171], a[164:167], v[120:123], v[168:171]
    v_add_f32 v237, v237, v151
    v_mfma_f32_16x16x32_bf16 v[172:175], a[168:171], v[120:123], v[172:175]
    s_waitcnt lgkmcnt(7)
    v_add_f32 v238, v238, v152
    v_add_f32 v239, v239, v153
    v_mfma_f32_16x16x32_bf16 v[176:179], a[172:175], v[120:123], v[176:179]
    v_add_f32 v240, v240, v154
    v_add_f32 v241, v241, v155
    v_mfma_f32_16x16x32_bf16 v[180:183], a[176:179], v[120:123], v[180:183]
    s_waitcnt vmcnt(6)
    buffer_load_dwordx4 v[108:111], v218, s[4:7], s62 offen offset:3072 sc1
    v_mfma_f32_16x16x32_bf16 v[164:167], a[180:183], v[124:127], v[164:167]
    s_waitcnt lgkmcnt(6)
    v_add_f32 v242, v242, v156
    v_add_f32 v243, v243, v157
    v_mfma_f32_16x16x32_bf16 v[168:171], a[184:187], v[124:127], v[168:171]
    v_add_f32 v244, v244, v158
    v_mfma_f32_16x16x32_bf16 v[172:175], a[188:191], v[124:127], v[172:175]
    v_add_f32 v245, v245, v159
    v_mfma_f32_16x16x32_bf16 v[176:179], a[192:195], v[124:127], v[176:179]
    s_waitcnt lgkmcnt(4)
    v_add_f32 v246, v246, v160
    v_mfma_f32_16x16x32_bf16 v[180:183], a[196:199], v[124:127], v[180:183]
    s_waitcnt vmcnt(6)
    s_add_u32 s62, s93, 0
    v_add_f32 v247, v247, v161
    v_mfma_f32_16x16x32_bf16 v[164:167], a[200:203], v[128:131], v[164:167]
    buffer_load_dwordx4 v[112:115], v218, s[4:7], s62 offen offset:0 sc1
    v_mfma_f32_16x16x32_bf16 v[168:171], a[204:207], v[128:131], v[168:171]
    v_add_f32 v248, v248, v162
    v_add_f32 v249, v249, v163
    v_mfma_f32_16x16x32_bf16 v[172:175], a[208:211], v[128:131], v[172:175]
    v_mfma_f32_16x16x32_bf16 v[176:179], a[212:215], v[128:131], v[176:179]
    buffer_load_dwordx4 v[116:119], v218, s[4:7], s62 offen offset:1024 sc1
    v_mfma_f32_16x16x32_bf16 v[180:183], a[216:219], v[128:131], v[180:183]
    s_waitcnt vmcnt(7)
    v_mfma_f32_16x16x32_bf16 v[164:167], a[220:223], v[132:135], v[164:167]
    v_mfma_f32_16x16x32_bf16 v[168:171], a[224:227], v[132:135], v[168:171]
    v_mfma_f32_16x16x32_bf16 v[172:175], a[228:231], v[132:135], v[172:175]
    v_mfma_f32_16x16x32_bf16 v[176:179], a[232:235], v[132:135], v[176:179]
    buffer_load_dwordx4 v[120:123], v218, s[4:7], s62 offen offset:2048 sc1
    v_mfma_f32_16x16x32_bf16 v[180:183], a[236:239], v[132:135], v[180:183]
    s_waitcnt vmcnt(7)
    v_mfma_f32_16x16x32_bf16 v[164:167], v[0:3], v[136:139], v[164:167]
    v_mfma_f32_16x16x32_bf16 v[168:171], v[4:7], v[136:139], v[168:171]
    v_mfma_f32_16x16x32_bf16 v[172:175], v[8:11], v[136:139], v[172:175]
    v_mfma_f32_16x16x32_bf16 v[176:179], v[12:15], v[136:139], v[176:179]
    buffer_load_dwordx4 v[124:127], v218, s[4:7], s62 offen offset:3072 sc1
    v_mfma_f32_16x16x32_bf16 v[180:183], v[16:19], v[136:139], v[180:183]
    s_waitcnt vmcnt(7)
    v_mfma_f32_16x16x32_bf16 v[164:167], v[20:23], v[140:143], v[164:167]
    v_mfma_f32_16x16x32_bf16 v[168:171], v[24:27], v[140:143], v[168:171]
    v_mfma_f32_16x16x32_bf16 v[172:175], v[28:31], v[140:143], v[172:175]
    v_mfma_f32_16x16x32_bf16 v[176:179], v[32:35], v[140:143], v[176:179]
    s_add_u32 s62, s93, 4096
    buffer_load_dwordx4 v[128:131], v218, s[4:7], s62 offen offset:0 sc1
    v_mfma_f32_16x16x32_bf16 v[180:183], v[36:39], v[140:143], v[180:183]
    s_waitcnt vmcnt(7)
    v_mfma_f32_16x16x32_bf16 v[164:167], v[40:43], v[100:103], v[164:167]
    v_mfma_f32_16x16x32_bf16 v[168:171], v[44:47], v[100:103], v[168:171]
    v_mfma_f32_16x16x32_bf16 v[172:175], v[48:51], v[100:103], v[172:175]
    v_mfma_f32_16x16x32_bf16 v[176:179], v[52:55], v[100:103], v[176:179]
    buffer_load_dwordx4 v[132:135], v218, s[4:7], s62 offen offset:1024 sc1
    v_mfma_f32_16x16x32_bf16 v[180:183], v[56:59], v[100:103], v[180:183]
    s_waitcnt vmcnt(7)
    v_mfma_f32_16x16x32_bf16 v[164:167], v[60:63], v[104:107], v[164:167]
    v_mfma_f32_16x16x32_bf16 v[168:171], v[64:67], v[104:107], v[168:171]
    v_mfma_f32_16x16x32_bf16 v[172:175], v[68:71], v[104:107], v[172:175]
    buffer_load_dwordx4 v[136:139], v218, s[4:7], s62 offen offset:2048 sc1
    v_mfma_f32_16x16x32_bf16 v[176:179], v[72:75], v[104:107], v[176:179]
    v_mfma_f32_16x16x32_bf16 v[180:183], v[76:79], v[104:107], v[180:183]
    s_waitcnt vmcnt(7)
    s_and_b32 s35, s73, 3
    v_mfma_f32_16x16x32_bf16 v[164:167], v[80:83], v[108:111], v[164:167]
    s_mul_i32 s35, s35, 10240
    v_mfma_f32_16x16x32_bf16 v[168:171], v[84:87], v[108:111], v[168:171]
    s_add_u32 s35, s35, 112640
    v_mfma_f32_16x16x32_bf16 v[172:175], v[88:91], v[108:111], v[172:175]
    buffer_load_dwordx4 v[140:143], v218, s[4:7], s62 offen offset:3072 sc1
    v_mfma_f32_16x16x32_bf16 v[176:179], v[92:95], v[108:111], v[176:179]
    v_add_u32 v223, s35, v218
    v_mfma_f32_16x16x32_bf16 v[180:183], v[96:99], v[108:111], v[180:183]
    s_waitcnt vmcnt(7)
    s_waitcnt lgkmcnt(0)
    s_barrier
    ds_read_b128 v[184:187], v219 offset:5120
    v_mfma_f32_16x16x32_bf16 v[230:233], a[100:103], v[112:115], v[230:233]
    ds_read_b128 v[188:191], v219 offset:6144
    ds_read_b128 v[192:195], v219 offset:7168
    v_mfma_f32_16x16x32_bf16 v[234:237], a[104:107], v[112:115], v[234:237]
    ds_read_b128 v[196:199], v219 offset:8192
    v_mfma_f32_16x16x32_bf16 v[238:241], a[108:111], v[112:115], v[238:241]
    s_add_u32 s62, s93, 8192
    buffer_load_dwordx4 v[100:103], v218, s[4:7], s62 offen offset:0 sc1
    v_mfma_f32_16x16x32_bf16 v[242:245], a[112:115], v[112:115], v[242:245]
    ds_write_b128 v223, v[164:167] offset:0
    ds_read_b128 v[200:203], v219 offset:9216
    v_mfma_f32_16x16x32_bf16 v[246:249], a[116:119], v[112:115], v[246:249]
    s_waitcnt vmcnt(7)
    ds_write_b128 v223, v[168:171] offset:1024
    v_mfma_f32_16x16x32_bf16 v[230:233], a[120:123], v[116:119], v[230:233]
    v_mfma_f32_16x16x32_bf16 v[234:237], a[124:127], v[116:119], v[234:237]
    v_mfma_f32_16x16x32_bf16 v[238:241], a[128:131], v[116:119], v[238:241]
    buffer_load_dwordx4 v[104:107], v218, s[4:7], s62 offen offset:1024 sc1
    v_mfma_f32_16x16x32_bf16 v[242:245], a[132:135], v[116:119], v[242:245]
    ds_write_b128 v223, v[172:175] offset:2048
    v_mfma_f32_16x16x32_bf16 v[246:249], a[136:139], v[116:119], v[246:249]
    s_waitcnt vmcnt(7)
    v_mfma_f32_16x16x32_bf16 v[230:233], a[140:143], v[120:123], v[230:233]
    ds_write_b128 v223, v[176:179] offset:3072
    v_mfma_f32_16x16x32_bf16 v[234:237], a[144:147], v[120:123], v[234:237]
    v_mfma_f32_16x16x32_bf16 v[238:241], a[148:151], v[120:123], v[238:241]
    buffer_load_dwordx4 v[108:111], v218, s[4:7], s62 offen offset:2048 sc1
    v_mfma_f32_16x16x32_bf16 v[242:245], a[152:155], v[120:123], v[242:245]
    ds_write_b128 v223, v[180:183] offset:4096
    v_mfma_f32_16x16x32_bf16 v[246:249], a[156:159], v[120:123], v[246:249]
    s_waitcnt vmcnt(7)
    v_mfma_f32_16x16x32_bf16 v[230:233], a[160:163], v[124:127], v[230:233]
    v_mfma_f32_16x16x32_bf16 v[234:237], a[164:167], v[124:127], v[234:237]
    s_waitcnt lgkmcnt(0)
    buffer_load_dwordx4 v[112:115], v218, s[4:7], s62 offen offset:3072 sc1
    v_mfma_f32_16x16x32_bf16 v[238:241], a[168:171], v[124:127], v[238:241]
    s_barrier
    ds_read_b128 v[164:167], v219 offset:0
    ds_read_b128 v[168:171], v219 offset:1024
    v_mfma_f32_16x16x32_bf16 v[242:245], a[172:175], v[124:127], v[242:245]
    ds_read_b128 v[172:175], v219 offset:2048
    ds_read_b128 v[176:179], v219 offset:3072
    v_mfma_f32_16x16x32_bf16 v[246:249], a[176:179], v[124:127], v[246:249]
    s_waitcnt vmcnt(7)
    ds_read_b128 v[180:183], v219 offset:4096
    ds_read_b32 v223, v224 offset:3080
    v_mfma_f32_16x16x32_bf16 v[230:233], a[180:183], v[128:131], v[230:233]
    v_mfma_f32_16x16x32_bf16 v[234:237], a[184:187], v[128:131], v[234:237]
    v_mfma_f32_16x16x32_bf16 v[238:241], a[188:191], v[128:131], v[238:241]
    v_mfma_f32_16x16x32_bf16 v[242:245], a[192:195], v[128:131], v[242:245]
    v_mfma_f32_16x16x32_bf16 v[246:249], a[196:199], v[128:131], v[246:249]
    s_waitcnt vmcnt(6)
    v_mfma_f32_16x16x32_bf16 v[230:233], a[200:203], v[132:135], v[230:233]
    v_mfma_f32_16x16x32_bf16 v[234:237], a[204:207], v[132:135], v[234:237]
    s_waitcnt lgkmcnt(5)
    v_add_f32 v184, v184, v164
    v_mfma_f32_16x16x32_bf16 v[238:241], a[208:211], v[132:135], v[238:241]
    v_add_f32 v185, v185, v165
    v_mfma_f32_16x16x32_bf16 v[242:245], a[212:215], v[132:135], v[242:245]
    v_add_f32 v186, v186, v166
    v_mfma_f32_16x16x32_bf16 v[246:249], a[216:219], v[132:135], v[246:249]
    s_waitcnt vmcnt(5)
    v_add_f32 v187, v187, v167
    v_mfma_f32_16x16x32_bf16 v[230:233], a[220:223], v[136:139], v[230:233]
    s_waitcnt lgkmcnt(4)
    v_add_f32 v188, v188, v168
    v_mfma_f32_16x16x32_bf16 v[234:237], a[224:227], v[136:139], v[234:237]
    v_add_f32 v189, v189, v169
    v_mfma_f32_16x16x32_bf16 v[238:241], a[228:231], v[136:139], v[238:241]
    v_add_f32 v190, v190, v170
    v_mfma_f32_16x16x32_bf16 v[242:245], a[232:235], v[136:139], v[242:245]
    v_add_f32 v191, v191, v171
    v_mfma_f32_16x16x32_bf16 v[246:249], a[236:239], v[136:139], v[246:249]
    s_waitcnt vmcnt(4)
    s_waitcnt lgkmcnt(3)
    v_add_f32 v192, v192, v172
    v_mfma_f32_16x16x32_bf16 v[230:233], v[0:3], v[140:143], v[230:233]
    v_add_f32 v193, v193, v173
    v_mfma_f32_16x16x32_bf16 v[234:237], v[4:7], v[140:143], v[234:237]
    v_add_f32 v194, v194, v174
    v_mfma_f32_16x16x32_bf16 v[238:241], v[8:11], v[140:143], v[238:241]
    v_add_f32 v195, v195, v175
    v_mfma_f32_16x16x32_bf16 v[242:245], v[12:15], v[140:143], v[242:245]
    s_waitcnt lgkmcnt(2)
    v_add_f32 v196, v196, v176
    v_mfma_f32_16x16x32_bf16 v[246:249], v[16:19], v[140:143], v[246:249]
    s_waitcnt vmcnt(3)
    v_add_f32 v197, v197, v177
    v_mfma_f32_16x16x32_bf16 v[230:233], v[20:23], v[100:103], v[230:233]
    v_add_f32 v198, v198, v178
    v_mfma_f32_16x16x32_bf16 v[234:237], v[24:27], v[100:103], v[234:237]
    v_add_f32 v199, v199, v179
    v_mfma_f32_16x16x32_bf16 v[238:241], v[28:31], v[100:103], v[238:241]
    s_waitcnt lgkmcnt(1)
    v_add_f32 v200, v200, v180
    v_mfma_f32_16x16x32_bf16 v[242:245], v[32:35], v[100:103], v[242:245]
    v_add_f32 v201, v201, v181
    v_mfma_f32_16x16x32_bf16 v[246:249], v[36:39], v[100:103], v[246:249]
    s_waitcnt vmcnt(2)
    v_add_f32 v202, v202, v182
    v_mfma_f32_16x16x32_bf16 v[230:233], v[40:43], v[104:107], v[230:233]
    v_add_f32 v203, v203, v183
    v_mfma_f32_16x16x32_bf16 v[234:237], v[44:47], v[104:107], v[234:237]
    v_mfma_f32_16x16x32_bf16 v[238:241], v[48:51], v[104:107], v[238:241]
    v_mfma_f32_16x16x32_bf16 v[242:245], v[52:55], v[104:107], v[242:245]
    v_mfma_f32_16x16x32_bf16 v[246:249], v[56:59], v[104:107], v[246:249]
    s_waitcnt vmcnt(1)
    v_mfma_f32_16x16x32_bf16 v[230:233], v[60:63], v[108:111], v[230:233]
    v_mfma_f32_16x16x32_bf16 v[234:237], v[64:67], v[108:111], v[234:237]
    v_mfma_f32_16x16x32_bf16 v[238:241], v[68:71], v[108:111], v[238:241]
    v_mfma_f32_16x16x32_bf16 v[242:245], v[72:75], v[108:111], v[242:245]
    v_mfma_f32_16x16x32_bf16 v[246:249], v[76:79], v[108:111], v[246:249]
    s_waitcnt vmcnt(0)
    v_mfma_f32_16x16x32_bf16 v[230:233], v[80:83], v[112:115], v[230:233]
    v_mfma_f32_16x16x32_bf16 v[234:237], v[84:87], v[112:115], v[234:237]
    v_mfma_f32_16x16x32_bf16 v[238:241], v[88:91], v[112:115], v[238:241]
    v_mfma_f32_16x16x32_bf16 v[242:245], v[92:95], v[112:115], v[242:245]
    v_mfma_f32_16x16x32_bf16 v[246:249], v[96:99], v[112:115], v[246:249]
    s_nop 3
    v_pk_add_f32 v[230:231], v[230:231], v[184:185]
    v_cvt_pk_bf16_f32 v208, v230, v231
    v_pk_add_f32 v[232:233], v[232:233], v[186:187]
    v_cvt_pk_bf16_f32 v209, v232, v233
    v_pk_add_f32 v[234:235], v[234:235], v[188:189]
    v_cvt_pk_bf16_f32 v210, v234, v235
    v_pk_add_f32 v[236:237], v[236:237], v[190:191]
    v_cvt_pk_bf16_f32 v211, v236, v237
    buffer_store_dwordx4 v[208:211], v204, s[20:23], s88 offen
    v_pk_add_f32 v[238:239], v[238:239], v[192:193]
    v_cvt_pk_bf16_f32 v212, v238, v239
    v_pk_add_f32 v[240:241], v[240:241], v[194:195]
    v_cvt_pk_bf16_f32 v213, v240, v241
    v_pk_add_f32 v[242:243], v[242:243], v[196:197]
    v_cvt_pk_bf16_f32 v214, v242, v243
    v_pk_add_f32 v[244:245], v[244:245], v[198:199]
    v_cvt_pk_bf16_f32 v215, v244, v245
    buffer_store_dwordx4 v[212:215], v204, s[20:23], s88 offen offset:64
    v_pk_add_f32 v[246:247], v[246:247], v[200:201]
    v_cvt_pk_bf16_f32 v216, v246, v247
    v_pk_add_f32 v[248:249], v[248:249], v[202:203]
    v_cvt_pk_bf16_f32 v217, v248, v249
    buffer_store_dwordx2 v[216:217], v206, s[20:23], s89 offen
L_finish:
    s_cmp_eq_u32 s2, 0
    s_mov_b32 s60, 7766016
    s_cselect_b32 s35, s60, 1073741824
    s_mov_b64 exec, 1
    s_waitcnt lgkmcnt(0)
    v_mov_b32 v223, s28
    buffer_store_dword v223, off, s[4:7], s35 sc1
    s_mov_b64 exec, -1
    s_endpgm
L_role_fix:
    s_waitcnt vmcnt(0)
    s_barrier
    s_mov_b32 s3, -1
    v_lshrrev_b32 v0, 4, v218
    v_mul_u32_u24 v1, 32, v0
    s_mov_b32 s35, 7700484
    buffer_load_dword v2, v1, s[4:7], s35 offen sc1
    s_add_u32 s35, s35, 2048
    buffer_load_dword v3, v1, s[4:7], s35 offen sc1
    s_add_u32 s35, s35, 2048
    buffer_load_dword v4, v1, s[4:7], s35 offen sc1
    s_add_u32 s35, s35, 2048
    buffer_load_dword v5, v1, s[4:7], s35 offen sc1
    s_add_u32 s35, s35, 2048
    s_min_u32 s25, s25, 8
    s_mov_b32 s26, 0
    s_waitcnt vmcnt(0)
    s_mov_b32 s66, 0
    s_mov_b32 s67, 0
    s_mov_b32 s68, 0
    s_mov_b32 s69, 0
    s_mov_b32 s70, 0
    s_mov_b32 s71, 0
    s_mov_b32 s72, 0
    s_mov_b32 s73, 0
    s_mov_b32 s74, 0
    v_and_b32 v2, 15, v2
    v_min_u32 v2, 8, v2
    v_cmp_eq_u32 vcc, 0, v2
    s_bcnt1_i32_b64 s35, vcc
    s_add_u32 s66, s66, s35
    v_cmp_eq_u32 vcc, 1, v2
    s_bcnt1_i32_b64 s35, vcc
    s_add_u32 s67, s67, s35
    v_cmp_eq_u32 vcc, 2, v2
    s_bcnt1_i32_b64 s35, vcc
    s_add_u32 s68, s68, s35
    v_cmp_eq_u32 vcc, 3, v2
    s_bcnt1_i32_b64 s35, vcc
    s_add_u32 s69, s69, s35
    v_cmp_eq_u32 vcc, 4, v2
    s_bcnt1_i32_b64 s35, vcc
    s_add_u32 s70, s70, s35
    v_cmp_eq_u32 vcc, 5, v2
    s_bcnt1_i32_b64 s35, vcc
    s_add_u32 s71, s71, s35
    v_cmp_eq_u32 vcc, 6, v2
    s_bcnt1_i32_b64 s35, vcc
    s_add_u32 s72, s72, s35
    v_cmp_eq_u32 vcc, 7, v2
    s_bcnt1_i32_b64 s35, vcc
    s_add_u32 s73, s73, s35
    v_cmp_eq_u32 vcc, 8, v2
    s_bcnt1_i32_b64 s35, vcc
    s_add_u32 s74, s74, s35
    v_add_u32 v1, 0, v0
    v_cmp_gt_u32 s[92:93], s2, v1
    v_cmp_eq_u32 vcc, s25, v2
    s_and_b64 vcc, vcc, s[92:93]
    s_bcnt1_i32_b64 s35, vcc
    s_add_u32 s26, s26, s35
    v_and_b32 v3, 15, v3
    v_min_u32 v3, 8, v3
    v_cmp_eq_u32 vcc, 0, v3
    s_bcnt1_i32_b64 s35, vcc
    s_add_u32 s66, s66, s35
    v_cmp_eq_u32 vcc, 1, v3
    s_bcnt1_i32_b64 s35, vcc
    s_add_u32 s67, s67, s35
    v_cmp_eq_u32 vcc, 2, v3
    s_bcnt1_i32_b64 s35, vcc
    s_add_u32 s68, s68, s35
    v_cmp_eq_u32 vcc, 3, v3
    s_bcnt1_i32_b64 s35, vcc
    s_add_u32 s69, s69, s35
    v_cmp_eq_u32 vcc, 4, v3
    s_bcnt1_i32_b64 s35, vcc
    s_add_u32 s70, s70, s35
    v_cmp_eq_u32 vcc, 5, v3
    s_bcnt1_i32_b64 s35, vcc
    s_add_u32 s71, s71, s35
    v_cmp_eq_u32 vcc, 6, v3
    s_bcnt1_i32_b64 s35, vcc
    s_add_u32 s72, s72, s35
    v_cmp_eq_u32 vcc, 7, v3
    s_bcnt1_i32_b64 s35, vcc
    s_add_u32 s73, s73, s35
    v_cmp_eq_u32 vcc, 8, v3
    s_bcnt1_i32_b64 s35, vcc
    s_add_u32 s74, s74, s35
    v_add_u32 v1, 64, v0
    v_cmp_gt_u32 s[92:93], s2, v1
    v_cmp_eq_u32 vcc, s25, v3
    s_and_b64 vcc, vcc, s[92:93]
    s_bcnt1_i32_b64 s35, vcc
    s_add_u32 s26, s26, s35
    v_and_b32 v4, 15, v4
    v_min_u32 v4, 8, v4
    v_cmp_eq_u32 vcc, 0, v4
    s_bcnt1_i32_b64 s35, vcc
    s_add_u32 s66, s66, s35
    v_cmp_eq_u32 vcc, 1, v4
    s_bcnt1_i32_b64 s35, vcc
    s_add_u32 s67, s67, s35
    v_cmp_eq_u32 vcc, 2, v4
    s_bcnt1_i32_b64 s35, vcc
    s_add_u32 s68, s68, s35
    v_cmp_eq_u32 vcc, 3, v4
    s_bcnt1_i32_b64 s35, vcc
    s_add_u32 s69, s69, s35
    v_cmp_eq_u32 vcc, 4, v4
    s_bcnt1_i32_b64 s35, vcc
    s_add_u32 s70, s70, s35
    v_cmp_eq_u32 vcc, 5, v4
    s_bcnt1_i32_b64 s35, vcc
    s_add_u32 s71, s71, s35
    v_cmp_eq_u32 vcc, 6, v4
    s_bcnt1_i32_b64 s35, vcc
    s_add_u32 s72, s72, s35
    v_cmp_eq_u32 vcc, 7, v4
    s_bcnt1_i32_b64 s35, vcc
    s_add_u32 s73, s73, s35
    v_cmp_eq_u32 vcc, 8, v4
    s_bcnt1_i32_b64 s35, vcc
    s_add_u32 s74, s74, s35
    v_add_u32 v1, 128, v0
    v_cmp_gt_u32 s[92:93], s2, v1
    v_cmp_eq_u32 vcc, s25, v4
    s_and_b64 vcc, vcc, s[92:93]
    s_bcnt1_i32_b64 s35, vcc
    s_add_u32 s26, s26, s35
    v_and_b32 v5, 15, v5
    v_min_u32 v5, 8, v5
    v_cmp_eq_u32 vcc, 0, v5
    s_bcnt1_i32_b64 s35, vcc
    s_add_u32 s66, s66, s35
    v_cmp_eq_u32 vcc, 1, v5
    s_bcnt1_i32_b64 s35, vcc
    s_add_u32 s67, s67, s35
    v_cmp_eq_u32 vcc, 2, v5
    s_bcnt1_i32_b64 s35, vcc
    s_add_u32 s68, s68, s35
    v_cmp_eq_u32 vcc, 3, v5
    s_bcnt1_i32_b64 s35, vcc
    s_add_u32 s69, s69, s35
    v_cmp_eq_u32 vcc, 4, v5
    s_bcnt1_i32_b64 s35, vcc
    s_add_u32 s70, s70, s35
    v_cmp_eq_u32 vcc, 5, v5
    s_bcnt1_i32_b64 s35, vcc
    s_add_u32 s71, s71, s35
    v_cmp_eq_u32 vcc, 6, v5
    s_bcnt1_i32_b64 s35, vcc
    s_add_u32 s72, s72, s35
    v_cmp_eq_u32 vcc, 7, v5
    s_bcnt1_i32_b64 s35, vcc
    s_add_u32 s73, s73, s35
    v_cmp_eq_u32 vcc, 8, v5
    s_bcnt1_i32_b64 s35, vcc
    s_add_u32 s74, s74, s35
    v_add_u32 v1, 192, v0
    v_cmp_gt_u32 s[92:93], s2, v1
    v_cmp_eq_u32 vcc, s25, v5
    s_and_b64 vcc, vcc, s[92:93]
    s_bcnt1_i32_b64 s35, vcc
    s_add_u32 s26, s26, s35
    s_cmp_ge_u32 s25, 8
    s_cbranch_scc1 L_role_extra
    s_cmp_ge_u32 s26, 32
    s_cbranch_scc1 L_role_extra
    s_cmp_eq_u32 s25, 0
    s_cselect_b32 s35, s66, s35
    s_cmp_eq_u32 s25, 1
    s_cselect_b32 s35, s67, s35
    s_cmp_eq_u32 s25, 2
    s_cselect_b32 s35, s68, s35
    s_cmp_eq_u32 s25, 3
    s_cselect_b32 s35, s69, s35
    s_cmp_eq_u32 s25, 4
    s_cselect_b32 s35, s70, s35
    s_cmp_eq_u32 s25, 5
    s_cselect_b32 s35, s71, s35
    s_cmp_eq_u32 s25, 6
    s_cselect_b32 s35, s72, s35
    s_cmp_eq_u32 s25, 7
    s_cselect_b32 s35, s73, s35
    s_cmp_lt_u32 s35, 32
    s_cselect_b32 s27, 1, s27
    s_branch L_role_done
L_role_extra:
    s_mov_b32 s27, 1
    s_sub_u32 s60, s26, 32
    s_cmp_lt_u32 s25, 8
    s_cselect_b32 s60, s60, s26
    s_max_u32 s35, s66, 32
    s_sub_u32 s35, s35, 32
    s_cmp_gt_u32 s25, 0
    s_cselect_b32 s35, s35, 0
    s_add_u32 s60, s60, s35
    s_max_u32 s35, s67, 32
    s_sub_u32 s35, s35, 32
    s_cmp_gt_u32 s25, 1
    s_cselect_b32 s35, s35, 0
    s_add_u32 s60, s60, s35
    s_max_u32 s35, s68, 32
    s_sub_u32 s35, s35, 32
    s_cmp_gt_u32 s25, 2
    s_cselect_b32 s35, s35, 0
    s_add_u32 s60, s60, s35
    s_max_u32 s35, s69, 32
    s_sub_u32 s35, s35, 32
    s_cmp_gt_u32 s25, 3
    s_cselect_b32 s35, s35, 0
    s_add_u32 s60, s60, s35
    s_max_u32 s35, s70, 32
    s_sub_u32 s35, s35, 32
    s_cmp_gt_u32 s25, 4
    s_cselect_b32 s35, s35, 0
    s_add_u32 s60, s60, s35
    s_max_u32 s35, s71, 32
    s_sub_u32 s35, s35, 32
    s_cmp_gt_u32 s25, 5
    s_cselect_b32 s35, s35, 0
    s_add_u32 s60, s60, s35
    s_max_u32 s35, s72, 32
    s_sub_u32 s35, s35, 32
    s_cmp_gt_u32 s25, 6
    s_cselect_b32 s35, s35, 0
    s_add_u32 s60, s60, s35
    s_max_u32 s35, s73, 32
    s_sub_u32 s35, s35, 32
    s_cmp_gt_u32 s25, 7
    s_cselect_b32 s35, s35, 0
    s_add_u32 s60, s60, s35
    s_min_u32 s35, s66, 32
    s_add_u32 s26, s35, s60
    s_mov_b32 s25, 0
    s_cmp_lt_u32 s26, 32
    s_cbranch_scc1 L_role_done
    s_sub_u32 s60, s26, 32
    s_min_u32 s35, s67, 32
    s_add_u32 s26, s35, s60
    s_mov_b32 s25, 1
    s_cmp_lt_u32 s26, 32
    s_cbranch_scc1 L_role_done
    s_sub_u32 s60, s26, 32
    s_min_u32 s35, s68, 32
    s_add_u32 s26, s35, s60
    s_mov_b32 s25, 2
    s_cmp_lt_u32 s26, 32
    s_cbranch_scc1 L_role_done
    s_sub_u32 s60, s26, 32
    s_min_u32 s35, s69, 32
    s_add_u32 s26, s35, s60
    s_mov_b32 s25, 3
    s_cmp_lt_u32 s26, 32
    s_cbranch_scc1 L_role_done
    s_sub_u32 s60, s26, 32
    s_min_u32 s35, s70, 32
    s_add_u32 s26, s35, s60
    s_mov_b32 s25, 4
    s_cmp_lt_u32 s26, 32
    s_cbranch_scc1 L_role_done
    s_sub_u32 s60, s26, 32
    s_min_u32 s35, s71, 32
    s_add_u32 s26, s35, s60
    s_mov_b32 s25, 5
    s_cmp_lt_u32 s26, 32
    s_cbranch_scc1 L_role_done
    s_sub_u32 s60, s26, 32
    s_min_u32 s35, s72, 32
    s_add_u32 s26, s35, s60
    s_mov_b32 s25, 6
    s_cmp_lt_u32 s26, 32
    s_cbranch_scc1 L_role_done
    s_sub_u32 s60, s26, 32
    s_min_u32 s35, s73, 32
    s_add_u32 s26, s35, s60
    s_mov_b32 s25, 7
    s_cmp_lt_u32 s26, 32
    s_cbranch_scc1 L_role_done
    s_sub_u32 s60, s26, 32
    s_branch L_end
L_role_done:
    s_lshl_b32 s91, s25, 1
    s_lshr_b32 s35, s26, 4
    s_add_u32 s91, s91, s35
    s_lshl_b32 s91, s91, 2
    s_add_u32 s91, s91, s24
    s_mul_i32 s91, s91, 40960
    s_add_u32 m0, s90, 0
    s_add_u32 s98, s91, 0
    buffer_load_dwordx4 v240, s[20:23], s98 offen  lds
    buffer_load_dwordx4 v241, s[20:23], s98 offen offset:1024  lds
    s_add_u32 m0, s90, 2048
    s_add_u32 s98, s91, 20480
    buffer_load_dwordx4 v240, s[20:23], s98 offen  lds
    buffer_load_dwordx4 v241, s[20:23], s98 offen offset:1024  lds
    s_add_u32 m0, s90, 4096
    s_add_u32 s98, s91, 128
    buffer_load_dwordx4 v240, s[20:23], s98 offen  lds
    buffer_load_dwordx4 v241, s[20:23], s98 offen offset:1024  lds
    s_add_u32 m0, s90, 6144
    s_add_u32 s98, s91, 20608
    buffer_load_dwordx4 v240, s[20:23], s98 offen  lds
    buffer_load_dwordx4 v241, s[20:23], s98 offen offset:1024  lds
    s_add_u32 m0, s90, 8192
    s_add_u32 s98, s91, 256
    buffer_load_dwordx4 v240, s[20:23], s98 offen  lds
    buffer_load_dwordx4 v241, s[20:23], s98 offen offset:1024  lds
    s_add_u32 m0, s90, 10240
    s_add_u32 s98, s91, 20736
    buffer_load_dwordx4 v240, s[20:23], s98 offen  lds
    buffer_load_dwordx4 v241, s[20:23], s98 offen offset:1024  lds
    s_waitcnt vmcnt(0)
    s_branch L_reload_x
L_kvretry_9:
    s_mov_b32 s65, 262144
L_kvretry_9_loop:
    s_mov_b64 s[92:93], 0
    v_max3_u32 v230, v0, v1, v2
    v_max3_u32 v231, v4, v5, v6
    v_max3_u32 v232, v8, v9, v10
    v_max3_u32 v233, v12, v13, v14
    v_max3_u32 v234, v16, v17, v18
    v_max3_u32 v235, v20, v21, v22
    v_max3_u32 v236, v24, v25, v26
    v_max3_u32 v237, v28, v29, v30
    v_max3_u32 v238, v32, v33, v34
    v_max3_u32 v239, v36, v37, v38
    v_max3_u32 v240, v40, v41, v42
    v_max3_u32 v241, v44, v45, v46
    v_max3_u32 v242, v48, v49, v50
    v_max3_u32 v243, v52, v53, v54
    v_max3_u32 v244, v56, v57, v58
    v_max3_u32 v245, v60, v61, v62
    v_max_u32 v230, v230, v3
    v_max_u32 v231, v231, v7
    v_max_u32 v232, v232, v11
    v_max_u32 v233, v233, v15
    v_max_u32 v234, v234, v19
    v_max_u32 v235, v235, v23
    v_max_u32 v236, v236, v27
    v_max_u32 v237, v237, v31
    v_max_u32 v238, v238, v35
    v_max_u32 v239, v239, v39
    v_max_u32 v240, v240, v43
    v_max_u32 v241, v241, v47
    v_max_u32 v242, v242, v51
    v_max_u32 v243, v243, v55
    v_max_u32 v244, v244, v59
    v_max_u32 v245, v245, v63
    v_cmp_eq_u32 vcc, -1, v230
    s_add_u32 s61, s87, 0
    s_or_b64 s[92:93], s[92:93], vcc
    s_mov_b64 exec, vcc
    buffer_load_dwordx4 v[0:3], v219, s[4:7], s61 offen offset:0 sc1
    s_mov_b64 exec, -1
    v_cmp_eq_u32 vcc, -1, v231
    s_or_b64 s[92:93], s[92:93], vcc
    s_mov_b64 exec, vcc
    buffer_load_dwordx4 v[4:7], v219, s[4:7], s61 offen offset:1024 sc1
    s_mov_b64 exec, -1
    v_cmp_eq_u32 vcc, -1, v232
    s_or_b64 s[92:93], s[92:93], vcc
    s_mov_b64 exec, vcc
    buffer_load_dwordx4 v[8:11], v219, s[4:7], s61 offen offset:2048 sc1
    s_mov_b64 exec, -1
    v_cmp_eq_u32 vcc, -1, v233
    s_or_b64 s[92:93], s[92:93], vcc
    s_mov_b64 exec, vcc
    buffer_load_dwordx4 v[12:15], v219, s[4:7], s61 offen offset:3072 sc1
    s_mov_b64 exec, -1
    v_cmp_eq_u32 vcc, -1, v234
    s_add_u32 s61, s87, 4096
    s_or_b64 s[92:93], s[92:93], vcc
    s_mov_b64 exec, vcc
    buffer_load_dwordx4 v[16:19], v219, s[4:7], s61 offen offset:0 sc1
    s_mov_b64 exec, -1
    v_cmp_eq_u32 vcc, -1, v235
    s_or_b64 s[92:93], s[92:93], vcc
    s_mov_b64 exec, vcc
    buffer_load_dwordx4 v[20:23], v219, s[4:7], s61 offen offset:1024 sc1
    s_mov_b64 exec, -1
    v_cmp_eq_u32 vcc, -1, v236
    s_or_b64 s[92:93], s[92:93], vcc
    s_mov_b64 exec, vcc
    buffer_load_dwordx4 v[24:27], v219, s[4:7], s61 offen offset:2048 sc1
    s_mov_b64 exec, -1
    v_cmp_eq_u32 vcc, -1, v237
    s_or_b64 s[92:93], s[92:93], vcc
    s_mov_b64 exec, vcc
    buffer_load_dwordx4 v[28:31], v219, s[4:7], s61 offen offset:3072 sc1
    s_mov_b64 exec, -1
    v_cmp_eq_u32 vcc, -1, v238
    s_add_u32 s61, s87, 8192
    s_or_b64 s[92:93], s[92:93], vcc
    s_mov_b64 exec, vcc
    buffer_load_dwordx4 v[32:35], v219, s[4:7], s61 offen offset:0 sc1
    s_mov_b64 exec, -1
    v_cmp_eq_u32 vcc, -1, v239
    s_or_b64 s[92:93], s[92:93], vcc
    s_mov_b64 exec, vcc
    buffer_load_dwordx4 v[36:39], v219, s[4:7], s61 offen offset:1024 sc1
    s_mov_b64 exec, -1
    v_cmp_eq_u32 vcc, -1, v240
    s_or_b64 s[92:93], s[92:93], vcc
    s_mov_b64 exec, vcc
    buffer_load_dwordx4 v[40:43], v219, s[4:7], s61 offen offset:2048 sc1
    s_mov_b64 exec, -1
    v_cmp_eq_u32 vcc, -1, v241
    s_or_b64 s[92:93], s[92:93], vcc
    s_mov_b64 exec, vcc
    buffer_load_dwordx4 v[44:47], v219, s[4:7], s61 offen offset:3072 sc1
    s_mov_b64 exec, -1
    v_cmp_eq_u32 vcc, -1, v242
    s_add_u32 s61, s87, 12288
    s_or_b64 s[92:93], s[92:93], vcc
    s_mov_b64 exec, vcc
    buffer_load_dwordx4 v[48:51], v219, s[4:7], s61 offen offset:0 sc1
    s_mov_b64 exec, -1
    v_cmp_eq_u32 vcc, -1, v243
    s_or_b64 s[92:93], s[92:93], vcc
    s_mov_b64 exec, vcc
    buffer_load_dwordx4 v[52:55], v219, s[4:7], s61 offen offset:1024 sc1
    s_mov_b64 exec, -1
    v_cmp_eq_u32 vcc, -1, v244
    s_or_b64 s[92:93], s[92:93], vcc
    s_mov_b64 exec, vcc
    buffer_load_dwordx4 v[56:59], v219, s[4:7], s61 offen offset:2048 sc1
    s_mov_b64 exec, -1
    v_cmp_eq_u32 vcc, -1, v245
    s_or_b64 s[92:93], s[92:93], vcc
    s_mov_b64 exec, vcc
    buffer_load_dwordx4 v[60:63], v219, s[4:7], s61 offen offset:3072 sc1
    s_mov_b64 exec, -1
    s_cmp_eq_u64 s[92:93], 0
    s_cbranch_scc1 L_kvretry_9_sum
    s_sub_u32 s65, s65, 1
    s_waitcnt vmcnt(0)
    s_cbranch_scc0 L_kvretry_9_loop
L_kvretry_9_sum:
    s_waitcnt vmcnt(0)
    v_mfma_f32_16x16x32_bf16 v[200:203], v[250:253], v[0:3], 0
    v_mfma_f32_16x16x32_bf16 v[204:207], v[252:255], v[0:3], 0
    v_mfma_f32_16x16x32_bf16 v[200:203], v[250:253], v[4:7], v[200:203]
    v_mfma_f32_16x16x32_bf16 v[204:207], v[252:255], v[4:7], v[204:207]
    v_mfma_f32_16x16x32_bf16 v[200:203], v[250:253], v[8:11], v[200:203]
    v_mfma_f32_16x16x32_bf16 v[204:207], v[252:255], v[8:11], v[204:207]
    v_mfma_f32_16x16x32_bf16 v[200:203], v[250:253], v[12:15], v[200:203]
    v_mfma_f32_16x16x32_bf16 v[204:207], v[252:255], v[12:15], v[204:207]
    v_mfma_f32_16x16x32_bf16 v[200:203], v[250:253], v[16:19], v[200:203]
    v_mfma_f32_16x16x32_bf16 v[204:207], v[252:255], v[16:19], v[204:207]
    v_mfma_f32_16x16x32_bf16 v[200:203], v[250:253], v[20:23], v[200:203]
    v_mfma_f32_16x16x32_bf16 v[204:207], v[252:255], v[20:23], v[204:207]
    v_mfma_f32_16x16x32_bf16 v[200:203], v[250:253], v[24:27], v[200:203]
    v_mfma_f32_16x16x32_bf16 v[204:207], v[252:255], v[24:27], v[204:207]
    v_mfma_f32_16x16x32_bf16 v[200:203], v[250:253], v[28:31], v[200:203]
    v_mfma_f32_16x16x32_bf16 v[204:207], v[252:255], v[28:31], v[204:207]
    v_mfma_f32_16x16x32_bf16 v[200:203], v[250:253], v[32:35], v[200:203]
    v_mfma_f32_16x16x32_bf16 v[204:207], v[252:255], v[32:35], v[204:207]
    v_mfma_f32_16x16x32_bf16 v[200:203], v[250:253], v[36:39], v[200:203]
    v_mfma_f32_16x16x32_bf16 v[204:207], v[252:255], v[36:39], v[204:207]
    v_mfma_f32_16x16x32_bf16 v[200:203], v[250:253], v[40:43], v[200:203]
    v_mfma_f32_16x16x32_bf16 v[204:207], v[252:255], v[40:43], v[204:207]
    v_mfma_f32_16x16x32_bf16 v[200:203], v[250:253], v[44:47], v[200:203]
    v_mfma_f32_16x16x32_bf16 v[204:207], v[252:255], v[44:47], v[204:207]
    v_mfma_f32_16x16x32_bf16 v[200:203], v[250:253], v[48:51], v[200:203]
    v_mfma_f32_16x16x32_bf16 v[204:207], v[252:255], v[48:51], v[204:207]
    v_mfma_f32_16x16x32_bf16 v[200:203], v[250:253], v[52:55], v[200:203]
    v_mfma_f32_16x16x32_bf16 v[204:207], v[252:255], v[52:55], v[204:207]
    v_mfma_f32_16x16x32_bf16 v[200:203], v[250:253], v[56:59], v[200:203]
    v_mfma_f32_16x16x32_bf16 v[204:207], v[252:255], v[56:59], v[204:207]
    v_mfma_f32_16x16x32_bf16 v[200:203], v[250:253], v[60:63], v[200:203]
    v_mfma_f32_16x16x32_bf16 v[204:207], v[252:255], v[60:63], v[204:207]
    s_nop 7
    s_branch L_kvok_10
L_slowpub_11:
    s_waitcnt vmcnt(0)
    buffer_wbl2 sc1
    s_waitcnt vmcnt(0)
    buffer_store_dwordx2 v[202:203], off, s[4:7], s35 offset:1024 sc1
    s_branch L_pubdone_12
L_slowacq_15:
    buffer_inv sc1
    s_waitcnt vmcnt(0)
    s_branch L_acqdone_16
L_slowpub_17:
    s_waitcnt vmcnt(0)
    buffer_wbl2 sc1
    s_waitcnt vmcnt(0)
    buffer_store_dwordx2 v[206:207], off, s[4:7], s35 offset:2048 sc1
    s_branch L_pubdone_18
L_slowacq_21:
    buffer_inv sc1
    s_waitcnt vmcnt(0)
    s_branch L_acqdone_22
L_slowpub_23:
    s_waitcnt vmcnt(0)
    buffer_wbl2 sc1
    s_waitcnt vmcnt(0)
    buffer_store_dwordx2 v[230:231], off, s[4:7], s35 offset:3072 sc1
    s_branch L_pubdone_24
L_slowacq_27:
    buffer_inv sc1
    s_waitcnt vmcnt(0)
    s_branch L_acqdone_28
L_slowpub_29:
    s_waitcnt vmcnt(0)
    buffer_wbl2 sc1
    s_waitcnt vmcnt(0)
    buffer_store_dwordx2 v[206:207], off, s[4:7], s35 offset:0 sc1
    s_branch L_pubdone_30
L_slowacq_33:
    buffer_inv sc1
    s_waitcnt vmcnt(0)
    s_branch L_acqdone_34
L_kvretry_41:
    s_mov_b32 s65, 262144
L_kvretry_41_loop:
    s_mov_b64 s[92:93], 0
    v_max3_u32 v230, v0, v1, v2
    v_max3_u32 v231, v4, v5, v6
    v_max3_u32 v232, v8, v9, v10
    v_max3_u32 v233, v12, v13, v14
    v_max3_u32 v234, v16, v17, v18
    v_max3_u32 v235, v20, v21, v22
    v_max3_u32 v236, v24, v25, v26
    v_max3_u32 v237, v28, v29, v30
    v_max3_u32 v238, v32, v33, v34
    v_max3_u32 v239, v36, v37, v38
    v_max3_u32 v240, v40, v41, v42
    v_max3_u32 v241, v44, v45, v46
    v_max3_u32 v242, v48, v49, v50
    v_max3_u32 v243, v52, v53, v54
    v_max3_u32 v244, v56, v57, v58
    v_max3_u32 v245, v60, v61, v62
    v_max_u32 v230, v230, v3
    v_max_u32 v231, v231, v7
    v_max_u32 v232, v232, v11
    v_max_u32 v233, v233, v15
    v_max_u32 v234, v234, v19
    v_max_u32 v235, v235, v23
    v_max_u32 v236, v236, v27
    v_max_u32 v237, v237, v31
    v_max_u32 v238, v238, v35
    v_max_u32 v239, v239, v39
    v_max_u32 v240, v240, v43
    v_max_u32 v241, v241, v47
    v_max_u32 v242, v242, v51
    v_max_u32 v243, v243, v55
    v_max_u32 v244, v244, v59
    v_max_u32 v245, v245, v63
    v_cmp_eq_u32 vcc, -1, v230
    s_add_u32 s61, s87, 1048576
    s_or_b64 s[92:93], s[92:93], vcc
    s_mov_b64 exec, vcc
    buffer_load_dwordx4 v[0:3], v219, s[4:7], s61 offen offset:0 sc1
    s_mov_b64 exec, -1
    v_cmp_eq_u32 vcc, -1, v231
    s_or_b64 s[92:93], s[92:93], vcc
    s_mov_b64 exec, vcc
    buffer_load_dwordx4 v[4:7], v219, s[4:7], s61 offen offset:1024 sc1
    s_mov_b64 exec, -1
    v_cmp_eq_u32 vcc, -1, v232
    s_or_b64 s[92:93], s[92:93], vcc
    s_mov_b64 exec, vcc
    buffer_load_dwordx4 v[8:11], v219, s[4:7], s61 offen offset:2048 sc1
    s_mov_b64 exec, -1
    v_cmp_eq_u32 vcc, -1, v233
    s_or_b64 s[92:93], s[92:93], vcc
    s_mov_b64 exec, vcc
    buffer_load_dwordx4 v[12:15], v219, s[4:7], s61 offen offset:3072 sc1
    s_mov_b64 exec, -1
    v_cmp_eq_u32 vcc, -1, v234
    s_add_u32 s61, s87, 1052672
    s_or_b64 s[92:93], s[92:93], vcc
    s_mov_b64 exec, vcc
    buffer_load_dwordx4 v[16:19], v219, s[4:7], s61 offen offset:0 sc1
    s_mov_b64 exec, -1
    v_cmp_eq_u32 vcc, -1, v235
    s_or_b64 s[92:93], s[92:93], vcc
    s_mov_b64 exec, vcc
    buffer_load_dwordx4 v[20:23], v219, s[4:7], s61 offen offset:1024 sc1
    s_mov_b64 exec, -1
    v_cmp_eq_u32 vcc, -1, v236
    s_or_b64 s[92:93], s[92:93], vcc
    s_mov_b64 exec, vcc
    buffer_load_dwordx4 v[24:27], v219, s[4:7], s61 offen offset:2048 sc1
    s_mov_b64 exec, -1
    v_cmp_eq_u32 vcc, -1, v237
    s_or_b64 s[92:93], s[92:93], vcc
    s_mov_b64 exec, vcc
    buffer_load_dwordx4 v[28:31], v219, s[4:7], s61 offen offset:3072 sc1
    s_mov_b64 exec, -1
    v_cmp_eq_u32 vcc, -1, v238
    s_add_u32 s61, s87, 1056768
    s_or_b64 s[92:93], s[92:93], vcc
    s_mov_b64 exec, vcc
    buffer_load_dwordx4 v[32:35], v219, s[4:7], s61 offen offset:0 sc1
    s_mov_b64 exec, -1
    v_cmp_eq_u32 vcc, -1, v239
    s_or_b64 s[92:93], s[92:93], vcc
    s_mov_b64 exec, vcc
    buffer_load_dwordx4 v[36:39], v219, s[4:7], s61 offen offset:1024 sc1
    s_mov_b64 exec, -1
    v_cmp_eq_u32 vcc, -1, v240
    s_or_b64 s[92:93], s[92:93], vcc
    s_mov_b64 exec, vcc
    buffer_load_dwordx4 v[40:43], v219, s[4:7], s61 offen offset:2048 sc1
    s_mov_b64 exec, -1
    v_cmp_eq_u32 vcc, -1, v241
    s_or_b64 s[92:93], s[92:93], vcc
    s_mov_b64 exec, vcc
    buffer_load_dwordx4 v[44:47], v219, s[4:7], s61 offen offset:3072 sc1
    s_mov_b64 exec, -1
    v_cmp_eq_u32 vcc, -1, v242
    s_add_u32 s61, s87, 1060864
    s_or_b64 s[92:93], s[92:93], vcc
    s_mov_b64 exec, vcc
    buffer_load_dwordx4 v[48:51], v219, s[4:7], s61 offen offset:0 sc1
    s_mov_b64 exec, -1
    v_cmp_eq_u32 vcc, -1, v243
    s_or_b64 s[92:93], s[92:93], vcc
    s_mov_b64 exec, vcc
    buffer_load_dwordx4 v[52:55], v219, s[4:7], s61 offen offset:1024 sc1
    s_mov_b64 exec, -1
    v_cmp_eq_u32 vcc, -1, v244
    s_or_b64 s[92:93], s[92:93], vcc
    s_mov_b64 exec, vcc
    buffer_load_dwordx4 v[56:59], v219, s[4:7], s61 offen offset:2048 sc1
    s_mov_b64 exec, -1
    v_cmp_eq_u32 vcc, -1, v245
    s_or_b64 s[92:93], s[92:93], vcc
    s_mov_b64 exec, vcc
    buffer_load_dwordx4 v[60:63], v219, s[4:7], s61 offen offset:3072 sc1
    s_mov_b64 exec, -1
    s_cmp_eq_u64 s[92:93], 0
    s_cbranch_scc1 L_kvretry_41_sum
    s_sub_u32 s65, s65, 1
    s_waitcnt vmcnt(0)
    s_cbranch_scc0 L_kvretry_41_loop
L_kvretry_41_sum:
    s_waitcnt vmcnt(0)
    v_mfma_f32_16x16x32_bf16 v[200:203], v[250:253], v[0:3], 0
    v_mfma_f32_16x16x32_bf16 v[204:207], v[252:255], v[0:3], 0
    v_mfma_f32_16x16x32_bf16 v[200:203], v[250:253], v[4:7], v[200:203]
    v_mfma_f32_16x16x32_bf16 v[204:207], v[252:255], v[4:7], v[204:207]
    v_mfma_f32_16x16x32_bf16 v[200:203], v[250:253], v[8:11], v[200:203]
    v_mfma_f32_16x16x32_bf16 v[204:207], v[252:255], v[8:11], v[204:207]
    v_mfma_f32_16x16x32_bf16 v[200:203], v[250:253], v[12:15], v[200:203]
    v_mfma_f32_16x16x32_bf16 v[204:207], v[252:255], v[12:15], v[204:207]
    v_mfma_f32_16x16x32_bf16 v[200:203], v[250:253], v[16:19], v[200:203]
    v_mfma_f32_16x16x32_bf16 v[204:207], v[252:255], v[16:19], v[204:207]
    v_mfma_f32_16x16x32_bf16 v[200:203], v[250:253], v[20:23], v[200:203]
    v_mfma_f32_16x16x32_bf16 v[204:207], v[252:255], v[20:23], v[204:207]
    v_mfma_f32_16x16x32_bf16 v[200:203], v[250:253], v[24:27], v[200:203]
    v_mfma_f32_16x16x32_bf16 v[204:207], v[252:255], v[24:27], v[204:207]
    v_mfma_f32_16x16x32_bf16 v[200:203], v[250:253], v[28:31], v[200:203]
    v_mfma_f32_16x16x32_bf16 v[204:207], v[252:255], v[28:31], v[204:207]
    v_mfma_f32_16x16x32_bf16 v[200:203], v[250:253], v[32:35], v[200:203]
    v_mfma_f32_16x16x32_bf16 v[204:207], v[252:255], v[32:35], v[204:207]
    v_mfma_f32_16x16x32_bf16 v[200:203], v[250:253], v[36:39], v[200:203]
    v_mfma_f32_16x16x32_bf16 v[204:207], v[252:255], v[36:39], v[204:207]
    v_mfma_f32_16x16x32_bf16 v[200:203], v[250:253], v[40:43], v[200:203]
    v_mfma_f32_16x16x32_bf16 v[204:207], v[252:255], v[40:43], v[204:207]
    v_mfma_f32_16x16x32_bf16 v[200:203], v[250:253], v[44:47], v[200:203]
    v_mfma_f32_16x16x32_bf16 v[204:207], v[252:255], v[44:47], v[204:207]
    v_mfma_f32_16x16x32_bf16 v[200:203], v[250:253], v[48:51], v[200:203]
    v_mfma_f32_16x16x32_bf16 v[204:207], v[252:255], v[48:51], v[204:207]
    v_mfma_f32_16x16x32_bf16 v[200:203], v[250:253], v[52:55], v[200:203]
    v_mfma_f32_16x16x32_bf16 v[204:207], v[252:255], v[52:55], v[204:207]
    v_mfma_f32_16x16x32_bf16 v[200:203], v[250:253], v[56:59], v[200:203]
    v_mfma_f32_16x16x32_bf16 v[204:207], v[252:255], v[56:59], v[204:207]
    v_mfma_f32_16x16x32_bf16 v[200:203], v[250:253], v[60:63], v[200:203]
    v_mfma_f32_16x16x32_bf16 v[204:207], v[252:255], v[60:63], v[204:207]
    s_nop 7
    s_branch L_kvok_42
L_slowpub_43:
    s_waitcnt vmcnt(0)
    buffer_wbl2 sc1
    s_waitcnt vmcnt(0)
    buffer_store_dwordx2 v[202:203], off, s[4:7], s35 offset:1024 sc1
    s_branch L_pubdone_44
L_slowacq_47:
    buffer_inv sc1
    s_waitcnt vmcnt(0)
    s_branch L_acqdone_48
L_slowpub_49:
    s_waitcnt vmcnt(0)
    buffer_wbl2 sc1
    s_waitcnt vmcnt(0)
    buffer_store_dwordx2 v[206:207], off, s[4:7], s35 offset:2048 sc1
    s_branch L_pubdone_50
L_slowacq_53:
    buffer_inv sc1
    s_waitcnt vmcnt(0)
    s_branch L_acqdone_54
L_slowpub_55:
    s_waitcnt vmcnt(0)
    buffer_wbl2 sc1
    s_waitcnt vmcnt(0)
    buffer_store_dwordx2 v[230:231], off, s[4:7], s35 offset:3072 sc1
    s_branch L_pubdone_56
L_slowacq_59:
    buffer_inv sc1
    s_waitcnt vmcnt(0)
    s_branch L_acqdone_60
L_end:
    s_endpgm
.section .rodata,"a"
.p2align 6
.amdhsa_kernel interleave_layers__linear_kernel_hedgehog__dense_activation_squared_relu__prompt_kernel
  .amdhsa_next_free_vgpr 512
  .amdhsa_next_free_sgpr 102
  .amdhsa_accum_offset 256
  .amdhsa_group_segment_fixed_size 0
  .amdhsa_kernarg_size 96
  .amdhsa_user_sgpr_count 2
  .amdhsa_user_sgpr_kernarg_segment_ptr 1
  .amdhsa_system_sgpr_workgroup_id_x 1
  .amdhsa_float_denorm_mode_32 3
.end_amdhsa_kernel
```
